```python
import torch

def _softmax(x, axis=-1):
    return torch.softmax(x, dim=axis)
def _gelu(x):
    return torch.nn.functional.gelu(x, approximate="tanh")
def _silu(x):
    return torch.nn.functional.silu(x)
def _sigmoid(x):
    return torch.sigmoid(x)
def _layernorm(x, axis=-1, eps=1e-5):
    m = x.mean(dim=axis, keepdim=True)
    v = x.var(dim=axis, keepdim=True, unbiased=False)
    return (x - m) / torch.sqrt(v + eps)
def _scatter_add(tgt, idx, src, axis=0):
    return tgt.clone().index_add_(axis, idx, src)
def _segment_sum(src, seg, n):
    out = torch.zeros((n,) + src.shape[1:], dtype=src.dtype)
    return out.index_add_(0, seg, src)
def _pad(x, pw):
    flat = tuple(v for pair in reversed(pw) for v in pair)
    return torch.nn.functional.pad(x, flat)

kernel_name = 'parallel_sum__ssm_conv_h3__dense_activation_gelu__prompt'

def setup_inputs():

    _w = (lambda a: (lambda t: t.to(torch.bfloat16) if t.is_floating_point() else t)(torch.as_tensor(a)))
    def _A_setup():
        B, S, D = 1, 2048, 576
        ks = 4
        return {
            "q": _w((lambda *s: torch.randn(*s, dtype=torch.bfloat16) * 0.05)(B, S, D)),
            "k": _w((lambda *s: torch.randn(*s, dtype=torch.bfloat16) * 0.2)(B, S, D)),
            "v": _w((lambda *s: torch.randn(*s, dtype=torch.bfloat16) * 0.2)(B, S, D)),
            "shift_k": _w((lambda *s: torch.randn(*s, dtype=torch.bfloat16) * 0.2)(D, ks) * 0.5),
            "ssm_k": _w((lambda *s: torch.randn(*s, dtype=torch.bfloat16) * 0.8)(D, S) * (1.0 / S ** 0.5)),
            "ssm_D": _w((lambda *s: torch.randn(*s, dtype=torch.bfloat16) * 0.2)(D)),
        }
    _A_in = _A_setup()

    def _B_setup():
        B, S, D, F = 1, 2048, 576, 4608
        return {
            "x": _w((lambda *s: torch.randn(*s, dtype=torch.bfloat16) * 0.05)(B, S, D)),
            "w1": _w((lambda *s: torch.randn(*s, dtype=torch.bfloat16) * 0.4)(D, F) * (D ** -0.5)),
            "b1": _w((lambda *s: torch.randn(*s, dtype=torch.bfloat16) * 12.8)(F) * 0.01),
            "w2": _w((lambda *s: torch.randn(*s, dtype=torch.bfloat16) * 0.2)(F, D) * (F ** -0.5)),
            "b2": _w((lambda *s: torch.randn(*s, dtype=torch.bfloat16) * 1.6)(D) * 0.01),
        }
    _B_in = _B_setup()

    return {
        "A_q": _A_in["q"],
        "A_k": _A_in["k"],
        "A_v": _A_in["v"],
        "A_shift_k": _A_in["shift_k"],
        "A_ssm_k": _A_in["ssm_k"],
        "A_ssm_D": _A_in["ssm_D"],
        "B_x": _B_in["x"],
        "B_w1": _B_in["w1"],
        "B_b1": _B_in["b1"],
        "B_w2": _B_in["w2"],
        "B_b2": _B_in["b2"],
    }

def reference(A_q, A_k, A_v, A_shift_k, A_ssm_k, A_ssm_D, B_x, B_w1, B_b1, B_w2, B_b2):
    def _A_ref(q, k, v, shift_k, ssm_k, ssm_D):
        B, S, D = q.shape
        ks = shift_k.shape[-1]
        k_pad = _pad(k, ((0, 0), (ks - 1, 0), (0, 0)))
        k_shift = torch.zeros_like(k)
        for t in range(ks):
            k_shift = k_shift + k_pad[:, t:t + S, :] * shift_k[:, ks - 1 - t][None, None, :]
        kv = k_shift * v
        L = 2 * S
        kv_pad = _pad(kv, ((0, 0), (0, S), (0, 0)))
        kf_pad = _pad(ssm_k, ((0, 0), (0, S)))
        kv_f = (lambda x, axes=(-2,-1): torch.fft.rfft2(x.float(), dim=axes))(kv_pad[:, None, :, :], axes=(1, 2))
        kf_f = (lambda x, axes=(-2,-1): torch.fft.rfft2(x.float(), dim=axes))(kf_pad[:, None, :], axes=(1, 2))
        kf_f = (lambda x, *d: x.permute(*d))(kf_f, 1, 2, 0)
        y_f = kv_f * kf_f[None, :, :, :]
        y = (lambda x, s, axes=(-2,-1): torch.fft.irfft2(x, s=s, dim=axes).to(torch.bfloat16))(y_f, (1, L), axes=(1, 2))[:, 0, :S, :]
        y = y + kv * ssm_D[None, None, :]
        return q * y

    def _B_ref(x, w1, b1, w2, b2):
        h = torch.einsum("bsd,df->bsf", x, w1) + b1
        h = _gelu(h)
        return torch.einsum("bsf,fd->bsd", h, w2) + b2

    x = A_q
    xn = _layernorm(x, axis=-1)
    return x + _A_ref(xn, A_k, A_v, A_shift_k, A_ssm_k, A_ssm_D) + _B_ref(xn, B_w1, B_b1, B_w2, B_b2)
```

```asm
; @launch grid=(256,1,1) block=(256,1,1) lds=163840
.amdgcn_target "amdgcn-amd-amdhsa--gfx950"
.text
.globl parallel_sum__ssm_conv_h3__dense_activation_gelu__prompt_kernel
.p2align 12
.type parallel_sum__ssm_conv_h3__dense_activation_gelu__prompt_kernel,@function
parallel_sum__ssm_conv_h3__dense_activation_gelu__prompt_kernel:
s_cmp_ge_u32 s2, 256
s_cbranch_scc1 L_end
s_load_dwordx2 s[8:9], s[0:1], 0
s_getpc_b64 s[84:85]
L_pc:
s_mov_b32 s86, ZEND-L_pc
s_mov_b32 s87, 0x20000
s_lshr_b32 s83, s2, 3
s_mul_i32 s83, s83, 1536
v_min_u32 v2, 11, v0
v_lshlrev_b32 v2, 7, v2
buffer_load_dword v183, v2, s[84:87], s83 offen
v_lshrrev_b32 v1, 6, v0
v_and_b32 v15, 63, v0
v_readfirstlane_b32 s3, v1
s_and_b32 s70, s2, 7
s_lshr_b32 s71, s2, 3
s_and_b32 s4, s70, 3
s_lshl_b32 s4, s4, 3
s_lshr_b32 s72, s71, 2
s_add_u32 s4, s4, s72
s_and_b32 s5, s70, 4
s_and_b32 s72, s71, 3
s_add_u32 s5, s5, s72
s_and_b32 s72, s5, 1
s_mov_b32 s10, 2359296
s_mov_b32 s11, 0x20000
v_lshrrev_b32 v35, 3, v15
v_mul_u32_u24 v34, 1152, v35
v_and_b32 v21, 7, v15
v_lshl_add_u32 v34, v21, 4, v34
s_lshl_b32 s75, s4, 2
s_add_u32 s75, s75, s3
s_mul_i32 s73, s75, 9
s_mul_i32 s75, s75, 18432
s_mul_i32 s72, s72, 9216
s_add_u32 s88, s75, s72
s_add_u32 s82, s75, 9216
s_sub_u32 s82, s82, s72
s_lshr_b32 s73, s73, 1
s_min_u32 s73, s73, 571
v_mul_u32_u24 v36, 52, v15
v_lshrrev_b32 v36, 8, v36
v_mul_u32_u24 v37, 5, v36
v_sub_u32 v37, v15, v37
v_mul_u32_u24 v38, 9216, v37
v_lshl_add_u32 v182, v36, 7, v38
s_waitcnt lgkmcnt(0)
buffer_load_dwordx4 v[48:51], v34, s[8:11], s88 offen offset:0
buffer_load_dwordx4 v[52:55], v34, s[8:11], s88 offen offset:128
buffer_load_dwordx4 v[56:59], v34, s[8:11], s88 offen offset:256
buffer_load_dwordx4 v[60:63], v34, s[8:11], s88 offen offset:384
buffer_load_dwordx4 v[64:67], v34, s[8:11], s88 offen offset:512
buffer_load_dwordx4 v[68:71], v34, s[8:11], s88 offen offset:640
buffer_load_dwordx4 v[72:75], v34, s[8:11], s88 offen offset:768
buffer_load_dwordx4 v[76:79], v34, s[8:11], s88 offen offset:896
buffer_load_dwordx4 v[80:83], v34, s[8:11], s88 offen offset:1024
s_load_dwordx2 s[20:21], s[0:1], 56
s_load_dwordx2 s[40:41], s[0:1], 64
s_load_dwordx2 s[28:29], s[0:1], 104
s_load_dwordx2 s[44:45], s[0:1], 80
s_load_dwordx2 s[48:49], s[0:1], 24
s_load_dwordx2 s[36:37], s[0:1], 32
s_load_dwordx2 s[52:53], s[0:1], 40
s_load_dwordx2 s[12:13], s[0:1], 8
s_load_dwordx2 s[16:17], s[0:1], 16
s_load_dwordx2 s[24:25], s[0:1], 72
s_load_dwordx2 s[32:33], s[0:1], 88
s_mov_b32 s14, 2359296
s_mov_b32 s15, 0x20000
s_mov_b32 s18, 2359296
s_mov_b32 s19, 0x20000
s_mov_b32 s22, 5308416
s_mov_b32 s23, 0x20000
s_mov_b32 s26, 5308416
s_mov_b32 s27, 0x20000
s_mov_b32 s30, 268435456
s_mov_b32 s31, 0x20000
s_mov_b32 s34, 2359296
s_mov_b32 s35, 0x20000
s_mov_b32 s38, 2359296
s_mov_b32 s39, 0x20000
s_mov_b32 s42, 9216
s_mov_b32 s43, 0x20000
s_mov_b32 s46, 1152
s_mov_b32 s47, 0x20000
s_mov_b32 s50, 4608
s_mov_b32 s51, 0x20000
s_mul_i32 s58, s5, 1152
s_mul_i32 s87, s73, 9216
s_add_u32 s87, s87, s58
v_min_u32 v39, 35, v15
v_lshlrev_b32 v39, 3, v39
s_mul_i32 s83, s3, 288
s_add_u32 s83, s83, s58
s_bfe_u32 s74, s4, 0x10002
s_lshl_b32 s74, s74, 7
s_lshl_b32 s67, s5, 5
s_add_u32 s67, s67, s4
s_lshl_b32 s67, s67, 13
s_lshr_b32 s70, s4, 2
s_lshl_b32 s71, s5, 3
s_add_u32 s71, s71, s70
s_add_u32 s71, s71, 512
s_lshl_b32 s55, s71, 12
s_lshl_b32 s6, s3, 12
s_add_u32 s66, s67, s6
s_cmp_lt_u32 s3, 2
s_cselect_b32 s66, s66, s55
s_lshr_b32 s7, s66, 13
s_lshl_b32 s7, s7, 2
v_lshrrev_b32 v22, 4, v15
v_lshlrev_b32 v23, 1, v22
v_xor_b32 v23, v23, v15
v_lshlrev_b32 v4, 4, v23
v_add_u32 v5, 0x10000, v4
s_lshr_b32 s72, s3, 1
s_lshl_b32 s72, s72, 12
s_and_b32 s71, s3, 1
s_lshl_b32 s71, s71, 3
s_add_u32 s72, s72, s71
v_add_u32 v6, s72, v4
v_cmp_eq_u32 vcc, 0, v0
v_mov_b32 v23, 2147483648
v_lshlrev_b32 v17, 3, v22
v_cndmask_b32 v19, v23, 0, vcc
v_lshlrev_b32 v16, 4, v15
s_lshl_b32 s72, s3, 6
s_add_u32 s72, s72, 159744
v_lshl_add_u32 v7, v22, 4, s72
v_lshrrev_b32 v22, 5, v15
v_bfe_u32 v23, v15, 3, 2
v_lshlrev_b32 v37, 2, v22
v_lshl_add_u32 v22, v22, 3, v23
v_bfe_u32 v20, v15, 4, 2
v_lshlrev_b32 v20, 1, v20
v_xor_b32 v20, v20, v21
v_lshlrev_b32 v20, 4, v20
s_movk_i32 s70, 9216
v_mad_u32_u24 v0, v22, s70, v20
v_add_u32 v1, 146432, v0
v_add_u32 v2, 34816, v0
v_add_u32 v3, 181248, v0
s_movk_i32 s70, 1152
v_mad_u32_u24 v8, v35, s70, v20
s_mul_i32 s70, s5, 663552
v_add_u32 v8, s70, v8
v_add_u32 v9, 8192, v8
v_add_u32 v10, 16384, v8
v_add_u32 v11, 24576, v8
s_mul_i32 s70, s3, 294912
s_add_u32 s58, s58, s70
s_sub_u32 s81, s58, s74
s_add_u32 s58, s58, s74
s_sub_u32 s59, s81, 5308288
s_cmp_lt_u32 s3, 2
s_cselect_b32 s59, s58, s59
v_xor_b32 v23, s3, v23
v_lshlrev_b32 v23, 5, v23
v_lshrrev_b32 v22, 2, v15
v_lshl_add_u32 v23, v22, 7, v23
v_and_b32 v22, 3, v15
v_lshl_add_u32 v12, v22, 3, v23
v_add_u32 v13, 0x10000, v12
v_add_u32 v14, 0x20000, v12
s_mov_b32 s62, 0xc09d30fc
s_mov_b32 s63, 0x3eeff558
s_mov_b32 s64, 0xffff0000
s_mov_b32 s65, 0x40088e99
s_mov_b32 s61, 0x10001
v_lshlrev_b32 v26, 1, v22
v_xor_b32 v26, v26, v35
v_lshl_add_u32 v24, v22, 4, v26
s_lshl_b32 s72, s3, 10
v_lshl_add_u32 v24, v24, 4, s72
v_bfe_u32 v26, v15, 2, 1
v_lshl_add_u32 v24, v26, 12, v24
s_lshl_b32 s72, s3, 7
s_add_u32 s72, s72, 162048
v_lshl_add_u32 v25, v35, 3, s72
s_and_b32 s72, s5, 1
v_lshl_add_u32 v24, s72, 7, v24
v_lshl_add_u32 v25, s72, 6, v25
v_add_u32 v27, 0x8000, v24
v_xor_b32 v30, 128, v24
v_xor_b32 v31, 128, v27
v_xor_b32 v36, 64, v25
s_lshl_b32 s72, s5, 7
s_add_u32 s70, s75, s72
v_add_u32 v164, s70, v34
s_mul_i32 s70, s4, 73728
s_add_u32 s72, s72, s70
s_sub_u32 s72, s72, 9216
s_lshl_b32 s71, s5, 4
s_add_u32 s71, s71, s70
s_add_u32 s71, s71, 1024
s_sub_u32 s70, s71, 73728
v_mul_u32_u24 v41, 1152, v15
s_cmp_eq_u32 s3, 0
s_cselect_b32 s72, s72, 2147483648
v_add_u32 v165, s72, v34
s_cmp_lt_u32 s3, 2
s_cselect_b32 s70, s70, s71
s_cselect_b32 vcc_lo, -1, 0
s_cselect_b32 vcc_hi, 0x0fffffff, 0
v_add_u32 v41, s70, v41
v_bfrev_b32 v44, 1
v_cndmask_b32 v41, v41, v44, vcc
v_lshlrev_b32 v44, 3, v22
s_mul_i32 s72, s3, 576
s_add_u32 s72, s72, 159744
v_lshl_add_u32 v26, v39, 1, s72
v_cmp_gt_u32 vcc, 161280, v26
s_lshl_b32 s72, s74, 1
v_xor_b32 v35, s72, v26
v_cndmask_b32 v26, v26, v35, vcc
v_and_b32 v35, 15, v15
v_lshlrev_b32 v35, 3, v35
v_mov_b32 v46, 0
s_lshl_b32 s57, s5, 7
s_lshl_b32 s73, s3, 5
s_add_u32 s57, s57, s73
s_mul_i32 s70, s4, 73728
s_add_u32 s76, s70, s57
s_lshl_b32 s86, s5, 4
s_and_b32 s73, s3, 1
s_lshl_b32 s73, s73, 3
s_add_u32 s86, s86, s73
s_add_u32 s86, s86, 1024
s_add_u32 s79, s70, s86
s_lshr_b32 s73, s3, 1
s_mul_i32 s73, s73, 36864
s_add_u32 s79, s79, s73
s_lshl_b32 s54, s57, 2
s_lshl_b32 s56, s86, 2
v_and_b32 v20, 1, v15
v_lshlrev_b32 v20, 4, v20
s_movk_i32 s70, 0x3f80
v_lshlrev_b32 v20, v20, s70
s_mov_b32 vcc_lo, 0x00300003
s_mov_b32 vcc_hi, 0x30000300
v_cndmask_b32 v174, 0, v20, vcc
s_lshl_b64 vcc, vcc, 2
v_cndmask_b32 v175, 0, v20, vcc
v_mov_b32 v172, 0
v_mov_b32 v173, 0
v_mov_b32 v176, 0
v_mov_b32 v177, 0
v_lshrrev_b32 v166, 4, v15
v_bfe_u32 v20, v15, 2, 2
v_and_b32 v21, 3, v15
s_lshl_b32 s72, s3, 5
v_lshl_add_u32 v167, v166, 2, v21
v_lshl_add_u32 v167, v167, 2, v20
s_bfe_u32 s73, s72, 0x40002
s_add_u32 s73, s73, 157632
v_lshl_add_u32 v167, v167, 4, s73
v_lshlrev_b32 v20, 7, v20
v_lshl_add_u32 v20, v21, 3, v20
s_add_u32 s72, s72, 139264
v_add_u32 v20, s72, v20
v_lshl_add_u32 v166, v166, 10, v20
v_add_u32 v125, 162048, v35
s_lshr_b32 s72, s3, 1
v_and_b32 v126, 31, v15
s_lshl_b32 s73, s72, 8
s_add_u32 s73, s73, 162048
v_lshl_add_u32 v126, v126, 3, s73
s_and_b32 s74, s3, 1
s_lshl_b32 s73, s74, 1
v_lshrrev_b32 v20, 5, v15
v_add_u32 v124, s73, v20
v_and_b32 v21, 15, v15
v_mul_u32_u24 v124, 18, v124
v_xor_b32 v124, v124, v21
v_and_b32 v22, 8, v17
v_lshl_add_u32 v124, v124, 4, v22
s_lshl_b32 s73, s5, 1
s_add_u32 s73, s73, s72
s_lshl_b32 s73, s73, 12
v_add_u32 v124, s73, v124
s_and_b32 s73, s5, 3
s_mul_i32 s73, s73, 18
v_xor_b32 v181, s73, v21
v_lshlrev_b32 v181, 4, v181
v_lshl_add_u32 v181, v20, 2, v181
v_lshl_add_u32 v181, v22, 7, v181
s_lshr_b32 s73, s5, 2
s_lshl_b32 s73, s73, 12
s_lshl_b32 s72, s72, 11
s_add_u32 s73, s73, s72
s_lshl_b32 s74, s74, 3
s_add_u32 s73, s73, s74
s_add_u32 s73, s73, 65536
v_add_u32 v181, s73, v181
s_cmp_eq_u32 s3, 0
s_cbranch_scc1 PAD1
s_cmp_eq_u32 s3, 1
s_cbranch_scc1 PAD2
s_cmp_eq_u32 s3, 2
s_cbranch_scc1 PAD3
s_branch PAD4
L_back:
buffer_load_dwordx4 v[84:87], v34, s[8:11], s82 offen offset:0
buffer_load_dwordx4 v[88:91], v34, s[8:11], s82 offen offset:128
buffer_load_dwordx4 v[92:95], v34, s[8:11], s82 offen offset:256
buffer_load_dwordx4 v[96:99], v34, s[8:11], s82 offen offset:384
buffer_load_dwordx4 v[100:103], v34, s[8:11], s82 offen offset:512
buffer_load_dwordx4 v[104:107], v34, s[8:11], s82 offen offset:640
buffer_load_dwordx4 v[108:111], v34, s[8:11], s82 offen offset:768
buffer_load_dwordx4 v[112:115], v34, s[8:11], s82 offen offset:896
buffer_load_dwordx4 v[116:119], v34, s[8:11], s82 offen offset:1024
s_waitcnt lgkmcnt(0)
s_mov_b32 s70, 0x3f803f80
v_mov_b32 v144, 0
v_mov_b32 v150, 0
v_mov_b32 v145, 0
v_mov_b32 v151, 0
v_mov_b32 v146, 0
v_mov_b32 v152, 0
v_mov_b32 v147, 0
v_mov_b32 v153, 0
s_waitcnt vmcnt(17)
buffer_load_dwordx2 v[32:33], v39, s[40:43], s83 offen
v_dot2c_f32_bf16 v144, s70, v48
v_dot2c_f32_bf16 v146, v48, v48
v_dot2c_f32_bf16 v145, s70, v49
v_dot2c_f32_bf16 v147, v49, v49
v_dot2c_f32_bf16 v144, s70, v50
v_dot2c_f32_bf16 v146, v50, v50
v_dot2c_f32_bf16 v145, s70, v51
v_dot2c_f32_bf16 v147, v51, v51
v_mfma_f32_16x16x32_bf16 v[184:187], v[174:177], v[48:51], 0
v_mfma_f32_16x16x32_bf16 v[188:191], v[172:175], v[48:51], 0
s_waitcnt vmcnt(17)
buffer_load_dwordx2 v[178:179], v17, s[44:47], s57 offen
v_dot2c_f32_bf16 v144, s70, v52
v_dot2c_f32_bf16 v146, v52, v52
v_dot2c_f32_bf16 v145, s70, v53
v_dot2c_f32_bf16 v147, v53, v53
v_dot2c_f32_bf16 v144, s70, v54
v_dot2c_f32_bf16 v146, v54, v54
v_dot2c_f32_bf16 v145, s70, v55
v_dot2c_f32_bf16 v147, v55, v55
v_mfma_f32_16x16x32_bf16 v[192:195], v[174:177], v[52:55], 0
v_mfma_f32_16x16x32_bf16 v[196:199], v[172:175], v[52:55], 0
s_waitcnt vmcnt(17)
buffer_load_dword v180, v37, s[44:47], s86 offen
v_dot2c_f32_bf16 v144, s70, v56
v_dot2c_f32_bf16 v146, v56, v56
v_dot2c_f32_bf16 v145, s70, v57
v_dot2c_f32_bf16 v147, v57, v57
v_dot2c_f32_bf16 v144, s70, v58
v_dot2c_f32_bf16 v146, v58, v58
v_dot2c_f32_bf16 v145, s70, v59
v_dot2c_f32_bf16 v147, v59, v59
v_mfma_f32_16x16x32_bf16 v[200:203], v[174:177], v[56:59], 0
v_mfma_f32_16x16x32_bf16 v[204:207], v[172:175], v[56:59], 0
s_waitcnt vmcnt(17)
s_cmp_eq_u32 s3, 3
s_cselect_b32 s44, s16, s12
s_cselect_b32 s45, s17, s13
s_mov_b32 s46, 2359296
s_lshr_b32 s71, s6, 2
s_add_u32 m0, s71, 155648
s_nop 0
buffer_load_dwordx4 v41, s[44:47], 0 offen lds
v_dot2c_f32_bf16 v144, s70, v60
v_dot2c_f32_bf16 v146, v60, v60
v_dot2c_f32_bf16 v145, s70, v61
v_dot2c_f32_bf16 v147, v61, v61
v_dot2c_f32_bf16 v144, s70, v62
v_dot2c_f32_bf16 v146, v62, v62
v_dot2c_f32_bf16 v145, s70, v63
v_dot2c_f32_bf16 v147, v63, v63
v_mfma_f32_16x16x32_bf16 v[208:211], v[174:177], v[60:63], 0
v_mfma_f32_16x16x32_bf16 v[212:215], v[172:175], v[60:63], 0
s_waitcnt vmcnt(17)
s_mov_b32 exec_lo, 0x3ff
s_mov_b32 exec_hi, 0x0
buffer_load_dword v183, v182, s[20:23], s87 offen
s_mov_b64 exec, -1
v_dot2c_f32_bf16 v144, s70, v64
v_dot2c_f32_bf16 v146, v64, v64
v_dot2c_f32_bf16 v145, s70, v65
v_dot2c_f32_bf16 v147, v65, v65
v_dot2c_f32_bf16 v144, s70, v66
v_dot2c_f32_bf16 v146, v66, v66
v_dot2c_f32_bf16 v145, s70, v67
v_dot2c_f32_bf16 v147, v67, v67
s_waitcnt vmcnt(17)
buffer_load_dwordx2 v[42:43], v35, s[48:51], s54 offen
v_dot2c_f32_bf16 v144, s70, v68
v_dot2c_f32_bf16 v146, v68, v68
v_dot2c_f32_bf16 v145, s70, v69
v_dot2c_f32_bf16 v147, v69, v69
v_dot2c_f32_bf16 v144, s70, v70
v_dot2c_f32_bf16 v146, v70, v70
v_dot2c_f32_bf16 v145, s70, v71
v_dot2c_f32_bf16 v147, v71, v71
s_waitcnt vmcnt(17)
buffer_load_dwordx2 v[44:45], v44, s[48:51], s56 offen
v_dot2c_f32_bf16 v144, s70, v72
v_dot2c_f32_bf16 v146, v72, v72
v_dot2c_f32_bf16 v145, s70, v73
v_dot2c_f32_bf16 v147, v73, v73
v_dot2c_f32_bf16 v144, s70, v74
v_dot2c_f32_bf16 v146, v74, v74
v_dot2c_f32_bf16 v145, s70, v75
v_dot2c_f32_bf16 v147, v75, v75
s_waitcnt vmcnt(17)
buffer_load_dword v46, v46, s[28:31], 0 offen sc1
v_dot2c_f32_bf16 v144, s70, v76
v_dot2c_f32_bf16 v146, v76, v76
v_dot2c_f32_bf16 v145, s70, v77
v_dot2c_f32_bf16 v147, v77, v77
v_dot2c_f32_bf16 v144, s70, v78
v_dot2c_f32_bf16 v146, v78, v78
v_dot2c_f32_bf16 v145, s70, v79
v_dot2c_f32_bf16 v147, v79, v79
s_waitcnt vmcnt(17)
s_mov_b32 exec_lo, 0x3ffffc00
s_mov_b32 exec_hi, 0x0
buffer_load_dword v183, v182, s[20:23], s87 offen
s_mov_b64 exec, -1
v_dot2c_f32_bf16 v144, s70, v80
v_dot2c_f32_bf16 v146, v80, v80
v_dot2c_f32_bf16 v145, s70, v81
v_dot2c_f32_bf16 v147, v81, v81
v_dot2c_f32_bf16 v144, s70, v82
v_dot2c_f32_bf16 v146, v82, v82
v_dot2c_f32_bf16 v145, s70, v83
v_dot2c_f32_bf16 v147, v83, v83
v_mfma_f32_16x16x32_bf16 v[216:219], v[174:177], v[64:67], 0
v_mfma_f32_16x16x32_bf16 v[220:223], v[172:175], v[64:67], 0
v_add_f32 v144, v144, v145
v_add_f32 v146, v146, v147
v_mfma_f32_16x16x32_bf16 v[224:227], v[174:177], v[68:71], 0
v_add_f32_dpp v144, v144, v144 quad_perm:[1,0,3,2] row_mask:0xf bank_mask:0xf
v_add_f32_dpp v146, v146, v146 quad_perm:[1,0,3,2] row_mask:0xf bank_mask:0xf
v_mfma_f32_16x16x32_bf16 v[228:231], v[172:175], v[68:71], 0
v_add_f32_dpp v144, v144, v144 quad_perm:[2,3,0,1] row_mask:0xf bank_mask:0xf
v_add_f32_dpp v146, v146, v146 quad_perm:[2,3,0,1] row_mask:0xf bank_mask:0xf
v_mfma_f32_16x16x32_bf16 v[232:235], v[174:177], v[72:75], 0
v_add_f32_dpp v144, v144, v144 row_half_mirror row_mask:0xf bank_mask:0xf
v_add_f32_dpp v146, v146, v146 row_half_mirror row_mask:0xf bank_mask:0xf
v_mfma_f32_16x16x32_bf16 v[236:239], v[172:175], v[72:75], 0
v_mul_f32 v144, 0x3ae38e39, v144
v_mul_f32 v146, 0x3ae38e39, v146
v_mfma_f32_16x16x32_bf16 v[240:243], v[174:177], v[76:79], 0
v_fma_f32 v146, -v144, v144, v146
v_max_f32 v146, 0, v146
v_mfma_f32_16x16x32_bf16 v[244:247], v[172:175], v[76:79], 0
v_cvt_pk_bf16_f32 v145, v144, v146
v_and_b32 v146, s64, v145
v_mfma_f32_16x16x32_bf16 v[248:251], v[174:177], v[80:83], 0
v_lshlrev_b32 v144, 16, v145
v_add_f32 v146, 0x3727c5ac, v146
v_mfma_f32_16x16x32_bf16 v[252:255], v[172:175], v[80:83], 0
v_cvt_pk_bf16_f32 v146, v146, v146
v_and_b32 v146, s64, v146
v_sqrt_f32 v146, v146
s_nop 0
v_cvt_pk_bf16_f32 v146, v146, v146
v_and_b32 v146, s64, v146
v_mul_f32 v145, s65, v146
v_rcp_f32 v146, v146
s_nop 0
v_mul_f32 v148, s63, v146
v_mul_f32 v149, -v144, v148
v_pk_fma_f32 v[184:185], v[184:185], v[148:149], v[148:149] op_sel:[0,0,1] op_sel_hi:[1,0,1]
v_pk_fma_f32 v[186:187], v[186:187], v[148:149], v[148:149] op_sel:[0,0,1] op_sel_hi:[1,0,1]
v_pk_fma_f32 v[188:189], v[188:189], v[148:149], v[148:149] op_sel:[0,0,1] op_sel_hi:[1,0,1]
v_pk_fma_f32 v[190:191], v[190:191], v[148:149], v[148:149] op_sel:[0,0,1] op_sel_hi:[1,0,1]
s_waitcnt vmcnt(17)
v_dot2c_f32_bf16 v150, s70, v84
v_dot2c_f32_bf16 v152, v84, v84
v_dot2c_f32_bf16 v151, s70, v85
v_dot2c_f32_bf16 v153, v85, v85
v_dot2c_f32_bf16 v150, s70, v86
v_dot2c_f32_bf16 v152, v86, v86
v_dot2c_f32_bf16 v151, s70, v87
v_dot2c_f32_bf16 v153, v87, v87
v_mfma_f32_16x16x32_bf16 v[128:131], v[174:177], v[84:87], 0
v_cvt_pk_bf16_f32 v48, v184, v185
v_cvt_pk_bf16_f32 v49, v186, v187
v_mfma_f32_16x16x32_bf16 v[132:135], v[172:175], v[84:87], 0
v_cvt_pk_bf16_f32 v50, v188, v189
v_cvt_pk_bf16_f32 v51, v190, v191
ds_write_b64 v25, v[144:145]
ds_write_b128 v24, v[48:51] offset:0
v_pk_fma_f32 v[192:193], v[192:193], v[148:149], v[148:149] op_sel:[0,0,1] op_sel_hi:[1,0,1]
v_pk_fma_f32 v[194:195], v[194:195], v[148:149], v[148:149] op_sel:[0,0,1] op_sel_hi:[1,0,1]
v_pk_fma_f32 v[196:197], v[196:197], v[148:149], v[148:149] op_sel:[0,0,1] op_sel_hi:[1,0,1]
v_pk_fma_f32 v[198:199], v[198:199], v[148:149], v[148:149] op_sel:[0,0,1] op_sel_hi:[1,0,1]
s_waitcnt vmcnt(16)
v_dot2c_f32_bf16 v150, s70, v88
v_dot2c_f32_bf16 v152, v88, v88
v_dot2c_f32_bf16 v151, s70, v89
v_dot2c_f32_bf16 v153, v89, v89
v_dot2c_f32_bf16 v150, s70, v90
v_dot2c_f32_bf16 v152, v90, v90
v_dot2c_f32_bf16 v151, s70, v91
v_dot2c_f32_bf16 v153, v91, v91
v_mfma_f32_16x16x32_bf16 v[136:139], v[174:177], v[88:91], 0
v_cvt_pk_bf16_f32 v52, v192, v193
v_cvt_pk_bf16_f32 v53, v194, v195
v_mfma_f32_16x16x32_bf16 v[140:143], v[172:175], v[88:91], 0
v_cvt_pk_bf16_f32 v54, v196, v197
v_cvt_pk_bf16_f32 v55, v198, v199
ds_write_b128 v24, v[52:55] offset:8192
v_pk_fma_f32 v[200:201], v[200:201], v[148:149], v[148:149] op_sel:[0,0,1] op_sel_hi:[1,0,1]
v_pk_fma_f32 v[202:203], v[202:203], v[148:149], v[148:149] op_sel:[0,0,1] op_sel_hi:[1,0,1]
v_pk_fma_f32 v[204:205], v[204:205], v[148:149], v[148:149] op_sel:[0,0,1] op_sel_hi:[1,0,1]
v_pk_fma_f32 v[206:207], v[206:207], v[148:149], v[148:149] op_sel:[0,0,1] op_sel_hi:[1,0,1]
s_waitcnt vmcnt(15)
v_dot2c_f32_bf16 v150, s70, v92
v_dot2c_f32_bf16 v152, v92, v92
v_dot2c_f32_bf16 v151, s70, v93
v_dot2c_f32_bf16 v153, v93, v93
v_dot2c_f32_bf16 v150, s70, v94
v_dot2c_f32_bf16 v152, v94, v94
v_dot2c_f32_bf16 v151, s70, v95
v_dot2c_f32_bf16 v153, v95, v95
v_mfma_f32_16x16x32_bf16 v[184:187], v[174:177], v[92:95], 0
v_cvt_pk_bf16_f32 v56, v200, v201
v_cvt_pk_bf16_f32 v57, v202, v203
v_mfma_f32_16x16x32_bf16 v[188:191], v[172:175], v[92:95], 0
v_cvt_pk_bf16_f32 v58, v204, v205
v_cvt_pk_bf16_f32 v59, v206, v207
ds_write_b128 v24, v[56:59] offset:16384
v_pk_fma_f32 v[208:209], v[208:209], v[148:149], v[148:149] op_sel:[0,0,1] op_sel_hi:[1,0,1]
v_pk_fma_f32 v[210:211], v[210:211], v[148:149], v[148:149] op_sel:[0,0,1] op_sel_hi:[1,0,1]
v_pk_fma_f32 v[212:213], v[212:213], v[148:149], v[148:149] op_sel:[0,0,1] op_sel_hi:[1,0,1]
v_pk_fma_f32 v[214:215], v[214:215], v[148:149], v[148:149] op_sel:[0,0,1] op_sel_hi:[1,0,1]
s_waitcnt vmcnt(14)
v_dot2c_f32_bf16 v150, s70, v96
v_dot2c_f32_bf16 v152, v96, v96
v_dot2c_f32_bf16 v151, s70, v97
v_dot2c_f32_bf16 v153, v97, v97
v_dot2c_f32_bf16 v150, s70, v98
v_dot2c_f32_bf16 v152, v98, v98
v_dot2c_f32_bf16 v151, s70, v99
v_dot2c_f32_bf16 v153, v99, v99
v_mfma_f32_16x16x32_bf16 v[192:195], v[174:177], v[96:99], 0
v_cvt_pk_bf16_f32 v60, v208, v209
v_cvt_pk_bf16_f32 v61, v210, v211
v_mfma_f32_16x16x32_bf16 v[196:199], v[172:175], v[96:99], 0
v_cvt_pk_bf16_f32 v62, v212, v213
v_cvt_pk_bf16_f32 v63, v214, v215
ds_write_b128 v24, v[60:63] offset:24576
v_pk_fma_f32 v[216:217], v[216:217], v[148:149], v[148:149] op_sel:[0,0,1] op_sel_hi:[1,0,1]
v_pk_fma_f32 v[218:219], v[218:219], v[148:149], v[148:149] op_sel:[0,0,1] op_sel_hi:[1,0,1]
v_pk_fma_f32 v[220:221], v[220:221], v[148:149], v[148:149] op_sel:[0,0,1] op_sel_hi:[1,0,1]
v_pk_fma_f32 v[222:223], v[222:223], v[148:149], v[148:149] op_sel:[0,0,1] op_sel_hi:[1,0,1]
s_waitcnt vmcnt(13)
v_dot2c_f32_bf16 v150, s70, v100
v_dot2c_f32_bf16 v152, v100, v100
v_dot2c_f32_bf16 v151, s70, v101
v_dot2c_f32_bf16 v153, v101, v101
v_dot2c_f32_bf16 v150, s70, v102
v_dot2c_f32_bf16 v152, v102, v102
v_dot2c_f32_bf16 v151, s70, v103
v_dot2c_f32_bf16 v153, v103, v103
v_mfma_f32_16x16x32_bf16 v[200:203], v[174:177], v[100:103], 0
v_cvt_pk_bf16_f32 v64, v216, v217
v_cvt_pk_bf16_f32 v65, v218, v219
v_mfma_f32_16x16x32_bf16 v[204:207], v[172:175], v[100:103], 0
v_cvt_pk_bf16_f32 v66, v220, v221
v_cvt_pk_bf16_f32 v67, v222, v223
ds_write_b128 v27, v[64:67] offset:0
s_load_dword s54, s[36:37], s66
s_load_dword s56, s[52:53], s7
v_pk_fma_f32 v[224:225], v[224:225], v[148:149], v[148:149] op_sel:[0,0,1] op_sel_hi:[1,0,1]
v_pk_fma_f32 v[226:227], v[226:227], v[148:149], v[148:149] op_sel:[0,0,1] op_sel_hi:[1,0,1]
v_pk_fma_f32 v[228:229], v[228:229], v[148:149], v[148:149] op_sel:[0,0,1] op_sel_hi:[1,0,1]
v_pk_fma_f32 v[230:231], v[230:231], v[148:149], v[148:149] op_sel:[0,0,1] op_sel_hi:[1,0,1]
s_waitcnt vmcnt(12)
v_dot2c_f32_bf16 v150, s70, v104
v_dot2c_f32_bf16 v152, v104, v104
v_dot2c_f32_bf16 v151, s70, v105
v_dot2c_f32_bf16 v153, v105, v105
v_dot2c_f32_bf16 v150, s70, v106
s_branch SK1
.p2align 12
PAD1:
s_branch PAD5
SK1:
v_dot2c_f32_bf16 v152, v106, v106
v_dot2c_f32_bf16 v151, s70, v107
v_dot2c_f32_bf16 v153, v107, v107
v_mfma_f32_16x16x32_bf16 v[208:211], v[174:177], v[104:107], 0
v_cvt_pk_bf16_f32 v68, v224, v225
v_cvt_pk_bf16_f32 v69, v226, v227
v_mfma_f32_16x16x32_bf16 v[212:215], v[172:175], v[104:107], 0
v_cvt_pk_bf16_f32 v70, v228, v229
v_cvt_pk_bf16_f32 v71, v230, v231
ds_write_b128 v27, v[68:71] offset:8192
v_pk_fma_f32 v[232:233], v[232:233], v[148:149], v[148:149] op_sel:[0,0,1] op_sel_hi:[1,0,1]
v_pk_fma_f32 v[234:235], v[234:235], v[148:149], v[148:149] op_sel:[0,0,1] op_sel_hi:[1,0,1]
v_pk_fma_f32 v[236:237], v[236:237], v[148:149], v[148:149] op_sel:[0,0,1] op_sel_hi:[1,0,1]
v_pk_fma_f32 v[238:239], v[238:239], v[148:149], v[148:149] op_sel:[0,0,1] op_sel_hi:[1,0,1]
s_waitcnt vmcnt(11)
v_dot2c_f32_bf16 v150, s70, v108
v_dot2c_f32_bf16 v152, v108, v108
v_dot2c_f32_bf16 v151, s70, v109
v_dot2c_f32_bf16 v153, v109, v109
v_dot2c_f32_bf16 v150, s70, v110
v_dot2c_f32_bf16 v152, v110, v110
v_dot2c_f32_bf16 v151, s70, v111
v_dot2c_f32_bf16 v153, v111, v111
v_mfma_f32_16x16x32_bf16 v[216:219], v[174:177], v[108:111], 0
v_cvt_pk_bf16_f32 v72, v232, v233
v_cvt_pk_bf16_f32 v73, v234, v235
v_mfma_f32_16x16x32_bf16 v[220:223], v[172:175], v[108:111], 0
v_cvt_pk_bf16_f32 v74, v236, v237
v_cvt_pk_bf16_f32 v75, v238, v239
ds_write_b128 v27, v[72:75] offset:16384
v_pk_fma_f32 v[240:241], v[240:241], v[148:149], v[148:149] op_sel:[0,0,1] op_sel_hi:[1,0,1]
v_pk_fma_f32 v[242:243], v[242:243], v[148:149], v[148:149] op_sel:[0,0,1] op_sel_hi:[1,0,1]
v_pk_fma_f32 v[244:245], v[244:245], v[148:149], v[148:149] op_sel:[0,0,1] op_sel_hi:[1,0,1]
v_pk_fma_f32 v[246:247], v[246:247], v[148:149], v[148:149] op_sel:[0,0,1] op_sel_hi:[1,0,1]
s_waitcnt vmcnt(10)
v_dot2c_f32_bf16 v150, s70, v112
v_dot2c_f32_bf16 v152, v112, v112
v_dot2c_f32_bf16 v151, s70, v113
v_dot2c_f32_bf16 v153, v113, v113
v_dot2c_f32_bf16 v150, s70, v114
v_dot2c_f32_bf16 v152, v114, v114
v_dot2c_f32_bf16 v151, s70, v115
v_dot2c_f32_bf16 v153, v115, v115
v_mfma_f32_16x16x32_bf16 v[224:227], v[174:177], v[112:115], 0
v_cvt_pk_bf16_f32 v76, v240, v241
v_cvt_pk_bf16_f32 v77, v242, v243
v_mfma_f32_16x16x32_bf16 v[228:231], v[172:175], v[112:115], 0
v_cvt_pk_bf16_f32 v78, v244, v245
v_cvt_pk_bf16_f32 v79, v246, v247
ds_write_b128 v27, v[76:79] offset:24576
v_pk_fma_f32 v[248:249], v[248:249], v[148:149], v[148:149] op_sel:[0,0,1] op_sel_hi:[1,0,1]
v_pk_fma_f32 v[250:251], v[250:251], v[148:149], v[148:149] op_sel:[0,0,1] op_sel_hi:[1,0,1]
v_pk_fma_f32 v[252:253], v[252:253], v[148:149], v[148:149] op_sel:[0,0,1] op_sel_hi:[1,0,1]
v_pk_fma_f32 v[254:255], v[254:255], v[148:149], v[148:149] op_sel:[0,0,1] op_sel_hi:[1,0,1]
s_waitcnt vmcnt(9)
v_dot2c_f32_bf16 v150, s70, v116
v_dot2c_f32_bf16 v152, v116, v116
v_dot2c_f32_bf16 v151, s70, v117
v_dot2c_f32_bf16 v153, v117, v117
v_dot2c_f32_bf16 v150, s70, v118
v_dot2c_f32_bf16 v152, v118, v118
v_dot2c_f32_bf16 v151, s70, v119
v_dot2c_f32_bf16 v153, v119, v119
v_mfma_f32_16x16x32_bf16 v[232:235], v[174:177], v[116:119], 0
v_cvt_pk_bf16_f32 v80, v248, v249
v_cvt_pk_bf16_f32 v81, v250, v251
v_mfma_f32_16x16x32_bf16 v[236:239], v[172:175], v[116:119], 0
v_cvt_pk_bf16_f32 v82, v252, v253
v_cvt_pk_bf16_f32 v83, v254, v255
ds_write_b128 v27, v[80:83] offset:32768
s_nop 0
s_nop 0
v_add_f32 v150, v150, v151
v_add_f32 v152, v152, v153
s_nop 0
v_add_f32_dpp v150, v150, v150 quad_perm:[1,0,3,2] row_mask:0xf bank_mask:0xf
v_add_f32_dpp v152, v152, v152 quad_perm:[1,0,3,2] row_mask:0xf bank_mask:0xf
s_nop 0
v_add_f32_dpp v150, v150, v150 quad_perm:[2,3,0,1] row_mask:0xf bank_mask:0xf
v_add_f32_dpp v152, v152, v152 quad_perm:[2,3,0,1] row_mask:0xf bank_mask:0xf
s_nop 0
v_add_f32_dpp v150, v150, v150 row_half_mirror row_mask:0xf bank_mask:0xf
v_add_f32_dpp v152, v152, v152 row_half_mirror row_mask:0xf bank_mask:0xf
v_mul_f32 v150, 0x3ae38e39, v150
v_mul_f32 v152, 0x3ae38e39, v152
v_fma_f32 v152, -v150, v150, v152
v_max_f32 v152, 0, v152
v_cvt_pk_bf16_f32 v151, v150, v152
v_and_b32 v152, s64, v151
v_lshlrev_b32 v150, 16, v151
v_add_f32 v152, 0x3727c5ac, v152
v_cvt_pk_bf16_f32 v152, v152, v152
v_and_b32 v152, s64, v152
v_sqrt_f32 v152, v152
s_nop 0
v_cvt_pk_bf16_f32 v152, v152, v152
v_and_b32 v152, s64, v152
v_mul_f32 v151, s65, v152
v_rcp_f32 v152, v152
s_nop 0
v_mul_f32 v154, s63, v152
v_mul_f32 v155, -v150, v154
ds_write_b64 v36, v[150:151]
v_pk_fma_f32 v[128:129], v[128:129], v[154:155], v[154:155] op_sel:[0,0,1] op_sel_hi:[1,0,1]
v_pk_fma_f32 v[130:131], v[130:131], v[154:155], v[154:155] op_sel:[0,0,1] op_sel_hi:[1,0,1]
v_pk_fma_f32 v[132:133], v[132:133], v[154:155], v[154:155] op_sel:[0,0,1] op_sel_hi:[1,0,1]
v_pk_fma_f32 v[134:135], v[134:135], v[154:155], v[154:155] op_sel:[0,0,1] op_sel_hi:[1,0,1]
v_cvt_pk_bf16_f32 v84, v128, v129
v_cvt_pk_bf16_f32 v85, v130, v131
v_cvt_pk_bf16_f32 v86, v132, v133
v_cvt_pk_bf16_f32 v87, v134, v135
ds_write_b128 v30, v[84:87] offset:0
s_add_u32 m0, s6, 73728
s_add_u32 s57, s58, 0
buffer_load_dwordx4 v0, s[20:23], s57 offen offset:0 lds
buffer_load_dwordx4 v1, s[20:23], s57 offen offset:1024 lds
buffer_load_dwordx4 v2, s[20:23], s57 offen offset:2048 lds
buffer_load_dwordx4 v3, s[20:23], s57 offen offset:3072 lds
v_pk_fma_f32 v[136:137], v[136:137], v[154:155], v[154:155] op_sel:[0,0,1] op_sel_hi:[1,0,1]
v_pk_fma_f32 v[138:139], v[138:139], v[154:155], v[154:155] op_sel:[0,0,1] op_sel_hi:[1,0,1]
v_pk_fma_f32 v[140:141], v[140:141], v[154:155], v[154:155] op_sel:[0,0,1] op_sel_hi:[1,0,1]
v_pk_fma_f32 v[142:143], v[142:143], v[154:155], v[154:155] op_sel:[0,0,1] op_sel_hi:[1,0,1]
v_cvt_pk_bf16_f32 v88, v136, v137
v_cvt_pk_bf16_f32 v89, v138, v139
v_cvt_pk_bf16_f32 v90, v140, v141
v_cvt_pk_bf16_f32 v91, v142, v143
ds_write_b128 v30, v[88:91] offset:8192
v_pk_fma_f32 v[184:185], v[184:185], v[154:155], v[154:155] op_sel:[0,0,1] op_sel_hi:[1,0,1]
v_pk_fma_f32 v[186:187], v[186:187], v[154:155], v[154:155] op_sel:[0,0,1] op_sel_hi:[1,0,1]
v_pk_fma_f32 v[188:189], v[188:189], v[154:155], v[154:155] op_sel:[0,0,1] op_sel_hi:[1,0,1]
v_pk_fma_f32 v[190:191], v[190:191], v[154:155], v[154:155] op_sel:[0,0,1] op_sel_hi:[1,0,1]
v_cvt_pk_bf16_f32 v92, v184, v185
v_cvt_pk_bf16_f32 v93, v186, v187
v_cvt_pk_bf16_f32 v94, v188, v189
v_cvt_pk_bf16_f32 v95, v190, v191
ds_write_b128 v30, v[92:95] offset:16384
v_pk_fma_f32 v[192:193], v[192:193], v[154:155], v[154:155] op_sel:[0,0,1] op_sel_hi:[1,0,1]
v_pk_fma_f32 v[194:195], v[194:195], v[154:155], v[154:155] op_sel:[0,0,1] op_sel_hi:[1,0,1]
v_pk_fma_f32 v[196:197], v[196:197], v[154:155], v[154:155] op_sel:[0,0,1] op_sel_hi:[1,0,1]
v_pk_fma_f32 v[198:199], v[198:199], v[154:155], v[154:155] op_sel:[0,0,1] op_sel_hi:[1,0,1]
v_cvt_pk_bf16_f32 v96, v192, v193
v_cvt_pk_bf16_f32 v97, v194, v195
v_cvt_pk_bf16_f32 v98, v196, v197
v_cvt_pk_bf16_f32 v99, v198, v199
ds_write_b128 v30, v[96:99] offset:24576
v_pk_fma_f32 v[200:201], v[200:201], v[154:155], v[154:155] op_sel:[0,0,1] op_sel_hi:[1,0,1]
v_pk_fma_f32 v[202:203], v[202:203], v[154:155], v[154:155] op_sel:[0,0,1] op_sel_hi:[1,0,1]
v_pk_fma_f32 v[204:205], v[204:205], v[154:155], v[154:155] op_sel:[0,0,1] op_sel_hi:[1,0,1]
v_pk_fma_f32 v[206:207], v[206:207], v[154:155], v[154:155] op_sel:[0,0,1] op_sel_hi:[1,0,1]
v_cvt_pk_bf16_f32 v100, v200, v201
v_cvt_pk_bf16_f32 v101, v202, v203
v_cvt_pk_bf16_f32 v102, v204, v205
v_cvt_pk_bf16_f32 v103, v206, v207
ds_write_b128 v31, v[100:103] offset:0
v_pk_fma_f32 v[208:209], v[208:209], v[154:155], v[154:155] op_sel:[0,0,1] op_sel_hi:[1,0,1]
v_pk_fma_f32 v[210:211], v[210:211], v[154:155], v[154:155] op_sel:[0,0,1] op_sel_hi:[1,0,1]
v_pk_fma_f32 v[212:213], v[212:213], v[154:155], v[154:155] op_sel:[0,0,1] op_sel_hi:[1,0,1]
v_pk_fma_f32 v[214:215], v[214:215], v[154:155], v[154:155] op_sel:[0,0,1] op_sel_hi:[1,0,1]
v_cvt_pk_bf16_f32 v104, v208, v209
v_cvt_pk_bf16_f32 v105, v210, v211
v_cvt_pk_bf16_f32 v106, v212, v213
v_cvt_pk_bf16_f32 v107, v214, v215
ds_write_b128 v31, v[104:107] offset:8192
s_add_u32 m0, s6, 90112
s_add_u32 s57, s58, 1179648
buffer_load_dwordx4 v0, s[20:23], s57 offen offset:0 lds
buffer_load_dwordx4 v1, s[20:23], s57 offen offset:1024 lds
buffer_load_dwordx4 v2, s[20:23], s57 offen offset:2048 lds
buffer_load_dwordx4 v3, s[20:23], s57 offen offset:3072 lds
v_pk_fma_f32 v[216:217], v[216:217], v[154:155], v[154:155] op_sel:[0,0,1] op_sel_hi:[1,0,1]
v_pk_fma_f32 v[218:219], v[218:219], v[154:155], v[154:155] op_sel:[0,0,1] op_sel_hi:[1,0,1]
v_pk_fma_f32 v[220:221], v[220:221], v[154:155], v[154:155] op_sel:[0,0,1] op_sel_hi:[1,0,1]
v_pk_fma_f32 v[222:223], v[222:223], v[154:155], v[154:155] op_sel:[0,0,1] op_sel_hi:[1,0,1]
v_cvt_pk_bf16_f32 v108, v216, v217
v_cvt_pk_bf16_f32 v109, v218, v219
v_cvt_pk_bf16_f32 v110, v220, v221
v_cvt_pk_bf16_f32 v111, v222, v223
ds_write_b128 v31, v[108:111] offset:16384
v_pk_fma_f32 v[224:225], v[224:225], v[154:155], v[154:155] op_sel:[0,0,1] op_sel_hi:[1,0,1]
v_pk_fma_f32 v[226:227], v[226:227], v[154:155], v[154:155] op_sel:[0,0,1] op_sel_hi:[1,0,1]
v_pk_fma_f32 v[228:229], v[228:229], v[154:155], v[154:155] op_sel:[0,0,1] op_sel_hi:[1,0,1]
v_pk_fma_f32 v[230:231], v[230:231], v[154:155], v[154:155] op_sel:[0,0,1] op_sel_hi:[1,0,1]
v_cvt_pk_bf16_f32 v112, v224, v225
v_cvt_pk_bf16_f32 v113, v226, v227
v_cvt_pk_bf16_f32 v114, v228, v229
v_cvt_pk_bf16_f32 v115, v230, v231
ds_write_b128 v31, v[112:115] offset:24576
v_pk_fma_f32 v[232:233], v[232:233], v[154:155], v[154:155] op_sel:[0,0,1] op_sel_hi:[1,0,1]
v_pk_fma_f32 v[234:235], v[234:235], v[154:155], v[154:155] op_sel:[0,0,1] op_sel_hi:[1,0,1]
v_pk_fma_f32 v[236:237], v[236:237], v[154:155], v[154:155] op_sel:[0,0,1] op_sel_hi:[1,0,1]
v_pk_fma_f32 v[238:239], v[238:239], v[154:155], v[154:155] op_sel:[0,0,1] op_sel_hi:[1,0,1]
v_cvt_pk_bf16_f32 v116, v232, v233
v_cvt_pk_bf16_f32 v117, v234, v235
v_cvt_pk_bf16_f32 v118, v236, v237
v_cvt_pk_bf16_f32 v119, v238, v239
ds_write_b128 v31, v[116:119] offset:32768
s_waitcnt vmcnt(16)
v_lshlrev_b32 v20, 16, v32
v_and_b32 v21, s64, v32
v_lshlrev_b32 v22, 16, v33
v_and_b32 v23, s64, v33
v_mul_f32 v20, s63, v20
v_mul_f32 v21, s63, v21
v_mul_f32 v22, s63, v22
v_mul_f32 v23, s63, v23
ds_write_b128 v26, v[20:23]
s_add_u32 m0, s6, 106496
s_add_u32 s57, s58, 2359296
buffer_load_dwordx4 v0, s[20:23], s57 offen offset:0 lds
buffer_load_dwordx4 v1, s[20:23], s57 offen offset:1024 lds
buffer_load_dwordx4 v2, s[20:23], s57 offen offset:2048 lds
buffer_load_dwordx4 v3, s[20:23], s57 offen offset:3072 lds
s_waitcnt vmcnt(8) lgkmcnt(0)
s_barrier
ds_read_b64_tr_b16 v[192:193], v13 offset:8192
ds_read_b64_tr_b16 v[194:195], v13 offset:10240
ds_read_b64_tr_b16 v[196:197], v13 offset:12288
ds_read_b64_tr_b16 v[198:199], v13 offset:14336
ds_read_b64_tr_b16 v[200:201], v13 offset:16384
ds_read_b64_tr_b16 v[202:203], v13 offset:18432
ds_read_b64_tr_b16 v[204:205], v13 offset:20480
ds_read_b64_tr_b16 v[206:207], v13 offset:22528
ds_read_b128 a[0:3], v4 offset:0
ds_read_b128 a[4:7], v4 offset:1024
ds_read_b128 a[8:11], v4 offset:2048
s_add_u32 m0, s6, 122880
s_add_u32 s57, s58, 3538944
buffer_load_dwordx4 v0, s[20:23], s57 offen offset:0 lds
ds_read_b128 a[12:15], v4 offset:3072
ds_read_b128 v[24:27], v7
ds_read_b128 a[16:19], v4 offset:4096
buffer_load_dwordx4 v1, s[20:23], s57 offen offset:1024 lds
ds_read_b128 a[20:23], v4 offset:5120
ds_read_b128 a[24:27], v4 offset:6144
ds_read_b128 a[28:31], v4 offset:7168
buffer_load_dwordx4 v2, s[20:23], s57 offen offset:2048 lds
ds_read_b128 a[32:35], v4 offset:8192
ds_read_b128 a[36:39], v4 offset:9216
ds_read_b128 a[40:43], v4 offset:10240
buffer_load_dwordx4 v3, s[20:23], s57 offen offset:3072 lds
ds_read_b128 a[44:47], v4 offset:11264
ds_read_b128 a[48:51], v4 offset:12288
ds_read_b128 a[52:55], v4 offset:13312
ds_read_b128 a[56:59], v4 offset:14336
ds_read_b128 a[60:63], v4 offset:15360
ds_read_b64 v[184:185], v124 offset:0
ds_read_b64 v[186:187], v124 offset:1024
ds_read_b64 v[188:189], v124 offset:2048
ds_read_b64 v[190:191], v124 offset:3072
ds_read_b32 v181, v181
ds_read_b64 v[32:33], v125 offset:0
ds_read_b64 v[34:35], v125 offset:128
ds_read_b64 v[36:37], v125 offset:256
ds_read_b64 v[38:39], v125 offset:384
ds_read_b64 v[40:41], v126
s_waitcnt vmcnt(8) lgkmcnt(6)
s_barrier
v_mfma_f32_16x16x32_bf16 v[48:51], v[192:195], a[0:3], v[24:27]
s_add_u32 m0, s6, 0
s_add_u32 s57, s59, 4718592
ds_read_b64_tr_b16 v[208:209], v13 offset:24576
ds_read_b128 a[64:67], v4 offset:16384
v_mfma_f32_16x16x32_bf16 v[48:51], v[196:199], a[16:19], v[48:51]
buffer_load_dwordx4 v0, s[20:23], s57 offen offset:0 lds
ds_read_b128 a[68:71], v4 offset:17408
v_mfma_f32_16x16x32_bf16 v[48:51], v[200:203], a[32:35], v[48:51]
ds_read_b64_tr_b16 v[210:211], v13 offset:26624
ds_read_b128 a[72:75], v4 offset:18432
v_mfma_f32_16x16x32_bf16 v[48:51], v[204:207], a[48:51], v[48:51]
ds_read_b64_tr_b16 v[212:213], v13 offset:28672
ds_read_b128 a[76:79], v4 offset:19456
v_mfma_f32_16x16x32_bf16 v[52:55], v[192:195], a[4:7], v[24:27]
buffer_load_dwordx4 v1, s[20:23], s57 offen offset:1024 lds
ds_read_b128 a[80:83], v4 offset:20480
v_mfma_f32_16x16x32_bf16 v[52:55], v[196:199], a[20:23], v[52:55]
ds_read_b64_tr_b16 v[214:215], v13 offset:30720
ds_read_b128 a[84:87], v4 offset:21504
v_mfma_f32_16x16x32_bf16 v[52:55], v[200:203], a[36:39], v[52:55]
buffer_load_dwordx4 v2, s[20:23], s57 offen offset:2048 lds
ds_read_b128 a[88:91], v4 offset:22528
v_mfma_f32_16x16x32_bf16 v[52:55], v[204:207], a[52:55], v[52:55]
ds_read_b64_tr_b16 v[216:217], v13 offset:32768
ds_read_b128 a[92:95], v4 offset:23552
v_mfma_f32_16x16x32_bf16 v[56:59], v[192:195], a[8:11], v[24:27]
ds_read_b64_tr_b16 v[218:219], v13 offset:34816
ds_read_b128 a[96:99], v4 offset:24576
s_lshr_b32 s70, s3, 1
s_and_b32 s71, s3, 1
v_mfma_f32_16x16x32_bf16 v[56:59], v[196:199], a[24:27], v[56:59]
buffer_load_dwordx4 v3, s[20:23], s57 offen offset:3072 lds
ds_read_b128 a[100:103], v4 offset:25600
s_lshl_b32 s71, s71, 11
v_mfma_f32_16x16x32_bf16 v[56:59], v[200:203], a[40:43], v[56:59]
s_add_u32 m0, s6, 139264
ds_read_b64_tr_b16 v[220:221], v13 offset:36864
ds_read_b64_tr_b16 v[222:223], v13 offset:38912
s_mul_i32 s40, s70, 4160
v_mfma_f32_16x16x32_bf16 v[56:59], v[204:207], a[56:59], v[56:59]
s_add_u32 s57, s81, 589952
ds_read_b128 a[104:107], v4 offset:26624
ds_read_b128 a[108:111], v4 offset:27648
v_mfma_f32_16x16x32_bf16 v[60:63], v[192:195], a[12:15], v[24:27]
buffer_load_dwordx4 v0, s[20:23], s57 offen offset:0 lds
ds_read_b128 a[112:115], v4 offset:28672
s_add_u32 s40, s40, s71
s_add_u32 s40, s40, 32
v_mfma_f32_16x16x32_bf16 v[60:63], v[196:199], a[28:31], v[60:63]
ds_read_b128 a[116:119], v4 offset:29696
ds_read_b128 a[120:123], v4 offset:30720
ds_read_b128 a[124:127], v4 offset:31744
v_mfma_f32_16x16x32_bf16 v[60:63], v[200:203], a[44:47], v[60:63]
buffer_load_dwordx4 v1, s[20:23], s57 offen offset:1024 lds
s_lshl_b32 s41, s70, 1
s_add_u32 s41, s41, s71
s_add_u32 s41, s41, 2
v_mfma_f32_16x16x32_bf16 v[60:63], v[204:207], a[60:63], v[60:63]
s_lshl_b32 s70, s4, 2
s_add_u32 s70, s70, s3
s_mul_i32 s70, s70, 9
s_waitcnt vmcnt(10) lgkmcnt(0)
s_barrier
v_mfma_f32_16x16x32_bf16 v[48:51], v[208:211], a[64:67], v[48:51]
ds_read_b64_tr_b16 v[192:193], v13 offset:40960
ds_read_b128 a[128:131], v4 offset:32768
s_lshr_b32 s70, s70, 1
s_min_u32 s70, s70, 571
v_mfma_f32_16x16x32_bf16 v[48:51], v[212:215], a[80:83], v[48:51]
buffer_load_dwordx4 v2, s[20:23], s57 offen offset:2048 lds
ds_read_b128 a[132:135], v4 offset:33792
s_mul_i32 s70, s70, 1152
v_mfma_f32_16x16x32_bf16 v[48:51], v[216:219], a[96:99], v[48:51]
ds_read_b64_tr_b16 v[194:195], v13 offset:43008
ds_read_b128 a[136:139], v4 offset:34816
s_mul_i32 s42, s5, 663552
s_add_u32 s42, s42, s70
v_mfma_f32_16x16x32_bf16 v[48:51], v[220:223], a[112:115], v[48:51]
ds_read_b64_tr_b16 v[196:197], v13 offset:45056
ds_read_b128 a[140:143], v4 offset:35840
v_mfma_f32_16x16x32_bf16 v[52:55], v[208:211], a[68:71], v[52:55]
buffer_load_dwordx4 v3, s[20:23], s57 offen offset:3072 lds
s_add_u32 m0, s6, 16384
ds_read_b128 a[144:147], v4 offset:36864
v_mfma_f32_16x16x32_bf16 v[52:55], v[212:215], a[84:87], v[52:55]
s_add_u32 s57, s81, 1769600
ds_read_b64_tr_b16 v[198:199], v13 offset:47104
ds_read_b128 a[148:151], v4 offset:37888
v_mfma_f32_16x16x32_bf16 v[52:55], v[216:219], a[100:103], v[52:55]
buffer_load_dwordx4 v0, s[20:23], s57 offen offset:0 lds
ds_read_b128 a[152:155], v4 offset:38912
v_mfma_f32_16x16x32_bf16 v[52:55], v[220:223], a[116:119], v[52:55]
ds_read_b64_tr_b16 v[200:201], v13 offset:49152
ds_read_b128 a[156:159], v4 offset:39936
v_mfma_f32_16x16x32_bf16 v[56:59], v[208:211], a[72:75], v[56:59]
ds_read_b64_tr_b16 v[202:203], v13 offset:51200
ds_read_b128 a[160:163], v4 offset:40960
v_mfma_f32_16x16x32_bf16 v[56:59], v[212:215], a[88:91], v[56:59]
buffer_load_dwordx4 v1, s[20:23], s57 offen offset:1024 lds
ds_read_b128 a[164:167], v4 offset:41984
v_mfma_f32_16x16x32_bf16 v[56:59], v[216:219], a[104:107], v[56:59]
ds_read_b64_tr_b16 v[204:205], v13 offset:53248
ds_read_b64_tr_b16 v[206:207], v13 offset:55296
v_mfma_f32_16x16x32_bf16 v[56:59], v[220:223], a[120:123], v[56:59]
ds_read_b128 a[168:171], v4 offset:43008
ds_read_b128 a[172:175], v4 offset:44032
v_mfma_f32_16x16x32_bf16 v[60:63], v[208:211], a[76:79], v[60:63]
buffer_load_dwordx4 v2, s[20:23], s57 offen offset:2048 lds
ds_read_b128 a[176:179], v4 offset:45056
v_mfma_f32_16x16x32_bf16 v[60:63], v[212:215], a[92:95], v[60:63]
ds_read_b128 a[180:183], v4 offset:46080
ds_read_b128 a[184:187], v4 offset:47104
ds_read_b128 a[188:191], v4 offset:48128
v_mfma_f32_16x16x32_bf16 v[60:63], v[216:219], a[108:111], v[60:63]
buffer_load_dwordx4 v3, s[20:23], s57 offen offset:3072 lds
v_mfma_f32_16x16x32_bf16 v[60:63], v[220:223], a[124:127], v[60:63]
s_add_u32 m0, s6, 32768
s_waitcnt vmcnt(12) lgkmcnt(0)
s_barrier
v_mfma_f32_16x16x32_bf16 v[48:51], v[192:195], a[128:131], v[48:51]
s_add_u32 s57, s81, 2949248
ds_read_b64_tr_b16 v[208:209], v13 offset:57344
ds_read_b128 a[192:195], v4 offset:49152
v_mfma_f32_16x16x32_bf16 v[48:51], v[196:199], a[144:147], v[48:51]
buffer_load_dwordx4 v0, s[20:23], s57 offen offset:0 lds
ds_read_b128 a[196:199], v4 offset:50176
v_mfma_f32_16x16x32_bf16 v[48:51], v[200:203], a[160:163], v[48:51]
ds_read_b64_tr_b16 v[210:211], v13 offset:59392
ds_read_b128 a[200:203], v4 offset:51200
v_mfma_f32_16x16x32_bf16 v[48:51], v[204:207], a[176:179], v[48:51]
ds_read_b64_tr_b16 v[212:213], v13 offset:61440
ds_read_b128 a[204:207], v4 offset:52224
v_mfma_f32_16x16x32_bf16 v[52:55], v[192:195], a[132:135], v[52:55]
buffer_load_dwordx4 v1, s[20:23], s57 offen offset:1024 lds
ds_read_b128 a[208:211], v4 offset:53248
v_mfma_f32_16x16x32_bf16 v[52:55], v[196:199], a[148:151], v[52:55]
ds_read_b64_tr_b16 v[214:215], v13 offset:63488
ds_read_b128 a[212:215], v4 offset:54272
v_mfma_f32_16x16x32_bf16 v[52:55], v[200:203], a[164:167], v[52:55]
buffer_load_dwordx4 v2, s[20:23], s57 offen offset:2048 lds
ds_read_b128 a[216:219], v4 offset:55296
v_mfma_f32_16x16x32_bf16 v[52:55], v[204:207], a[180:183], v[52:55]
ds_read_b64_tr_b16 v[216:217], v14 offset:0
ds_read_b128 a[220:223], v4 offset:56320
v_mfma_f32_16x16x32_bf16 v[56:59], v[192:195], a[136:139], v[56:59]
ds_read_b64_tr_b16 v[218:219], v14 offset:2048
ds_read_b128 a[224:227], v4 offset:57344
v_mfma_f32_16x16x32_bf16 v[56:59], v[196:199], a[152:155], v[56:59]
buffer_load_dwordx4 v3, s[20:23], s57 offen offset:3072 lds
ds_read_b128 a[228:231], v4 offset:58368
v_mfma_f32_16x16x32_bf16 v[56:59], v[200:203], a[168:171], v[56:59]
s_add_u32 m0, s6, 73728
ds_read_b64_tr_b16 v[220:221], v14 offset:4096
ds_read_b64_tr_b16 v[222:223], v14 offset:6144
v_mfma_f32_16x16x32_bf16 v[56:59], v[204:207], a[184:187], v[56:59]
s_add_u32 s57, s81, 4128896
ds_read_b128 a[232:235], v4 offset:59392
ds_read_b128 a[236:239], v4 offset:60416
v_mfma_f32_16x16x32_bf16 v[60:63], v[192:195], a[140:143], v[60:63]
buffer_load_dwordx4 v0, s[20:23], s57 offen offset:0 lds
ds_read_b128 a[240:243], v4 offset:61440
v_mfma_f32_16x16x32_bf16 v[60:63], v[196:199], a[156:159], v[60:63]
ds_read_b128 a[244:247], v4 offset:62464
ds_read_b128 a[248:251], v4 offset:63488
ds_read_b128 a[252:255], v4 offset:64512
v_mfma_f32_16x16x32_bf16 v[60:63], v[200:203], a[172:175], v[60:63]
buffer_load_dwordx4 v1, s[20:23], s57 offen offset:1024 lds
v_mfma_f32_16x16x32_bf16 v[60:63], v[204:207], a[188:191], v[60:63]
s_waitcnt vmcnt(14) lgkmcnt(0)
s_barrier
v_mfma_f32_16x16x32_bf16 v[48:51], v[208:211], a[192:195], v[48:51]
ds_read_b64_tr_b16 v[192:193], v12 offset:0
v_mfma_f32_16x16x32_bf16 v[48:51], v[212:215], a[208:211], v[48:51]
buffer_load_dwordx4 v2, s[20:23], s57 offen offset:2048 lds
v_mfma_f32_16x16x32_bf16 v[48:51], v[216:219], a[224:227], v[48:51]
ds_read_b64_tr_b16 v[194:195], v12 offset:2048
v_mfma_f32_16x16x32_bf16 v[48:51], v[220:223], a[240:243], v[48:51]
ds_read_b64_tr_b16 v[196:197], v12 offset:4096
ds_read_b128 v[224:227], v5 offset:0
v_mfma_f32_16x16x32_bf16 v[52:55], v[208:211], a[196:199], v[52:55]
buffer_load_dwordx4 v3, s[20:23], s57 offen offset:3072 lds
s_add_u32 m0, s6, 49152
v_mfma_f32_16x16x32_bf16 v[52:55], v[212:215], a[212:215], v[52:55]
s_add_u32 s57, s58, 256
ds_read_b64_tr_b16 v[198:199], v12 offset:6144
ds_read_b128 v[228:231], v5 offset:1024
v_mfma_f32_16x16x32_bf16 v[52:55], v[216:219], a[228:231], v[52:55]
buffer_load_dwordx4 v0, s[20:23], s57 offen offset:0 lds
v_mfma_f32_16x16x32_bf16 v[52:55], v[220:223], a[244:247], v[52:55]
ds_read_b64_tr_b16 v[200:201], v12 offset:8192
ds_read_b128 v[232:235], v5 offset:2048
v_mfma_f32_16x16x32_bf16 v[56:59], v[208:211], a[200:203], v[56:59]
ds_read_b64_tr_b16 v[202:203], v12 offset:10240
ds_read_b128 v[236:239], v5 offset:3072
v_mfma_f32_16x16x32_bf16 v[56:59], v[212:215], a[216:219], v[56:59]
buffer_load_dwordx4 v1, s[20:23], s57 offen offset:1024 lds
v_mfma_f32_16x16x32_bf16 v[56:59], v[216:219], a[232:235], v[56:59]
ds_read_b64_tr_b16 v[204:205], v12 offset:12288
ds_read_b64_tr_b16 v[206:207], v12 offset:14336
v_mfma_f32_16x16x32_bf16 v[56:59], v[220:223], a[248:251], v[56:59]
ds_read_b128 v[240:243], v5 offset:4096
ds_read_b128 v[244:247], v5 offset:5120
v_mfma_f32_16x16x32_bf16 v[60:63], v[208:211], a[204:207], v[60:63]
buffer_load_dwordx4 v2, s[20:23], s57 offen offset:2048 lds
ds_read_b128 v[28:31], v7 offset:256
v_mfma_f32_16x16x32_bf16 v[60:63], v[212:215], a[220:223], v[60:63]
ds_read_b128 v[248:251], v5 offset:6144
ds_read_b128 v[252:255], v5 offset:7168
v_mfma_f32_16x16x32_bf16 v[60:63], v[216:219], a[236:239], v[60:63]
buffer_load_dwordx4 v3, s[20:23], s57 offen offset:3072 lds
v_mfma_f32_16x16x32_bf16 v[60:63], v[220:223], a[252:255], v[60:63]
s_add_u32 m0, s6, 90112
s_waitcnt vmcnt(16) lgkmcnt(0)
s_barrier
v_mfma_f32_16x16x32_bf16 v[48:51], v[192:195], v[224:227], v[48:51]
s_add_u32 s57, s58, 1179904
ds_read_b64_tr_b16 v[208:209], v14 offset:8192
v_mfma_f32_16x16x32_bf16 v[48:51], v[196:199], v[240:243], v[48:51]
buffer_load_dwordx4 v0, s[20:23], s57 offen offset:0 lds
v_mfma_f32_16x16x32_bf16 v[52:55], v[192:195], v[228:231], v[52:55]
ds_read_b64_tr_b16 v[210:211], v14 offset:10240
v_mfma_f32_16x16x32_bf16 v[52:55], v[196:199], v[244:247], v[52:55]
ds_read_b64_tr_b16 v[212:213], v14 offset:12288
v_mfma_f32_16x16x32_bf16 v[56:59], v[192:195], v[232:235], v[56:59]
buffer_load_dwordx4 v1, s[20:23], s57 offen offset:1024 lds
v_mfma_f32_16x16x32_bf16 v[56:59], v[196:199], v[248:251], v[56:59]
ds_read_b64_tr_b16 v[214:215], v14 offset:14336
v_mfma_f32_16x16x32_bf16 v[60:63], v[192:195], v[236:239], v[60:63]
buffer_load_dwordx4 v2, s[20:23], s57 offen offset:2048 lds
v_mfma_f32_16x16x32_bf16 v[60:63], v[196:199], v[252:255], v[60:63]
ds_read_b64_tr_b16 v[216:217], v14 offset:16384
v_mfma_f32_16x16x32_bf16 v[64:67], v[200:203], a[0:3], v[28:31]
ds_read_b64_tr_b16 v[218:219], v14 offset:18432
v_mfma_f32_16x16x32_bf16 v[64:67], v[204:207], a[16:19], v[64:67]
buffer_load_dwordx4 v3, s[20:23], s57 offen offset:3072 lds
v_mfma_f32_16x16x32_bf16 v[68:71], v[200:203], a[4:7], v[28:31]
s_add_u32 m0, s6, 0
ds_read_b64_tr_b16 v[220:221], v14 offset:20480
ds_read_b64_tr_b16 v[222:223], v14 offset:22528
v_mfma_f32_16x16x32_bf16 v[68:71], v[204:207], a[20:23], v[68:71]
s_add_u32 s57, s58, 2359552
v_mfma_f32_16x16x32_bf16 v[72:75], v[200:203], a[8:11], v[28:31]
buffer_load_dwordx4 v0, s[20:23], s57 offen offset:0 lds
v_mfma_f32_16x16x32_bf16 v[72:75], v[204:207], a[24:27], v[72:75]
v_mfma_f32_16x16x32_bf16 v[76:79], v[200:203], a[12:15], v[28:31]
buffer_load_dwordx4 v1, s[20:23], s57 offen offset:1024 lds
v_mfma_f32_16x16x32_bf16 v[76:79], v[204:207], a[28:31], v[76:79]
s_mul_i32 s70, s3, 36864
s_add_u32 s85, s70, 1024
s_lshl_b32 s71, s5, 7
s_add_u32 s60, s70, s71
s_add_u32 s72, s60, 589824
s_sub_u32 s84, s60, 73728
s_xor_b32 s84, s84, 128
s_cmp_lt_u32 s3, 2
s_cselect_b32 s84, s72, s84
s_lshl_b32 s70, s4, 19
s_and_b32 s71, s4, 7
s_lshl_b32 s71, s71, 13
s_add_u32 s70, s70, s71
s_add_u32 s70, s70, 16777216
s_lshl_b32 s72, s5, 16
s_add_u32 s68, s70, s72
s_lshl_b32 s71, s3, 11
s_add_u32 s68, s68, s71
s_lshr_b32 s71, s5, 1
s_lshl_b32 s71, s71, 11
s_and_b32 s73, s5, 1
s_lshl_b32 s73, s73, 9
s_add_u32 s73, s73, s71
s_add_u32 s77, s70, s73
s_lshr_b32 s71, s3, 1
s_lshl_b32 s71, s71, 10
s_add_u32 s77, s77, s71
s_and_b32 s74, s3, 1
s_lshl_b32 s70, s74, 8
s_add_u32 s77, s77, s70
s_add_u32 s72, s72, 16777216
s_lshl_b32 s70, s3, 22
s_add_u32 s78, s73, s70
s_lshl_b32 s70, s4, 16
s_and_b32 s70, s70, 0x70000
s_add_u32 s78, s78, s70
s_lshr_b32 s70, s4, 3
s_mul_i32 s70, s70, 0x300
s_and_b32 s70, s70, 0x500
s_cmp_ge_u32 s4, 24
s_cselect_b32 s70, 0x500, s70
s_add_u32 s78, s78, s70
s_add_u32 s78, s78, 16777216
s_add_u32 s69, s72, s73
s_lshl_b32 s70, s74, 23
s_add_u32 s69, s69, s70
s_lshr_b32 s71, s71, 2
s_add_u32 s69, s69, s71
s_and_b32 s70, s4, 3
s_lshl_b32 s70, s70, 6
s_add_u32 s69, s69, s70
s_lshr_b32 s70, s4, 2
s_sub_u32 s71, 7, s70
s_cmp_lt_u32 s70, 4
s_cselect_b32 s70, s70, s71
s_cselect_b32 s71, 1024, 0
s_mul_i32 s70, s70, 532480
s_xor_b32 s70, s70, 0x6000
s_add_u32 s69, s69, s70
s_add_u32 s69, s69, s71
s_waitcnt vmcnt(18) lgkmcnt(0)
s_barrier
v_mfma_f32_16x16x32_bf16 v[64:67], v[208:211], a[32:35], v[64:67]
ds_read_b64_tr_b16 v[192:193], v12 offset:16384
v_mfma_f32_16x16x32_bf16 v[64:67], v[212:215], a[48:51], v[64:67]
buffer_load_dwordx4 v2, s[20:23], s57 offen offset:2048 lds
v_add_u32 v46, 0x9e3779b9, v46
v_and_b32 v20, 7, v15
v_mfma_f32_16x16x32_bf16 v[64:67], v[216:219], a[64:67], v[64:67]
ds_read_b64_tr_b16 v[194:195], v12 offset:18432
v_readfirstlane_b32 s7, v46
v_lshlrev_b32 v20, 1, v20
v_lshrrev_b32 v18, v20, v46
v_mfma_f32_16x16x32_bf16 v[64:67], v[220:223], a[80:83], v[64:67]
s_branch SK2
.p2align 12
PAD2:
s_branch PAD6
SK2:
buffer_load_dwordx4 v3, s[20:23], s57 offen offset:3072 lds
v_xor_b32 v46, v46, v15
v_lshrrev_b32 v47, 1, v18
v_mfma_f32_16x16x32_bf16 v[68:71], v[208:211], a[36:39], v[68:71]
s_add_u32 m0, s6, 106496
ds_read_b64_tr_b16 v[196:197], v12 offset:20480
v_bfi_b32 v18, 1, v46, v18
v_not_b32 v46, v46
v_mfma_f32_16x16x32_bf16 v[68:71], v[212:215], a[52:55], v[68:71]
s_add_u32 s57, s58, 3539200
ds_read_b64_tr_b16 v[198:199], v12 offset:22528
v_bfi_b32 v47, 1, v46, v47
v_mfma_f32_16x16x32_bf16 v[68:71], v[216:219], a[68:71], v[68:71]
buffer_load_dwordx4 v0, s[20:23], s57 offen offset:0 lds
v_fma_f32 v20, v48, -v48, s62
v_fma_f32 v21, v49, -v49, s62
v_mul_f32 v20, v20, v48
v_mfma_f32_16x16x32_bf16 v[68:71], v[220:223], a[84:87], v[68:71]
ds_read_b64_tr_b16 v[200:201], v12 offset:24576
ds_read_b64_tr_b16 v[202:203], v12 offset:26624
v_mul_f32 v21, v21, v49
v_mfma_f32_16x16x32_bf16 v[72:75], v[208:211], a[40:43], v[72:75]
buffer_load_dwordx4 v1, s[20:23], s57 offen offset:1024 lds
v_exp_f32 v20, v20
v_mfma_f32_16x16x32_bf16 v[72:75], v[212:215], a[56:59], v[72:75]
ds_read_b64_tr_b16 v[204:205], v12 offset:28672
ds_read_b64_tr_b16 v[206:207], v12 offset:30720
v_exp_f32 v21, v21
v_mfma_f32_16x16x32_bf16 v[72:75], v[216:219], a[72:75], v[72:75]
buffer_load_dwordx4 v2, s[20:23], s57 offen offset:2048 lds
v_add_f32 v20, 1.0, v20
v_add_f32 v21, 1.0, v21
v_mfma_f32_16x16x32_bf16 v[72:75], v[220:223], a[88:91], v[72:75]
v_rcp_f32 v20, v20
v_rcp_f32 v21, v21
v_mfma_f32_16x16x32_bf16 v[76:79], v[208:211], a[44:47], v[76:79]
v_mul_f32 v20, v20, v48
v_mul_f32 v21, v21, v49
v_cvt_pk_bf16_f32 v96, v20, v21
v_fma_f32 v22, v50, -v50, s62
v_mfma_f32_16x16x32_bf16 v[76:79], v[212:215], a[60:63], v[76:79]
buffer_load_dwordx4 v3, s[20:23], s57 offen offset:3072 lds
s_add_u32 m0, s6, 122880
v_fma_f32 v23, v51, -v51, s62
v_mfma_f32_16x16x32_bf16 v[76:79], v[216:219], a[76:79], v[76:79]
s_add_u32 s57, s59, 4718848
v_mul_f32 v22, v22, v50
v_mul_f32 v23, v23, v51
v_mfma_f32_16x16x32_bf16 v[76:79], v[220:223], a[92:95], v[76:79]
buffer_load_dwordx4 v0, s[20:23], s57 offen offset:0 lds
v_exp_f32 v22, v22
v_exp_f32 v23, v23
s_waitcnt vmcnt(21) lgkmcnt(0)
s_barrier
v_mfma_f32_16x16x32_bf16 v[64:67], v[192:195], a[96:99], v[64:67]
ds_read_b64_tr_b16 v[208:209], v12 offset:32768
v_add_f32 v22, 1.0, v22
v_add_f32 v23, 1.0, v23
v_mfma_f32_16x16x32_bf16 v[64:67], v[196:199], a[112:115], v[64:67]
buffer_load_dwordx4 v1, s[20:23], s57 offen offset:1024 lds
v_rcp_f32 v22, v22
v_mfma_f32_16x16x32_bf16 v[64:67], v[200:203], a[128:131], v[64:67]
ds_read_b64_tr_b16 v[210:211], v12 offset:34816
v_rcp_f32 v23, v23
v_mul_f32 v22, v22, v50
v_mfma_f32_16x16x32_bf16 v[64:67], v[204:207], a[144:147], v[64:67]
buffer_load_dwordx4 v2, s[20:23], s57 offen offset:2048 lds
v_mul_f32 v23, v23, v51
v_cvt_pk_bf16_f32 v97, v22, v23
v_mfma_f32_16x16x32_bf16 v[68:71], v[192:195], a[100:103], v[68:71]
ds_read_b64_tr_b16 v[212:213], v12 offset:36864
v_fma_f32 v20, v52, -v52, s62
v_fma_f32 v21, v53, -v53, s62
v_mul_f32 v20, v20, v52
v_mfma_f32_16x16x32_bf16 v[68:71], v[196:199], a[116:119], v[68:71]
ds_read_b64_tr_b16 v[214:215], v12 offset:38912
v_mul_f32 v21, v21, v53
v_exp_f32 v20, v20
v_mfma_f32_16x16x32_bf16 v[68:71], v[200:203], a[132:135], v[68:71]
buffer_load_dwordx4 v3, s[20:23], s57 offen offset:3072 lds
s_add_u32 m0, s6, 16384
v_mfma_f32_16x16x32_bf16 v[68:71], v[204:207], a[148:151], v[68:71]
s_add_u32 s57, s81, 590208
ds_read_b64_tr_b16 v[216:217], v12 offset:40960
ds_read_b64_tr_b16 v[218:219], v12 offset:43008
v_exp_f32 v21, v21
v_mfma_f32_16x16x32_bf16 v[72:75], v[192:195], a[104:107], v[72:75]
buffer_load_dwordx4 v0, s[20:23], s57 offen offset:0 lds
v_add_f32 v20, 1.0, v20
v_add_f32 v21, 1.0, v21
v_mfma_f32_16x16x32_bf16 v[72:75], v[196:199], a[120:123], v[72:75]
ds_read_b64_tr_b16 v[220:221], v12 offset:45056
ds_read_b64_tr_b16 v[222:223], v12 offset:47104
v_rcp_f32 v20, v20
v_mfma_f32_16x16x32_bf16 v[72:75], v[200:203], a[136:139], v[72:75]
buffer_load_dwordx4 v1, s[20:23], s57 offen offset:1024 lds
v_rcp_f32 v21, v21
v_mfma_f32_16x16x32_bf16 v[72:75], v[204:207], a[152:155], v[72:75]
v_mul_f32 v20, v20, v52
v_mul_f32 v21, v21, v53
v_cvt_pk_bf16_f32 v98, v20, v21
v_mfma_f32_16x16x32_bf16 v[76:79], v[192:195], a[108:111], v[76:79]
v_fma_f32 v22, v54, -v54, s62
v_fma_f32 v23, v55, -v55, s62
v_mul_f32 v22, v22, v54
v_mul_f32 v23, v23, v55
v_mfma_f32_16x16x32_bf16 v[76:79], v[196:199], a[124:127], v[76:79]
buffer_load_dwordx4 v2, s[20:23], s57 offen offset:2048 lds
v_exp_f32 v22, v22
v_mfma_f32_16x16x32_bf16 v[76:79], v[200:203], a[140:143], v[76:79]
v_exp_f32 v23, v23
v_add_f32 v22, 1.0, v22
v_add_f32 v23, 1.0, v23
v_mfma_f32_16x16x32_bf16 v[76:79], v[204:207], a[156:159], v[76:79]
buffer_load_dwordx4 v3, s[20:23], s57 offen offset:3072 lds
v_rcp_f32 v22, v22
s_waitcnt vmcnt(24) lgkmcnt(0)
s_barrier
v_mfma_f32_16x16x32_bf16 v[64:67], v[208:211], a[160:163], v[64:67]
s_lshr_b32 s86, s6, 1
s_add_u32 m0, s86, 140288
s_movk_i32 s57, 8192
ds_read_b64_tr_b16 v[192:193], v13 offset:8192
v_mfma_f32_16x16x32_bf16 v[64:67], v[212:215], a[176:179], v[64:67]
buffer_load_dwordx4 v164, s[12:15], 0 offen lds
v_rcp_f32 v23, v23
v_mfma_f32_16x16x32_bf16 v[64:67], v[216:219], a[192:195], v[64:67]
ds_read_b64_tr_b16 v[194:195], v13 offset:10240
v_mul_f32 v22, v22, v54
v_mul_f32 v23, v23, v55
v_cvt_pk_bf16_f32 v99, v22, v23
v_mfma_f32_16x16x32_bf16 v[64:67], v[220:223], a[208:211], v[64:67]
buffer_load_dwordx4 v164, s[12:15], s57 offen offset:1024 lds
v_fma_f32 v20, v56, -v56, s62
v_fma_f32 v21, v57, -v57, s62
v_mul_f32 v20, v20, v56
v_mfma_f32_16x16x32_bf16 v[68:71], v[208:211], a[164:167], v[68:71]
ds_read_b64_tr_b16 v[196:197], v13 offset:12288
v_mul_f32 v21, v21, v57
v_exp_f32 v20, v20
v_mfma_f32_16x16x32_bf16 v[68:71], v[212:215], a[180:183], v[68:71]
s_movk_i32 s86, 9216
s_cmp_eq_u32 s3, 0
s_cselect_b32 s86, 0, s86
s_add_u32 m0, s86, 139264
s_nop 0
ds_read_b64_tr_b16 v[198:199], v13 offset:14336
v_mfma_f32_16x16x32_bf16 v[68:71], v[216:219], a[196:199], v[68:71]
buffer_load_dwordx4 v165, s[12:15], 0 offen lds
s_add_u32 m0, s6, 32768
v_mfma_f32_16x16x32_bf16 v[68:71], v[220:223], a[212:215], v[68:71]
s_add_u32 s57, s81, 1769856
ds_read_b64_tr_b16 v[200:201], v13 offset:16384
ds_read_b64_tr_b16 v[202:203], v13 offset:18432
v_mfma_f32_16x16x32_bf16 v[72:75], v[208:211], a[168:171], v[72:75]
buffer_load_dwordx4 v0, s[20:23], s57 offen offset:0 lds
v_exp_f32 v21, v21
v_mfma_f32_16x16x32_bf16 v[72:75], v[212:215], a[184:187], v[72:75]
ds_read_b64_tr_b16 v[204:205], v13 offset:20480
ds_read_b64_tr_b16 v[206:207], v13 offset:22528
v_add_f32 v20, 1.0, v20
v_mfma_f32_16x16x32_bf16 v[72:75], v[216:219], a[200:203], v[72:75]
buffer_load_dwordx4 v1, s[20:23], s57 offen offset:1024 lds
v_add_f32 v21, 1.0, v21
v_rcp_f32 v20, v20
v_mfma_f32_16x16x32_bf16 v[72:75], v[220:223], a[216:219], v[72:75]
v_rcp_f32 v21, v21
v_mul_f32 v20, v20, v56
v_mfma_f32_16x16x32_bf16 v[76:79], v[208:211], a[172:175], v[76:79]
v_mul_f32 v21, v21, v57
v_cvt_pk_bf16_f32 v100, v20, v21
v_fma_f32 v22, v58, -v58, s62
v_fma_f32 v23, v59, -v59, s62
v_mfma_f32_16x16x32_bf16 v[76:79], v[212:215], a[188:191], v[76:79]
buffer_load_dwordx4 v2, s[20:23], s57 offen offset:2048 lds
v_mul_f32 v22, v22, v58
v_mul_f32 v23, v23, v59
v_mfma_f32_16x16x32_bf16 v[76:79], v[216:219], a[204:207], v[76:79]
v_exp_f32 v22, v22
v_exp_f32 v23, v23
v_mfma_f32_16x16x32_bf16 v[76:79], v[220:223], a[220:223], v[76:79]
buffer_load_dwordx4 v3, s[20:23], s57 offen offset:3072 lds
s_add_u32 m0, s6, 73728
v_add_f32 v22, 1.0, v22
s_waitcnt vmcnt(27) lgkmcnt(0)
s_barrier
v_mfma_f32_16x16x32_bf16 v[64:67], v[192:195], a[224:227], v[64:67]
s_add_u32 s57, s81, 2949504
ds_read_b64_tr_b16 v[208:209], v12 offset:49152
v_add_f32 v23, 1.0, v23
v_mfma_f32_16x16x32_bf16 v[64:67], v[196:199], a[240:243], v[64:67]
buffer_load_dwordx4 v0, s[20:23], s57 offen offset:0 lds
v_rcp_f32 v22, v22
v_rcp_f32 v23, v23
v_mfma_f32_16x16x32_bf16 v[64:67], v[200:203], v[224:227], v[64:67]
ds_read_b64_tr_b16 v[210:211], v12 offset:51200
v_mul_f32 v22, v22, v58
v_mul_f32 v23, v23, v59
v_mfma_f32_16x16x32_bf16 v[64:67], v[204:207], v[240:243], v[64:67]
buffer_load_dwordx4 v1, s[20:23], s57 offen offset:1024 lds
v_cvt_pk_bf16_f32 v101, v22, v23
v_fma_f32 v20, v60, -v60, s62
v_mfma_f32_16x16x32_bf16 v[68:71], v[192:195], a[228:231], v[68:71]
ds_read_b64_tr_b16 v[212:213], v12 offset:53248
v_fma_f32 v21, v61, -v61, s62
v_mul_f32 v20, v20, v60
v_mul_f32 v21, v21, v61
v_mfma_f32_16x16x32_bf16 v[68:71], v[196:199], a[244:247], v[68:71]
ds_read_b64_tr_b16 v[214:215], v12 offset:55296
v_exp_f32 v20, v20
v_mfma_f32_16x16x32_bf16 v[68:71], v[200:203], v[228:231], v[68:71]
buffer_load_dwordx4 v2, s[20:23], s57 offen offset:2048 lds
v_exp_f32 v21, v21
v_add_f32 v20, 1.0, v20
v_mfma_f32_16x16x32_bf16 v[68:71], v[204:207], v[244:247], v[68:71]
ds_read_b64_tr_b16 v[216:217], v12 offset:57344
v_add_f32 v21, 1.0, v21
v_rcp_f32 v20, v20
v_mfma_f32_16x16x32_bf16 v[72:75], v[192:195], a[232:235], v[72:75]
ds_read_b64_tr_b16 v[218:219], v12 offset:59392
v_rcp_f32 v21, v21
v_mfma_f32_16x16x32_bf16 v[72:75], v[196:199], a[248:251], v[72:75]
ds_read_b64_tr_b16 v[220:221], v12 offset:61440
v_mul_f32 v20, v20, v60
v_mul_f32 v21, v21, v61
v_mfma_f32_16x16x32_bf16 v[72:75], v[200:203], v[232:235], v[72:75]
ds_read_b64_tr_b16 v[222:223], v12 offset:63488
v_cvt_pk_bf16_f32 v102, v20, v21
v_fma_f32 v22, v62, -v62, s62
v_fma_f32 v23, v63, -v63, s62
v_mfma_f32_16x16x32_bf16 v[72:75], v[204:207], v[248:251], v[72:75]
v_mul_f32 v22, v22, v62
v_mul_f32 v23, v23, v63
v_exp_f32 v22, v22
v_mfma_f32_16x16x32_bf16 v[76:79], v[192:195], a[236:239], v[76:79]
v_exp_f32 v23, v23
v_add_f32 v22, 1.0, v22
v_mfma_f32_16x16x32_bf16 v[76:79], v[196:199], a[252:255], v[76:79]
ds_read_b128 v[24:27], v7 offset:512
v_add_f32 v23, 1.0, v23
v_rcp_f32 v22, v22
v_mfma_f32_16x16x32_bf16 v[76:79], v[200:203], v[236:239], v[76:79]
v_rcp_f32 v23, v23
v_mul_f32 v22, v22, v62
v_mfma_f32_16x16x32_bf16 v[76:79], v[204:207], v[252:255], v[76:79]
v_mul_f32 v23, v23, v63
v_cvt_pk_bf16_f32 v103, v22, v23
v_lshlrev_b32 v168, 16, v42
v_and_b32 v169, s64, v42
s_waitcnt vmcnt(22) lgkmcnt(0)
s_barrier
v_mfma_f32_16x16x32_bf16 v[80:83], v[208:211], a[0:3], v[24:27]
v_lshlrev_b32 v170, 16, v43
v_and_b32 v171, s64, v43
v_mul_f32 v168, s65, v168
v_mfma_f32_16x16x32_bf16 v[80:83], v[212:215], a[16:19], v[80:83]
v_mul_f32 v169, s65, v169
v_mul_f32 v170, s65, v170
v_mul_f32 v171, s65, v171
v_mfma_f32_16x16x32_bf16 v[80:83], v[216:219], a[32:35], v[80:83]
v_mfma_f32_16x16x32_bf16 v[80:83], v[220:223], a[48:51], v[80:83]
ds_read_b64_tr_b16 v[192:193], v13 offset:24576
v_mfma_f32_16x16x32_bf16 v[84:87], v[208:211], a[4:7], v[24:27]
ds_read_b64_tr_b16 v[194:195], v13 offset:26624
v_fma_f32 v20, v64, -v64, s62
v_fma_f32 v21, v65, -v65, s62
v_mul_f32 v20, v20, v64
v_mfma_f32_16x16x32_bf16 v[84:87], v[212:215], a[20:23], v[84:87]
ds_read_b64_tr_b16 v[196:197], v13 offset:28672
v_mul_f32 v21, v21, v65
v_exp_f32 v20, v20
v_mfma_f32_16x16x32_bf16 v[84:87], v[216:219], a[36:39], v[84:87]
ds_read_b64_tr_b16 v[198:199], v13 offset:30720
v_exp_f32 v21, v21
v_mfma_f32_16x16x32_bf16 v[84:87], v[220:223], a[52:55], v[84:87]
ds_read_b64_tr_b16 v[200:201], v13 offset:32768
v_add_f32 v20, 1.0, v20
v_add_f32 v21, 1.0, v21
v_mfma_f32_16x16x32_bf16 v[88:91], v[208:211], a[8:11], v[24:27]
ds_read_b64_tr_b16 v[202:203], v13 offset:34816
v_rcp_f32 v20, v20
v_rcp_f32 v21, v21
v_mfma_f32_16x16x32_bf16 v[88:91], v[212:215], a[24:27], v[88:91]
ds_read_b64_tr_b16 v[204:205], v13 offset:36864
v_mul_f32 v20, v20, v64
v_mul_f32 v21, v21, v65
v_mfma_f32_16x16x32_bf16 v[88:91], v[216:219], a[40:43], v[88:91]
ds_read_b64_tr_b16 v[206:207], v13 offset:38912
v_cvt_pk_bf16_f32 v104, v20, v21
v_fma_f32 v22, v66, -v66, s62
v_mfma_f32_16x16x32_bf16 v[88:91], v[220:223], a[56:59], v[88:91]
v_fma_f32 v23, v67, -v67, s62
v_mul_f32 v22, v22, v66
v_mul_f32 v23, v23, v67
v_mfma_f32_16x16x32_bf16 v[92:95], v[208:211], a[12:15], v[24:27]
v_exp_f32 v22, v22
v_exp_f32 v23, v23
v_mfma_f32_16x16x32_bf16 v[92:95], v[212:215], a[28:31], v[92:95]
v_add_f32 v22, 1.0, v22
v_add_f32 v23, 1.0, v23
v_rcp_f32 v22, v22
v_mfma_f32_16x16x32_bf16 v[92:95], v[216:219], a[44:47], v[92:95]
v_rcp_f32 v23, v23
v_mul_f32 v22, v22, v66
v_mfma_f32_16x16x32_bf16 v[92:95], v[220:223], a[60:63], v[92:95]
v_mul_f32 v23, v23, v67
v_cvt_pk_bf16_f32 v105, v22, v23
v_fma_f32 v20, v68, -v68, s62
v_fma_f32 v21, v69, -v69, s62
s_waitcnt lgkmcnt(0)
v_mfma_f32_16x16x32_bf16 v[80:83], v[192:195], a[64:67], v[80:83]
v_mul_f32 v20, v20, v68
v_mul_f32 v21, v21, v69
v_exp_f32 v20, v20
v_mfma_f32_16x16x32_bf16 v[80:83], v[196:199], a[80:83], v[80:83]
v_exp_f32 v21, v21
v_add_f32 v20, 1.0, v20
v_mfma_f32_16x16x32_bf16 v[80:83], v[200:203], a[96:99], v[80:83]
v_add_f32 v21, 1.0, v21
v_rcp_f32 v20, v20
v_mfma_f32_16x16x32_bf16 v[80:83], v[204:207], a[112:115], v[80:83]
ds_read_b64_tr_b16 v[208:209], v12 offset:0
v_rcp_f32 v21, v21
v_mul_f32 v20, v20, v68
v_mfma_f32_16x16x32_bf16 v[84:87], v[192:195], a[68:71], v[84:87]
ds_read_b64_tr_b16 v[210:211], v12 offset:2048
v_mul_f32 v21, v21, v69
v_cvt_pk_bf16_f32 v106, v20, v21
v_mfma_f32_16x16x32_bf16 v[84:87], v[196:199], a[84:87], v[84:87]
ds_read_b64_tr_b16 v[212:213], v12 offset:4096
v_fma_f32 v22, v70, -v70, s62
v_fma_f32 v23, v71, -v71, s62
v_mul_f32 v22, v22, v70
v_mfma_f32_16x16x32_bf16 v[84:87], v[200:203], a[100:103], v[84:87]
ds_read_b64_tr_b16 v[214:215], v12 offset:6144
v_mul_f32 v23, v23, v71
v_exp_f32 v22, v22
v_mfma_f32_16x16x32_bf16 v[84:87], v[204:207], a[116:119], v[84:87]
ds_read_b64_tr_b16 v[216:217], v12 offset:8192
v_exp_f32 v23, v23
v_mfma_f32_16x16x32_bf16 v[88:91], v[192:195], a[72:75], v[88:91]
ds_read_b64_tr_b16 v[218:219], v12 offset:10240
v_add_f32 v22, 1.0, v22
v_add_f32 v23, 1.0, v23
v_mfma_f32_16x16x32_bf16 v[88:91], v[196:199], a[88:91], v[88:91]
ds_read_b64_tr_b16 v[220:221], v12 offset:12288
v_rcp_f32 v22, v22
v_rcp_f32 v23, v23
v_mfma_f32_16x16x32_bf16 v[88:91], v[200:203], a[104:107], v[88:91]
ds_read_b64_tr_b16 v[222:223], v12 offset:14336
v_mul_f32 v22, v22, v70
v_mul_f32 v23, v23, v71
v_mfma_f32_16x16x32_bf16 v[88:91], v[204:207], a[120:123], v[88:91]
buffer_load_dwordx4 v3, s[20:23], s57 offen offset:3072 lds
s_add_u32 m0, s6, 49152
v_cvt_pk_bf16_f32 v107, v22, v23
v_mfma_f32_16x16x32_bf16 v[92:95], v[192:195], a[76:79], v[92:95]
s_add_u32 s57, s81, 4129152
v_fma_f32 v20, v72, -v72, s62
v_fma_f32 v21, v73, -v73, s62
v_mul_f32 v20, v20, v72
v_mfma_f32_16x16x32_bf16 v[92:95], v[196:199], a[92:95], v[92:95]
buffer_load_dwordx4 v0, s[20:23], s57 offen offset:0 lds
v_mul_f32 v21, v21, v73
v_exp_f32 v20, v20
v_mfma_f32_16x16x32_bf16 v[92:95], v[200:203], a[108:111], v[92:95]
v_exp_f32 v21, v21
v_add_f32 v20, 1.0, v20
v_mfma_f32_16x16x32_bf16 v[92:95], v[204:207], a[124:127], v[92:95]
buffer_load_dwordx4 v1, s[20:23], s57 offen offset:1024 lds
v_add_f32 v21, 1.0, v21
v_rcp_f32 v20, v20
s_waitcnt vmcnt(10) lgkmcnt(0)
s_barrier
v_mfma_f32_16x16x32_bf16 v[80:83], v[208:211], a[128:131], v[80:83]
ds_read_b64_tr_b16 v[192:193], v13 offset:40960
v_rcp_f32 v21, v21
v_mfma_f32_16x16x32_bf16 v[80:83], v[212:215], a[144:147], v[80:83]
ds_read_b64_tr_b16 v[194:195], v13 offset:43008
v_mul_f32 v20, v20, v72
v_mul_f32 v21, v21, v73
v_mfma_f32_16x16x32_bf16 v[80:83], v[216:219], a[160:163], v[80:83]
buffer_load_dwordx4 v2, s[20:23], s57 offen offset:2048 lds
v_cvt_pk_bf16_f32 v108, v20, v21
v_fma_f32 v22, v74, -v74, s62
v_fma_f32 v23, v75, -v75, s62
v_mfma_f32_16x16x32_bf16 v[80:83], v[220:223], a[176:179], v[80:83]
ds_read_b64_tr_b16 v[196:197], v13 offset:45056
ds_read_b64_tr_b16 v[128:129], v166 offset:512
v_mul_f32 v22, v22, v74
v_mul_f32 v23, v23, v75
v_mfma_f32_16x16x32_bf16 v[84:87], v[208:211], a[132:135], v[84:87]
buffer_load_dwordx4 v3, s[20:23], s57 offen offset:3072 lds
s_add_u32 m0, s6, 0
v_exp_f32 v22, v22
v_mfma_f32_16x16x32_bf16 v[84:87], v[212:215], a[148:151], v[84:87]
s_add_u32 s57, s58, 512
ds_read_b64_tr_b16 v[198:199], v13 offset:47104
ds_read_b64_tr_b16 v[130:131], v166 offset:1024
v_mfma_f32_16x16x32_bf16 v[84:87], v[216:219], a[164:167], v[84:87]
buffer_load_dwordx4 v0, s[20:23], s57 offen offset:0 lds
v_exp_f32 v23, v23
v_mfma_f32_16x16x32_bf16 v[84:87], v[220:223], a[180:183], v[84:87]
ds_read_b64_tr_b16 v[200:201], v13 offset:49152
ds_read_b64_tr_b16 v[132:133], v166 offset:1536
v_add_f32 v22, 1.0, v22
v_add_f32 v23, 1.0, v23
v_mfma_f32_16x16x32_bf16 v[88:91], v[208:211], a[136:139], v[88:91]
buffer_load_dwordx4 v1, s[20:23], s57 offen offset:1024 lds
v_rcp_f32 v22, v22
v_mfma_f32_16x16x32_bf16 v[88:91], v[212:215], a[152:155], v[88:91]
ds_read_b64_tr_b16 v[202:203], v13 offset:51200
ds_read_b64_tr_b16 v[134:135], v166 offset:4608
v_rcp_f32 v23, v23
v_mfma_f32_16x16x32_bf16 v[88:91], v[216:219], a[168:171], v[88:91]
ds_read_b64_tr_b16 v[204:205], v13 offset:53248
ds_read_b64_tr_b16 v[206:207], v13 offset:55296
v_mul_f32 v22, v22, v74
v_mfma_f32_16x16x32_bf16 v[88:91], v[220:223], a[184:187], v[88:91]
buffer_load_dwordx4 v2, s[20:23], s57 offen offset:2048 lds
v_mul_f32 v23, v23, v75
v_cvt_pk_bf16_f32 v109, v22, v23
v_fma_f32 v20, v76, -v76, s62
v_mfma_f32_16x16x32_bf16 v[92:95], v[208:211], a[140:143], v[92:95]
ds_read_b64_tr_b16 v[136:137], v166 offset:5120
ds_read_b64_tr_b16 v[138:139], v166 offset:5632
v_fma_f32 v21, v77, -v77, s62
v_mul_f32 v20, v20, v76
v_mfma_f32_16x16x32_bf16 v[92:95], v[212:215], a[156:159], v[92:95]
buffer_load_dwordx4 v3, s[20:23], s57 offen offset:3072 lds
s_add_u32 m0, s6, 90112
v_mul_f32 v21, v21, v77
v_mfma_f32_16x16x32_bf16 v[92:95], v[216:219], a[172:175], v[92:95]
s_add_u32 s57, s58, 1180160
ds_read_b64_tr_b16 v[140:141], v167 offset:0
ds_read_b64_tr_b16 v[142:143], v167 offset:64
v_mfma_f32_16x16x32_bf16 v[92:95], v[220:223], a[188:191], v[92:95]
buffer_load_dwordx4 v0, s[20:23], s57 offen offset:0 lds
v_exp_f32 v20, v20
v_exp_f32 v21, v21
s_waitcnt lgkmcnt(4)
v_mfma_f32_16x16x32_bf16 v[80:83], v[192:195], a[192:195], v[80:83]
ds_read_b64_tr_b16 v[208:209], v13 offset:57344
v_add_f32 v20, 1.0, v20
v_add_f32 v21, 1.0, v21
v_mfma_f32_16x16x32_bf16 v[80:83], v[196:199], a[208:211], v[80:83]
ds_read_b64_tr_b16 v[210:211], v13 offset:59392
v_rcp_f32 v20, v20
v_mfma_f32_16x16x32_bf16 v[80:83], v[200:203], a[224:227], v[80:83]
buffer_load_dwordx4 v1, s[20:23], s57 offen offset:1024 lds
v_rcp_f32 v21, v21
v_mul_f32 v20, v20, v76
v_mfma_f32_16x16x32_bf16 v[80:83], v[204:207], a[240:243], v[80:83]
ds_read_b64_tr_b16 v[212:213], v13 offset:61440
v_mul_f32 v21, v21, v77
v_cvt_pk_bf16_f32 v110, v20, v21
v_mfma_f32_16x16x32_bf16 v[84:87], v[192:195], a[196:199], v[84:87]
buffer_load_dwordx4 v2, s[20:23], s57 offen offset:2048 lds
v_fma_f32 v22, v78, -v78, s62
v_fma_f32 v23, v79, -v79, s62
v_mul_f32 v22, v22, v78
v_mfma_f32_16x16x32_bf16 v[84:87], v[196:199], a[212:215], v[84:87]
ds_read_b64_tr_b16 v[214:215], v13 offset:63488
v_mul_f32 v23, v23, v79
v_exp_f32 v22, v22
v_mfma_f32_16x16x32_bf16 v[84:87], v[200:203], a[228:231], v[84:87]
buffer_load_dwordx4 v3, s[20:23], s57 offen offset:3072 lds
v_exp_f32 v23, v23
v_mfma_f32_16x16x32_bf16 v[84:87], v[204:207], a[244:247], v[84:87]
ds_read_b64_tr_b16 v[216:217], v14 offset:0
v_add_f32 v22, 1.0, v22
v_add_f32 v23, 1.0, v23
v_mfma_f32_16x16x32_bf16 v[88:91], v[192:195], a[200:203], v[88:91]
s_mov_b32 exec_lo, 0xc0000000
s_mov_b32 exec_hi, 0x1fff
buffer_load_dword v183, v182, s[20:23], s87 offen
s_mov_b64 exec, -1
v_mfma_f32_16x16x32_bf16 v[88:91], v[196:199], a[216:219], v[88:91]
ds_read_b64_tr_b16 v[218:219], v14 offset:2048
v_rcp_f32 v22, v22
v_mfma_f32_16x16x32_bf16 v[88:91], v[200:203], a[232:235], v[88:91]
ds_read_b64_tr_b16 v[220:221], v14 offset:4096
ds_read_b64_tr_b16 v[222:223], v14 offset:6144
v_rcp_f32 v23, v23
v_mfma_f32_16x16x32_bf16 v[88:91], v[204:207], a[248:251], v[88:91]
v_mul_f32 v22, v22, v78
v_mul_f32 v23, v23, v79
v_cvt_pk_bf16_f32 v111, v22, v23
s_waitcnt lgkmcnt(8)
v_mfma_f32_16x16x32_bf16 v[92:95], v[192:195], a[204:207], v[92:95]
v_and_b32 v121, s64, v128
v_lshlrev_b32 v122, 16, v129
v_and_b32 v123, s64, v129
v_mfma_f32_16x16x32_bf16 v[92:95], v[196:199], a[220:223], v[92:95]
ds_read_b128 v[28:31], v7 offset:768
v_mul_f32 v144, v121, v171
v_lshlrev_b32 v120, 16, v130
v_fmac_f32 v144, v122, v170
v_mfma_f32_16x16x32_bf16 v[92:95], v[200:203], a[236:239], v[92:95]
v_fmac_f32 v144, v123, v169
v_fmac_f32 v144, v120, v168
v_mul_f32 v145, v122, v171
v_mfma_f32_16x16x32_bf16 v[92:95], v[204:207], a[252:255], v[92:95]
s_add_u32 m0, s6, 106496
v_and_b32 v121, s64, v130
v_fmac_f32 v145, v123, v170
v_fmac_f32 v145, v120, v169
s_waitcnt vmcnt(17) lgkmcnt(0)
s_barrier
v_mfma_f32_16x16x32_bf16 v[80:83], v[208:211], v[224:227], v[80:83]
s_add_u32 s57, s58, 2359808
ds_read_b64_tr_b16 v[192:193], v12 offset:16384
v_fmac_f32 v145, v121, v168
v_mfma_f32_16x16x32_bf16 v[80:83], v[212:215], v[240:243], v[80:83]
buffer_load_dwordx4 v0, s[20:23], s57 offen offset:0 lds
v_mul_f32 v146, v123, v171
v_lshlrev_b32 v122, 16, v131
v_fmac_f32 v146, v120, v170
v_mfma_f32_16x16x32_bf16 v[84:87], v[208:211], v[228:231], v[84:87]
ds_read_b64_tr_b16 v[194:195], v12 offset:18432
v_fmac_f32 v146, v121, v169
v_fmac_f32 v146, v122, v168
v_mfma_f32_16x16x32_bf16 v[84:87], v[212:215], v[244:247], v[84:87]
buffer_load_dwordx4 v1, s[20:23], s57 offen offset:1024 lds
v_mul_f32 v147, v120, v171
v_and_b32 v123, s64, v131
v_fmac_f32 v147, v121, v170
v_mfma_f32_16x16x32_bf16 v[88:91], v[208:211], v[232:235], v[88:91]
ds_read_b64_tr_b16 v[196:197], v12 offset:20480
v_fmac_f32 v147, v122, v169
v_fmac_f32 v147, v123, v168
v_mul_f32 v148, v121, v171
v_mfma_f32_16x16x32_bf16 v[88:91], v[212:215], v[248:251], v[88:91]
ds_read_b64_tr_b16 v[198:199], v12 offset:22528
v_lshlrev_b32 v120, 16, v132
v_fmac_f32 v148, v122, v170
v_mfma_f32_16x16x32_bf16 v[92:95], v[208:211], v[236:239], v[92:95]
buffer_load_dwordx4 v2, s[20:23], s57 offen offset:2048 lds
v_fmac_f32 v148, v123, v169
v_fmac_f32 v148, v120, v168
v_mul_f32 v149, v122, v171
v_mfma_f32_16x16x32_bf16 v[92:95], v[212:215], v[252:255], v[92:95]
ds_read_b64_tr_b16 v[200:201], v12 offset:24576
ds_read_b64_tr_b16 v[202:203], v12 offset:26624
v_and_b32 v121, s64, v132
v_mfma_f32_16x16x32_bf16 v[48:51], v[216:219], a[0:3], v[28:31]
buffer_load_dwordx4 v3, s[20:23], s57 offen offset:3072 lds
s_add_u32 m0, s6, 122880
v_fmac_f32 v149, v123, v170
v_fmac_f32 v149, v120, v169
v_mfma_f32_16x16x32_bf16 v[48:51], v[220:223], a[16:19], v[48:51]
s_add_u32 s57, s58, 3539456
ds_read_b64_tr_b16 v[204:205], v12 offset:28672
ds_read_b64_tr_b16 v[206:207], v12 offset:30720
v_mfma_f32_16x16x32_bf16 v[52:55], v[216:219], a[4:7], v[28:31]
buffer_load_dwordx4 v0, s[20:23], s57 offen offset:0 lds
v_fmac_f32 v149, v121, v168
v_mul_f32 v150, v123, v171
v_lshlrev_b32 v122, 16, v133
v_mfma_f32_16x16x32_bf16 v[52:55], v[220:223], a[20:23], v[52:55]
v_fmac_f32 v150, v120, v170
v_fmac_f32 v150, v121, v169
v_fmac_f32 v150, v122, v168
v_mfma_f32_16x16x32_bf16 v[56:59], v[216:219], a[8:11], v[28:31]
v_mul_f32 v151, v120, v171
v_and_b32 v123, s64, v133
v_fmac_f32 v151, v121, v170
v_fmac_f32 v151, v122, v169
v_mfma_f32_16x16x32_bf16 v[56:59], v[220:223], a[24:27], v[56:59]
buffer_load_dwordx4 v1, s[20:23], s57 offen offset:1024 lds
v_fmac_f32 v151, v123, v168
v_and_b32 v121, s64, v134
v_lshlrev_b32 v122, 16, v135
v_mfma_f32_16x16x32_bf16 v[60:63], v[216:219], a[12:15], v[28:31]
v_and_b32 v123, s64, v135
v_mul_f32 v152, v121, v171
v_lshlrev_b32 v120, 16, v136
v_mfma_f32_16x16x32_bf16 v[60:63], v[220:223], a[28:31], v[60:63]
buffer_load_dwordx4 v2, s[20:23], s57 offen offset:2048 lds
v_fmac_f32 v152, v122, v170
v_fmac_f32 v152, v123, v169
v_fmac_f32 v152, v120, v168
s_waitcnt lgkmcnt(0)
v_mfma_f32_16x16x32_bf16 v[48:51], v[192:195], a[32:35], v[48:51]
v_mul_f32 v153, v122, v171
v_and_b32 v121, s64, v136
v_fmac_f32 v153, v123, v170
v_mfma_f32_16x16x32_bf16 v[48:51], v[196:199], a[48:51], v[48:51]
buffer_load_dwordx4 v3, s[20:23], s57 offen offset:3072 lds
v_fmac_f32 v153, v120, v169
v_fmac_f32 v153, v121, v168
v_mul_f32 v154, v123, v171
v_mfma_f32_16x16x32_bf16 v[48:51], v[200:203], a[64:67], v[48:51]
v_lshlrev_b32 v122, 16, v137
v_fmac_f32 v154, v120, v170
v_fmac_f32 v154, v121, v169
v_mfma_f32_16x16x32_bf16 v[48:51], v[204:207], a[80:83], v[48:51]
ds_read_b64_tr_b16 v[208:209], v12 offset:32768
v_fmac_f32 v154, v122, v168
v_mul_f32 v155, v120, v171
v_and_b32 v123, s64, v137
v_mfma_f32_16x16x32_bf16 v[52:55], v[192:195], a[36:39], v[52:55]
ds_read_b64_tr_b16 v[210:211], v12 offset:34816
v_fmac_f32 v155, v121, v170
v_fmac_f32 v155, v122, v169
v_mfma_f32_16x16x32_bf16 v[52:55], v[196:199], a[52:55], v[52:55]
ds_read_b64_tr_b16 v[212:213], v12 offset:36864
v_fmac_f32 v155, v123, v168
v_mul_f32 v156, v121, v171
v_lshlrev_b32 v120, 16, v138
v_mfma_f32_16x16x32_bf16 v[52:55], v[200:203], a[68:71], v[52:55]
ds_read_b64_tr_b16 v[214:215], v12 offset:38912
v_fmac_f32 v156, v122, v170
v_fmac_f32 v156, v123, v169
v_fmac_f32 v156, v120, v168
v_mfma_f32_16x16x32_bf16 v[52:55], v[204:207], a[84:87], v[52:55]
ds_read_b64_tr_b16 v[216:217], v12 offset:40960
v_mul_f32 v157, v122, v171
v_and_b32 v121, s64, v138
v_mfma_f32_16x16x32_bf16 v[56:59], v[192:195], a[40:43], v[56:59]
ds_read_b64_tr_b16 v[218:219], v12 offset:43008
v_fmac_f32 v157, v123, v170
v_fmac_f32 v157, v120, v169
v_fmac_f32 v157, v121, v168
v_mfma_f32_16x16x32_bf16 v[56:59], v[196:199], a[56:59], v[56:59]
ds_read_b64_tr_b16 v[220:221], v12 offset:45056
v_mul_f32 v158, v123, v171
v_lshlrev_b32 v122, 16, v139
v_mfma_f32_16x16x32_bf16 v[56:59], v[200:203], a[72:75], v[56:59]
ds_read_b64_tr_b16 v[222:223], v12 offset:47104
v_fmac_f32 v158, v120, v170
v_fmac_f32 v158, v121, v169
v_fmac_f32 v158, v122, v168
v_mfma_f32_16x16x32_bf16 v[56:59], v[204:207], a[88:91], v[56:59]
v_mul_f32 v159, v120, v171
v_and_b32 v123, s64, v139
v_fmac_f32 v159, v121, v170
v_mfma_f32_16x16x32_bf16 v[60:63], v[192:195], a[44:47], v[60:63]
v_fmac_f32 v159, v122, v169
v_fmac_f32 v159, v123, v168
v_lshlrev_b32 v168, 16, v44
v_and_b32 v169, s64, v44
v_mfma_f32_16x16x32_bf16 v[60:63], v[196:199], a[60:63], v[60:63]
v_lshlrev_b32 v170, 16, v45
v_and_b32 v171, s64, v45
v_mul_f32 v168, s65, v168
v_mfma_f32_16x16x32_bf16 v[60:63], v[200:203], a[76:79], v[60:63]
v_mul_f32 v169, s65, v169
v_mul_f32 v170, s65, v170
v_mul_f32 v171, s65, v171
v_and_b32 v121, s64, v140
v_mfma_f32_16x16x32_bf16 v[60:63], v[204:207], a[92:95], v[60:63]
s_add_u32 m0, s6, 16384
v_lshlrev_b32 v122, 16, v141
v_and_b32 v123, s64, v141
v_mul_f32 v160, v121, v171
s_waitcnt vmcnt(17) lgkmcnt(0)
s_barrier
v_mfma_f32_16x16x32_bf16 v[48:51], v[208:211], a[96:99], v[48:51]
s_branch SK3
.p2align 12
PAD3:
s_branch PAD7
SK3:
s_add_u32 s57, s59, 4719104
v_lshlrev_b32 v120, 16, v142
v_fmac_f32 v160, v122, v170
v_mfma_f32_16x16x32_bf16 v[48:51], v[212:215], a[112:115], v[48:51]
buffer_load_dwordx4 v0, s[20:23], s57 offen offset:0 lds
v_fmac_f32 v160, v123, v169
v_fmac_f32 v160, v120, v168
v_mul_f32 v161, v122, v171
v_mfma_f32_16x16x32_bf16 v[48:51], v[216:219], a[128:131], v[48:51]
v_and_b32 v121, s64, v142
v_fmac_f32 v161, v123, v170
v_fmac_f32 v161, v120, v169
v_mfma_f32_16x16x32_bf16 v[48:51], v[220:223], a[144:147], v[48:51]
ds_read_b64_tr_b16 v[192:193], v13 offset:8192
v_fmac_f32 v161, v121, v168
v_mul_f32 v162, v123, v171
v_lshlrev_b32 v122, 16, v143
v_mfma_f32_16x16x32_bf16 v[52:55], v[208:211], a[100:103], v[52:55]
ds_read_b64_tr_b16 v[194:195], v13 offset:10240
v_fmac_f32 v162, v120, v170
v_fmac_f32 v162, v121, v169
v_mfma_f32_16x16x32_bf16 v[52:55], v[212:215], a[116:119], v[52:55]
ds_read_b64_tr_b16 v[196:197], v13 offset:12288
v_fmac_f32 v162, v122, v168
v_mul_f32 v163, v120, v171
v_and_b32 v123, s64, v143
v_mfma_f32_16x16x32_bf16 v[52:55], v[216:219], a[132:135], v[52:55]
ds_read_b64_tr_b16 v[198:199], v13 offset:14336
v_fmac_f32 v163, v121, v170
v_fmac_f32 v163, v122, v169
v_mfma_f32_16x16x32_bf16 v[52:55], v[220:223], a[148:151], v[52:55]
ds_read_b64_tr_b16 v[200:201], v13 offset:16384
v_fmac_f32 v163, v123, v168
v_fma_f32 v20, v80, -v80, s62
v_fma_f32 v21, v81, -v81, s62
v_mfma_f32_16x16x32_bf16 v[56:59], v[208:211], a[104:107], v[56:59]
ds_read_b64_tr_b16 v[202:203], v13 offset:18432
v_mul_f32 v20, v20, v80
v_mul_f32 v21, v21, v81
v_mfma_f32_16x16x32_bf16 v[56:59], v[212:215], a[120:123], v[56:59]
ds_read_b64_tr_b16 v[204:205], v13 offset:20480
v_exp_f32 v20, v20
v_exp_f32 v21, v21
v_mfma_f32_16x16x32_bf16 v[56:59], v[216:219], a[136:139], v[56:59]
ds_read_b64_tr_b16 v[206:207], v13 offset:22528
v_add_f32 v20, 1.0, v20
v_add_f32 v21, 1.0, v21
v_mfma_f32_16x16x32_bf16 v[56:59], v[220:223], a[152:155], v[56:59]
v_rcp_f32 v20, v20
v_rcp_f32 v21, v21
v_mfma_f32_16x16x32_bf16 v[60:63], v[208:211], a[108:111], v[60:63]
v_mul_f32 v20, v20, v80
v_mul_f32 v21, v21, v81
v_cvt_pk_bf16_f32 v112, v20, v21
v_mfma_f32_16x16x32_bf16 v[60:63], v[212:215], a[124:127], v[60:63]
v_fma_f32 v22, v82, -v82, s62
v_fma_f32 v23, v83, -v83, s62
v_mul_f32 v22, v22, v82
v_mfma_f32_16x16x32_bf16 v[60:63], v[216:219], a[140:143], v[60:63]
v_mul_f32 v23, v23, v83
v_exp_f32 v22, v22
v_mfma_f32_16x16x32_bf16 v[60:63], v[220:223], a[156:159], v[60:63]
v_exp_f32 v23, v23
v_add_f32 v22, 1.0, v22
v_add_f32 v23, 1.0, v23
s_waitcnt lgkmcnt(0)
v_mfma_f32_16x16x32_bf16 v[48:51], v[192:195], a[160:163], v[48:51]
ds_read_b64_tr_b16 v[208:209], v12 offset:49152
v_rcp_f32 v22, v22
v_mfma_f32_16x16x32_bf16 v[48:51], v[196:199], a[176:179], v[48:51]
ds_read_b64_tr_b16 v[210:211], v12 offset:51200
v_rcp_f32 v23, v23
v_mul_f32 v22, v22, v82
v_mfma_f32_16x16x32_bf16 v[48:51], v[200:203], a[192:195], v[48:51]
buffer_load_dwordx4 v1, s[20:23], s57 offen offset:1024 lds
v_mul_f32 v23, v23, v83
v_cvt_pk_bf16_f32 v113, v22, v23
v_fma_f32 v20, v84, -v84, s62
v_mfma_f32_16x16x32_bf16 v[48:51], v[204:207], a[208:211], v[48:51]
ds_read_b64_tr_b16 v[212:213], v12 offset:53248
v_fma_f32 v21, v85, -v85, s62
v_mul_f32 v20, v20, v84
v_mfma_f32_16x16x32_bf16 v[52:55], v[192:195], a[164:167], v[52:55]
buffer_load_dwordx4 v2, s[20:23], s57 offen offset:2048 lds
v_mul_f32 v21, v21, v85
v_exp_f32 v20, v20
v_mfma_f32_16x16x32_bf16 v[52:55], v[196:199], a[180:183], v[52:55]
ds_read_b64_tr_b16 v[214:215], v12 offset:55296
v_exp_f32 v21, v21
v_mfma_f32_16x16x32_bf16 v[52:55], v[200:203], a[196:199], v[52:55]
ds_read_b64_tr_b16 v[216:217], v12 offset:57344
v_add_f32 v20, 1.0, v20
v_add_f32 v21, 1.0, v21
v_mfma_f32_16x16x32_bf16 v[52:55], v[204:207], a[212:215], v[52:55]
buffer_load_dwordx4 v3, s[20:23], s57 offen offset:3072 lds
s_add_u32 m0, s6, 32768
v_rcp_f32 v20, v20
v_mfma_f32_16x16x32_bf16 v[56:59], v[192:195], a[168:171], v[56:59]
s_add_u32 s57, s81, 590464
ds_read_b64_tr_b16 v[218:219], v12 offset:59392
v_rcp_f32 v21, v21
v_mfma_f32_16x16x32_bf16 v[56:59], v[196:199], a[184:187], v[56:59]
buffer_load_dwordx4 v0, s[20:23], s57 offen offset:0 lds
v_mul_f32 v20, v20, v84
v_mul_f32 v21, v21, v85
v_mfma_f32_16x16x32_bf16 v[56:59], v[200:203], a[200:203], v[56:59]
ds_read_b64_tr_b16 v[220:221], v12 offset:61440
ds_read_b64_tr_b16 v[222:223], v12 offset:63488
v_cvt_pk_bf16_f32 v114, v20, v21
v_fma_f32 v22, v86, -v86, s62
v_mfma_f32_16x16x32_bf16 v[56:59], v[204:207], a[216:219], v[56:59]
buffer_load_dwordx4 v1, s[20:23], s57 offen offset:1024 lds
v_fma_f32 v23, v87, -v87, s62
v_mul_f32 v22, v22, v86
v_mfma_f32_16x16x32_bf16 v[60:63], v[192:195], a[172:175], v[60:63]
v_mul_f32 v23, v23, v87
v_exp_f32 v22, v22
v_mfma_f32_16x16x32_bf16 v[60:63], v[196:199], a[188:191], v[60:63]
buffer_load_dwordx4 v2, s[20:23], s57 offen offset:2048 lds
v_exp_f32 v23, v23
v_add_f32 v22, 1.0, v22
v_mfma_f32_16x16x32_bf16 v[60:63], v[200:203], a[204:207], v[60:63]
v_add_f32 v23, 1.0, v23
v_rcp_f32 v22, v22
v_mfma_f32_16x16x32_bf16 v[60:63], v[204:207], a[220:223], v[60:63]
v_rcp_f32 v23, v23
v_mul_f32 v22, v22, v86
v_mul_f32 v23, v23, v87
s_waitcnt vmcnt(16) lgkmcnt(0)
s_barrier
v_mfma_f32_16x16x32_bf16 v[48:51], v[208:211], a[224:227], v[48:51]
buffer_load_dwordx4 v3, s[20:23], s57 offen offset:3072 lds
s_add_u32 m0, s6, 49152
v_cvt_pk_bf16_f32 v115, v22, v23
v_fma_f32 v20, v88, -v88, s62
v_mfma_f32_16x16x32_bf16 v[48:51], v[212:215], a[240:243], v[48:51]
s_add_u32 s57, s81, 1770112
ds_read_b64_tr_b16 v[192:193], v12 offset:0
v_fma_f32 v21, v89, -v89, s62
v_mfma_f32_16x16x32_bf16 v[48:51], v[216:219], v[224:227], v[48:51]
buffer_load_dwordx4 v0, s[20:23], s57 offen offset:0 lds
v_mul_f32 v20, v20, v88
v_mul_f32 v21, v21, v89
v_mfma_f32_16x16x32_bf16 v[48:51], v[220:223], v[240:243], v[48:51]
ds_read_b64_tr_b16 v[194:195], v12 offset:2048
v_exp_f32 v20, v20
v_exp_f32 v21, v21
v_mfma_f32_16x16x32_bf16 v[52:55], v[208:211], a[228:231], v[52:55]
buffer_load_dwordx4 v1, s[20:23], s57 offen offset:1024 lds
v_add_f32 v20, 1.0, v20
v_add_f32 v21, 1.0, v21
v_mfma_f32_16x16x32_bf16 v[52:55], v[212:215], a[244:247], v[52:55]
ds_read_b64_tr_b16 v[196:197], v12 offset:4096
v_rcp_f32 v20, v20
v_mfma_f32_16x16x32_bf16 v[52:55], v[216:219], v[228:231], v[52:55]
ds_read_b64_tr_b16 v[198:199], v12 offset:6144
v_rcp_f32 v21, v21
v_mul_f32 v20, v20, v88
v_mfma_f32_16x16x32_bf16 v[52:55], v[220:223], v[244:247], v[52:55]
buffer_load_dwordx4 v2, s[20:23], s57 offen offset:2048 lds
v_mul_f32 v21, v21, v89
v_cvt_pk_bf16_f32 v116, v20, v21
v_mfma_f32_16x16x32_bf16 v[56:59], v[208:211], a[232:235], v[56:59]
ds_read_b64_tr_b16 v[200:201], v12 offset:8192
ds_read_b64_tr_b16 v[202:203], v12 offset:10240
v_fma_f32 v22, v90, -v90, s62
v_fma_f32 v23, v91, -v91, s62
v_mfma_f32_16x16x32_bf16 v[56:59], v[212:215], a[248:251], v[56:59]
buffer_load_dwordx4 v3, s[20:23], s57 offen offset:3072 lds
s_add_u32 m0, s6, 73728
v_mul_f32 v22, v22, v90
v_mfma_f32_16x16x32_bf16 v[56:59], v[216:219], v[232:235], v[56:59]
s_add_u32 s57, s81, 2949760
ds_read_b64_tr_b16 v[204:205], v12 offset:12288
ds_read_b64_tr_b16 v[206:207], v12 offset:14336
v_mul_f32 v23, v23, v91
v_mfma_f32_16x16x32_bf16 v[56:59], v[220:223], v[248:251], v[56:59]
buffer_load_dwordx4 v0, s[20:23], s57 offen offset:0 lds
v_exp_f32 v22, v22
v_mfma_f32_16x16x32_bf16 v[60:63], v[208:211], a[236:239], v[60:63]
ds_read_b128 v[24:27], v7 offset:1024
v_exp_f32 v23, v23
v_add_f32 v22, 1.0, v22
v_mfma_f32_16x16x32_bf16 v[60:63], v[212:215], a[252:255], v[60:63]
buffer_load_dwordx4 v1, s[20:23], s57 offen offset:1024 lds
v_add_f32 v23, 1.0, v23
v_rcp_f32 v22, v22
v_mfma_f32_16x16x32_bf16 v[60:63], v[216:219], v[236:239], v[60:63]
v_rcp_f32 v23, v23
v_mul_f32 v22, v22, v90
v_mfma_f32_16x16x32_bf16 v[60:63], v[220:223], v[252:255], v[60:63]
v_mul_f32 v23, v23, v91
v_cvt_pk_bf16_f32 v117, v22, v23
v_fma_f32 v20, v92, -v92, s62
v_fma_f32 v21, v93, -v93, s62
s_waitcnt lgkmcnt(0)
v_mfma_f32_16x16x32_bf16 v[64:67], v[192:195], a[0:3], v[24:27]
buffer_load_dwordx4 v2, s[20:23], s57 offen offset:2048 lds
v_mul_f32 v20, v20, v92
v_mul_f32 v21, v21, v93
v_mfma_f32_16x16x32_bf16 v[64:67], v[196:199], a[16:19], v[64:67]
ds_read_b64_tr_b16 v[208:209], v13 offset:24576
v_exp_f32 v20, v20
v_mfma_f32_16x16x32_bf16 v[64:67], v[200:203], a[32:35], v[64:67]
buffer_load_dwordx4 v3, s[20:23], s57 offen offset:3072 lds
v_exp_f32 v21, v21
v_add_f32 v20, 1.0, v20
v_mfma_f32_16x16x32_bf16 v[64:67], v[204:207], a[48:51], v[64:67]
s_lshr_b32 s86, s6, 1
s_add_u32 m0, s86, 148480
s_movk_i32 s57, 8192
ds_read_b64_tr_b16 v[210:211], v13 offset:26624
v_mfma_f32_16x16x32_bf16 v[68:71], v[192:195], a[4:7], v[24:27]
buffer_load_dwordx4 v164, s[16:19], 0 offen lds
v_add_f32 v21, 1.0, v21
v_rcp_f32 v20, v20
v_mfma_f32_16x16x32_bf16 v[68:71], v[196:199], a[20:23], v[68:71]
ds_read_b64_tr_b16 v[212:213], v13 offset:28672
v_rcp_f32 v21, v21
v_mfma_f32_16x16x32_bf16 v[68:71], v[200:203], a[36:39], v[68:71]
ds_read_b64_tr_b16 v[214:215], v13 offset:30720
v_mul_f32 v20, v20, v92
v_mul_f32 v21, v21, v93
v_mfma_f32_16x16x32_bf16 v[68:71], v[204:207], a[52:55], v[68:71]
buffer_load_dwordx4 v164, s[16:19], s57 offen offset:1024 lds
v_cvt_pk_bf16_f32 v118, v20, v21
v_fma_f32 v22, v94, -v94, s62
v_fma_f32 v23, v95, -v95, s62
v_mfma_f32_16x16x32_bf16 v[72:75], v[192:195], a[8:11], v[24:27]
ds_read_b64_tr_b16 v[216:217], v13 offset:32768
v_mul_f32 v22, v22, v94
v_mul_f32 v23, v23, v95
v_mfma_f32_16x16x32_bf16 v[72:75], v[196:199], a[24:27], v[72:75]
ds_read_b64_tr_b16 v[218:219], v13 offset:34816
v_exp_f32 v22, v22
v_mfma_f32_16x16x32_bf16 v[72:75], v[200:203], a[40:43], v[72:75]
ds_read_b64_tr_b16 v[220:221], v13 offset:36864
ds_read_b64_tr_b16 v[222:223], v13 offset:38912
v_exp_f32 v23, v23
v_mfma_f32_16x16x32_bf16 v[72:75], v[204:207], a[56:59], v[72:75]
v_add_f32 v22, 1.0, v22
v_add_f32 v23, 1.0, v23
v_rcp_f32 v22, v22
v_mfma_f32_16x16x32_bf16 v[76:79], v[192:195], a[12:15], v[24:27]
v_rcp_f32 v23, v23
v_mul_f32 v22, v22, v94
v_mfma_f32_16x16x32_bf16 v[76:79], v[196:199], a[28:31], v[76:79]
v_mul_f32 v23, v23, v95
v_cvt_pk_bf16_f32 v119, v22, v23
v_fma_f32 v20, v48, -v48, s62
v_fma_f32 v21, v49, -v49, s62
v_mfma_f32_16x16x32_bf16 v[76:79], v[200:203], a[44:47], v[76:79]
v_mul_f32 v20, v20, v48
v_mul_f32 v21, v21, v49
v_exp_f32 v20, v20
v_mfma_f32_16x16x32_bf16 v[76:79], v[204:207], a[60:63], v[76:79]
s_add_u32 m0, s6, 0
v_exp_f32 v21, v21
s_waitcnt vmcnt(18) lgkmcnt(0)
s_barrier
v_mfma_f32_16x16x32_bf16 v[64:67], v[208:211], a[64:67], v[64:67]
s_add_u32 s57, s81, 4129408
ds_read_b64_tr_b16 v[192:193], v13 offset:40960
v_add_f32 v20, 1.0, v20
v_mfma_f32_16x16x32_bf16 v[64:67], v[212:215], a[80:83], v[64:67]
buffer_load_dwordx4 v0, s[20:23], s57 offen offset:0 lds
v_add_f32 v21, 1.0, v21
v_rcp_f32 v20, v20
v_mfma_f32_16x16x32_bf16 v[64:67], v[216:219], a[96:99], v[64:67]
ds_read_b64_tr_b16 v[194:195], v13 offset:43008
v_rcp_f32 v21, v21
v_mul_f32 v20, v20, v48
v_mfma_f32_16x16x32_bf16 v[64:67], v[220:223], a[112:115], v[64:67]
buffer_load_dwordx4 v1, s[20:23], s57 offen offset:1024 lds
v_mul_f32 v21, v21, v49
v_cvt_pk_bf16_f32 v120, v20, v21
v_mfma_f32_16x16x32_bf16 v[68:71], v[208:211], a[68:71], v[68:71]
ds_read_b64_tr_b16 v[196:197], v13 offset:45056
v_fma_f32 v22, v50, -v50, s62
v_fma_f32 v23, v51, -v51, s62
v_mul_f32 v22, v22, v50
v_mfma_f32_16x16x32_bf16 v[68:71], v[212:215], a[84:87], v[68:71]
ds_read_b64_tr_b16 v[198:199], v13 offset:47104
v_mul_f32 v23, v23, v51
v_exp_f32 v22, v22
v_mfma_f32_16x16x32_bf16 v[68:71], v[216:219], a[100:103], v[68:71]
buffer_load_dwordx4 v2, s[20:23], s57 offen offset:2048 lds
v_exp_f32 v23, v23
v_mfma_f32_16x16x32_bf16 v[68:71], v[220:223], a[116:119], v[68:71]
ds_read_b64_tr_b16 v[200:201], v13 offset:49152
ds_read_b64_tr_b16 v[202:203], v13 offset:51200
v_add_f32 v22, 1.0, v22
v_mfma_f32_16x16x32_bf16 v[72:75], v[208:211], a[72:75], v[72:75]
buffer_load_dwordx4 v3, s[20:23], s57 offen offset:3072 lds
s_add_u32 m0, s6, 90112
v_add_f32 v23, 1.0, v23
v_mfma_f32_16x16x32_bf16 v[72:75], v[212:215], a[88:91], v[72:75]
s_add_u32 s58, s58, s81
s_lshr_b32 s58, s58, 1
s_sub_u32 s59, s58, 5308288
s_cmp_lt_u32 s3, 2
s_cselect_b32 s59, s58, s59
s_add_u32 s57, s58, 768
ds_read_b64_tr_b16 v[204:205], v13 offset:53248
ds_read_b64_tr_b16 v[206:207], v13 offset:55296
v_mfma_f32_16x16x32_bf16 v[72:75], v[216:219], a[104:107], v[72:75]
buffer_load_dwordx4 v0, s[20:23], s57 offen offset:0 lds
v_mfma_f32_16x16x32_bf16 v[72:75], v[220:223], a[120:123], v[72:75]
v_rcp_f32 v22, v22
v_rcp_f32 v23, v23
v_mfma_f32_16x16x32_bf16 v[76:79], v[208:211], a[76:79], v[76:79]
v_mul_f32 v22, v22, v50
v_mul_f32 v23, v23, v51
v_cvt_pk_bf16_f32 v121, v22, v23
v_mfma_f32_16x16x32_bf16 v[76:79], v[212:215], a[92:95], v[76:79]
buffer_load_dwordx4 v1, s[20:23], s57 offen offset:1024 lds
v_fma_f32 v20, v52, -v52, s62
v_fma_f32 v21, v53, -v53, s62
v_mfma_f32_16x16x32_bf16 v[76:79], v[216:219], a[108:111], v[76:79]
v_mul_f32 v20, v20, v52
v_mul_f32 v21, v21, v53
v_exp_f32 v20, v20
v_mfma_f32_16x16x32_bf16 v[76:79], v[220:223], a[124:127], v[76:79]
buffer_load_dwordx4 v2, s[20:23], s57 offen offset:2048 lds
v_exp_f32 v21, v21
s_waitcnt lgkmcnt(0)
v_mfma_f32_16x16x32_bf16 v[64:67], v[192:195], a[128:131], v[64:67]
v_add_f32 v20, 1.0, v20
v_add_f32 v21, 1.0, v21
v_rcp_f32 v20, v20
v_mfma_f32_16x16x32_bf16 v[64:67], v[196:199], a[144:147], v[64:67]
buffer_load_dwordx4 v3, s[20:23], s57 offen offset:3072 lds
v_rcp_f32 v21, v21
v_mfma_f32_16x16x32_bf16 v[64:67], v[200:203], a[160:163], v[64:67]
v_mul_f32 v20, v20, v52
v_mul_f32 v21, v21, v53
v_cvt_pk_bf16_f32 v122, v20, v21
v_fma_f32 v22, v54, -v54, s62
v_mfma_f32_16x16x32_bf16 v[64:67], v[204:207], a[176:179], v[64:67]
ds_read_b64_tr_b16 v[208:209], v13 offset:57344
v_fma_f32 v23, v55, -v55, s62
v_mul_f32 v22, v22, v54
v_mul_f32 v23, v23, v55
v_mfma_f32_16x16x32_bf16 v[68:71], v[192:195], a[132:135], v[68:71]
ds_read_b64_tr_b16 v[210:211], v13 offset:59392
v_exp_f32 v22, v22
v_mfma_f32_16x16x32_bf16 v[68:71], v[196:199], a[148:151], v[68:71]
ds_read_b64_tr_b16 v[212:213], v13 offset:61440
v_exp_f32 v23, v23
v_add_f32 v22, 1.0, v22
v_mfma_f32_16x16x32_bf16 v[68:71], v[200:203], a[164:167], v[68:71]
ds_read_b64_tr_b16 v[214:215], v13 offset:63488
v_add_f32 v23, 1.0, v23
v_rcp_f32 v22, v22
v_mfma_f32_16x16x32_bf16 v[68:71], v[204:207], a[180:183], v[68:71]
ds_read_b64_tr_b16 v[216:217], v14 offset:0
v_rcp_f32 v23, v23
v_mfma_f32_16x16x32_bf16 v[72:75], v[192:195], a[136:139], v[72:75]
ds_read_b64_tr_b16 v[218:219], v14 offset:2048
v_mul_f32 v22, v22, v54
v_mul_f32 v23, v23, v55
v_mfma_f32_16x16x32_bf16 v[72:75], v[196:199], a[152:155], v[72:75]
ds_read_b64_tr_b16 v[220:221], v14 offset:4096
v_cvt_pk_bf16_f32 v123, v22, v23
v_fma_f32 v20, v56, -v56, s62
v_fma_f32 v21, v57, -v57, s62
v_mfma_f32_16x16x32_bf16 v[72:75], v[200:203], a[168:171], v[72:75]
ds_read_b64_tr_b16 v[222:223], v14 offset:6144
v_mul_f32 v20, v20, v56
v_mul_f32 v21, v21, v57
v_mfma_f32_16x16x32_bf16 v[72:75], v[204:207], a[184:187], v[72:75]
v_exp_f32 v20, v20
v_exp_f32 v21, v21
v_mfma_f32_16x16x32_bf16 v[76:79], v[192:195], a[140:143], v[76:79]
v_add_f32 v20, 1.0, v20
v_add_f32 v21, 1.0, v21
v_rcp_f32 v20, v20
v_mfma_f32_16x16x32_bf16 v[76:79], v[196:199], a[156:159], v[76:79]
v_rcp_f32 v21, v21
v_mul_f32 v20, v20, v56
v_mfma_f32_16x16x32_bf16 v[76:79], v[200:203], a[172:175], v[76:79]
v_mul_f32 v21, v21, v57
v_cvt_pk_bf16_f32 v124, v20, v21
v_fma_f32 v22, v58, -v58, s62
v_fma_f32 v23, v59, -v59, s62
v_mfma_f32_16x16x32_bf16 v[76:79], v[204:207], a[188:191], v[76:79]
v_mul_f32 v22, v22, v58
v_mul_f32 v23, v23, v59
v_exp_f32 v22, v22
s_waitcnt vmcnt(22) lgkmcnt(0)
s_barrier
v_mfma_f32_16x16x32_bf16 v[64:67], v[208:211], a[192:195], v[64:67]
v_exp_f32 v23, v23
v_add_f32 v22, 1.0, v22
v_mfma_f32_16x16x32_bf16 v[64:67], v[212:215], a[208:211], v[64:67]
v_add_f32 v23, 1.0, v23
v_rcp_f32 v22, v22
v_mfma_f32_16x16x32_bf16 v[64:67], v[216:219], a[224:227], v[64:67]
v_rcp_f32 v23, v23
v_mul_f32 v22, v22, v58
v_mul_f32 v23, v23, v59
v_mfma_f32_16x16x32_bf16 v[64:67], v[220:223], a[240:243], v[64:67]
ds_read_b64_tr_b16 v[192:193], v12 offset:16384
v_cvt_pk_bf16_f32 v125, v22, v23
v_fma_f32 v20, v60, -v60, s62
v_fma_f32 v21, v61, -v61, s62
v_mfma_f32_16x16x32_bf16 v[68:71], v[208:211], a[196:199], v[68:71]
ds_read_b64_tr_b16 v[194:195], v12 offset:18432
v_mul_f32 v20, v20, v60
v_mul_f32 v21, v21, v61
v_mfma_f32_16x16x32_bf16 v[68:71], v[212:215], a[212:215], v[68:71]
ds_read_b64_tr_b16 v[196:197], v12 offset:20480
v_exp_f32 v20, v20
v_mfma_f32_16x16x32_bf16 v[68:71], v[216:219], a[228:231], v[68:71]
ds_read_b64_tr_b16 v[198:199], v12 offset:22528
v_exp_f32 v21, v21
v_add_f32 v20, 1.0, v20
v_mfma_f32_16x16x32_bf16 v[68:71], v[220:223], a[244:247], v[68:71]
ds_read_b64_tr_b16 v[200:201], v12 offset:24576
v_add_f32 v21, 1.0, v21
v_rcp_f32 v20, v20
v_mfma_f32_16x16x32_bf16 v[72:75], v[208:211], a[200:203], v[72:75]
ds_read_b64_tr_b16 v[202:203], v12 offset:26624
v_rcp_f32 v21, v21
v_mfma_f32_16x16x32_bf16 v[72:75], v[212:215], a[216:219], v[72:75]
ds_read_b64_tr_b16 v[204:205], v12 offset:28672
v_mul_f32 v20, v20, v60
v_mul_f32 v21, v21, v61
v_cvt_pk_bf16_f32 v126, v20, v21
v_mfma_f32_16x16x32_bf16 v[72:75], v[216:219], a[232:235], v[72:75]
ds_read_b64_tr_b16 v[206:207], v12 offset:30720
v_fma_f32 v22, v62, -v62, s62
v_fma_f32 v23, v63, -v63, s62
v_mfma_f32_16x16x32_bf16 v[72:75], v[220:223], a[248:251], v[72:75]
v_mul_f32 v22, v22, v62
v_mul_f32 v23, v23, v63
v_exp_f32 v22, v22
v_mfma_f32_16x16x32_bf16 v[76:79], v[208:211], a[204:207], v[76:79]
s_add_u32 m0, s6, 106496
v_exp_f32 v23, v23
v_mfma_f32_16x16x32_bf16 v[76:79], v[212:215], a[220:223], v[76:79]
s_add_u32 s57, s58, 1180416
ds_read_b128 v[28:31], v7 offset:1280
v_add_f32 v22, 1.0, v22
v_add_f32 v23, 1.0, v23
v_mfma_f32_16x16x32_bf16 v[76:79], v[216:219], a[236:239], v[76:79]
buffer_load_dwordx4 v0, s[20:23], s57 offen offset:0 lds
v_rcp_f32 v22, v22
v_mfma_f32_16x16x32_bf16 v[76:79], v[220:223], a[252:255], v[76:79]
v_rcp_f32 v23, v23
v_mul_f32 v22, v22, v62
v_mul_f32 v23, v23, v63
s_waitcnt vmcnt(9) lgkmcnt(0)
s_barrier
v_mfma_f32_16x16x32_bf16 v[64:67], v[192:195], v[224:227], v[64:67]
buffer_load_dwordx4 v1, s[20:23], s57 offen offset:1024 lds
v_cvt_pk_bf16_f32 v127, v22, v23
v_and_b32 v164, 15, v15
v_mul_u32_u24 v164, 4096, v164
v_mfma_f32_16x16x32_bf16 v[64:67], v[196:199], v[240:243], v[64:67]
ds_read_b64_tr_b16 v[208:209], v12 offset:32768
v_sub_u32 v165, 24, v17
v_lshl_add_u32 v165, v165, 1, v164
v_mfma_f32_16x16x32_bf16 v[68:71], v[192:195], v[228:231], v[68:71]
buffer_load_dwordx4 v2, s[20:23], s57 offen offset:2048 lds
v_and_b32 v164, 0x3000, v164
v_bfi_b32 v170, v15, 0, 60
s_lshl_b32 s72, s3, 30
v_mfma_f32_16x16x32_bf16 v[68:71], v[196:199], v[244:247], v[68:71]
ds_read_b64_tr_b16 v[210:211], v12 offset:34816
s_and_b32 s72, s72, 2147483648
v_lshl_add_u32 v164, v170, 1, v164
v_mfma_f32_16x16x32_bf16 v[72:75], v[192:195], v[232:235], v[72:75]
ds_read_b64_tr_b16 v[212:213], v12 offset:36864
v_or_b32 v164, s72, v164
s_lshl_b32 s72, s4, 7
s_sub_u32 s71, 4198272, s72
v_mfma_f32_16x16x32_bf16 v[72:75], v[196:199], v[248:251], v[72:75]
buffer_load_dwordx4 v3, s[20:23], s57 offen offset:3072 lds
s_add_u32 m0, s6, 16384
s_lshl2_add_u32 s72, s5, s3
v_mfma_f32_16x16x32_bf16 v[76:79], v[192:195], v[236:239], v[76:79]
s_add_u32 s57, s58, 2360064
ds_read_b64_tr_b16 v[214:215], v12 offset:38912
s_lshl_b32 s72, s72, 16
s_add_u32 s75, s72, s71
v_mfma_f32_16x16x32_bf16 v[76:79], v[196:199], v[252:255], v[76:79]
buffer_load_dwordx4 v0, s[20:23], s57 offen offset:0 lds
s_lshl1_add_u32 s72, s5, s3
s_lshl_b32 s72, s72, 14
s_add_u32 s72, s72, s71
v_mfma_f32_16x16x32_bf16 v[80:83], v[200:203], a[0:3], v[28:31]
ds_read_b64_tr_b16 v[216:217], v12 offset:40960
ds_read_b64_tr_b16 v[218:219], v12 offset:43008
s_add_u32 s43, s72, 2097152
v_mfma_f32_16x16x32_bf16 v[80:83], v[204:207], a[16:19], v[80:83]
buffer_load_dwordx4 v1, s[20:23], s57 offen offset:1024 lds
v_mul_u32_u24 v20, 52, v15
v_lshrrev_b32 v20, 8, v20
v_mul_u32_u24 v21, 5, v20
v_mfma_f32_16x16x32_bf16 v[84:87], v[200:203], a[4:7], v[28:31]
ds_read_b64_tr_b16 v[220:221], v12 offset:45056
ds_read_b64_tr_b16 v[222:223], v12 offset:47104
v_sub_u32 v21, v15, v21
v_mfma_f32_16x16x32_bf16 v[84:87], v[204:207], a[20:23], v[84:87]
ds_read_b64_tr_b16 v[136:137], v166 offset:9216
v_cmp_gt_u32 vcc, 5, v15
v_sub_u32 v22, 8, v20
v_mul_u32_u24 v21, 1152, v21
v_mfma_f32_16x16x32_bf16 v[88:91], v[200:203], a[8:11], v[28:31]
buffer_load_dwordx4 v2, s[20:23], s57 offen offset:2048 lds
v_xor_b32 v22, s5, v22
v_cndmask_b32 v22, v22, 8, vcc
v_mfma_f32_16x16x32_bf16 v[88:91], v[204:207], a[24:27], v[88:91]
ds_read_b64_tr_b16 v[138:139], v166 offset:9728
ds_read_b64_tr_b16 v[140:141], v166 offset:13312
v_lshl_add_u32 v182, v22, 7, v21
v_fma_f32 v20, v64, -v64, s62
v_mfma_f32_16x16x32_bf16 v[92:95], v[200:203], a[12:15], v[28:31]
buffer_load_dwordx4 v3, s[20:23], s57 offen offset:3072 lds
s_add_u32 m0, s6, 122880
v_fma_f32 v21, v65, -v65, s62
v_mul_f32 v20, v20, v64
v_mfma_f32_16x16x32_bf16 v[92:95], v[204:207], a[28:31], v[92:95]
s_add_u32 s57, s58, 3539712
ds_read_b64_tr_b16 v[142:143], v166 offset:13824
ds_read_b64_tr_b16 v[168:169], v167 offset:1088
v_mul_f32 v21, v21, v65
s_waitcnt lgkmcnt(0)
s_barrier
v_mfma_f32_16x16x32_bf16 v[80:83], v[208:211], a[32:35], v[80:83]
buffer_load_dwordx4 v0, s[20:23], s57 offen offset:0 lds
v_exp_f32 v20, v20
v_mfma_f32_16x16x32_bf16 v[80:83], v[212:215], a[48:51], v[80:83]
ds_read_b64_tr_b16 v[192:193], v12 offset:49152
v_exp_f32 v21, v21
v_add_f32 v20, 1.0, v20
v_mfma_f32_16x16x32_bf16 v[80:83], v[216:219], a[64:67], v[80:83]
buffer_load_dwordx4 v1, s[20:23], s57 offen offset:1024 lds
v_add_f32 v21, 1.0, v21
v_rcp_f32 v20, v20
v_mfma_f32_16x16x32_bf16 v[80:83], v[220:223], a[80:83], v[80:83]
ds_read_b64_tr_b16 v[194:195], v12 offset:51200
v_rcp_f32 v21, v21
v_mul_f32 v20, v20, v64
v_mfma_f32_16x16x32_bf16 v[84:87], v[208:211], a[36:39], v[84:87]
ds_read_b64_tr_b16 v[196:197], v12 offset:53248
v_mul_f32 v21, v21, v65
v_cvt_pk_bf16_f32 v128, v20, v21
v_mfma_f32_16x16x32_bf16 v[84:87], v[212:215], a[52:55], v[84:87]
buffer_load_dwordx4 v2, s[20:23], s57 offen offset:2048 lds
v_lshlrev_b32 v170, 16, v136
v_and_b32 v171, s64, v136
v_mul_f32 v144, v144, v170
v_mfma_f32_16x16x32_bf16 v[84:87], v[216:219], a[68:71], v[84:87]
ds_read_b64_tr_b16 v[198:199], v12 offset:55296
v_mul_f32 v145, v145, v171
v_lshlrev_b32 v170, 16, v137
v_and_b32 v171, s64, v137
v_mfma_f32_16x16x32_bf16 v[84:87], v[220:223], a[84:87], v[84:87]
buffer_load_dwordx4 v3, s[20:23], s57 offen offset:3072 lds
s_add_u32 m0, s6, 32768
v_mul_f32 v146, v146, v170
v_mul_f32 v147, v147, v171
v_mfma_f32_16x16x32_bf16 v[88:91], v[208:211], a[40:43], v[88:91]
s_add_u32 s57, s59, 4719360
ds_read_b64_tr_b16 v[200:201], v12 offset:57344
ds_read_b64_tr_b16 v[202:203], v12 offset:59392
v_lshlrev_b32 v170, 16, v138
v_mfma_f32_16x16x32_bf16 v[88:91], v[212:215], a[56:59], v[88:91]
buffer_load_dwordx4 v0, s[20:23], s57 offen offset:0 lds
v_and_b32 v171, s64, v138
v_mul_f32 v148, v148, v170
v_mul_f32 v149, v149, v171
v_mfma_f32_16x16x32_bf16 v[88:91], v[216:219], a[72:75], v[88:91]
ds_read_b64_tr_b16 v[204:205], v12 offset:61440
ds_read_b64_tr_b16 v[206:207], v12 offset:63488
v_lshlrev_b32 v170, 16, v139
v_and_b32 v171, s64, v139
v_mfma_f32_16x16x32_bf16 v[88:91], v[220:223], a[88:91], v[88:91]
v_mul_f32 v150, v150, v170
v_mul_f32 v151, v151, v171
v_cvt_pk_bf16_f32 v136, v151, v150
v_cvt_pk_bf16_f32 v137, v149, v148
v_mfma_f32_16x16x32_bf16 v[92:95], v[208:211], a[44:47], v[92:95]
buffer_load_dwordx4 v1, s[20:23], s57 offen offset:1024 lds
v_cvt_pk_bf16_f32 v138, v147, v146
v_cvt_pk_bf16_f32 v139, v145, v144
v_mfma_f32_16x16x32_bf16 v[92:95], v[212:215], a[60:63], v[92:95]
buffer_store_dwordx4 v[136:139], v165, s[28:31], s75 offen offset:64 sc1
v_lshlrev_b32 v170, 16, v140
v_and_b32 v171, s64, v140
v_mul_f32 v152, v152, v170
v_mul_f32 v153, v153, v171
v_mfma_f32_16x16x32_bf16 v[92:95], v[216:219], a[76:79], v[92:95]
buffer_load_dwordx4 v2, s[20:23], s57 offen offset:2048 lds
v_lshlrev_b32 v170, 16, v141
v_and_b32 v171, s64, v141
v_mfma_f32_16x16x32_bf16 v[92:95], v[220:223], a[92:95], v[92:95]
v_mul_f32 v154, v154, v170
v_mul_f32 v155, v155, v171
v_lshlrev_b32 v170, 16, v142
v_and_b32 v171, s64, v142
s_waitcnt lgkmcnt(0)
v_mfma_f32_16x16x32_bf16 v[80:83], v[192:195], a[96:99], v[80:83]
buffer_load_dwordx4 v3, s[20:23], s57 offen offset:3072 lds
s_add_u32 m0, s6, 139264
v_mul_f32 v156, v156, v170
v_mul_f32 v157, v157, v171
v_mfma_f32_16x16x32_bf16 v[80:83], v[196:199], a[112:115], v[80:83]
s_add_u32 s57, s58, 590720
ds_read_b64_tr_b16 v[208:209], v13 offset:8192
v_lshlrev_b32 v170, 16, v143
v_and_b32 v171, s64, v143
v_mfma_f32_16x16x32_bf16 v[80:83], v[200:203], a[128:131], v[80:83]
buffer_load_dwordx4 v0, s[20:23], s57 offen offset:0 lds
v_mul_f32 v158, v158, v170
v_mul_f32 v159, v159, v171
v_cvt_pk_bf16_f32 v140, v159, v158
v_mfma_f32_16x16x32_bf16 v[80:83], v[204:207], a[144:147], v[80:83]
ds_read_b64_tr_b16 v[210:211], v13 offset:10240
v_cvt_pk_bf16_f32 v141, v157, v156
v_cvt_pk_bf16_f32 v142, v155, v154
v_cvt_pk_bf16_f32 v143, v153, v152
v_mfma_f32_16x16x32_bf16 v[84:87], v[192:195], a[100:103], v[84:87]
ds_read_b64_tr_b16 v[212:213], v13 offset:12288
v_mfma_f32_16x16x32_bf16 v[84:87], v[196:199], a[116:119], v[84:87]
buffer_load_dwordx4 v1, s[20:23], s57 offen offset:1024 lds
buffer_store_dwordx4 v[140:143], v165, s[28:31], s75 offen offset:0 sc1
v_lshlrev_b32 v170, 16, v168
v_and_b32 v171, s64, v168
v_mul_f32 v160, v160, v170
v_mul_f32 v161, v161, v171
v_mfma_f32_16x16x32_bf16 v[84:87], v[200:203], a[132:135], v[84:87]
ds_read_b64_tr_b16 v[214:215], v13 offset:14336
v_lshlrev_b32 v170, 16, v169
v_and_b32 v171, s64, v169
v_mfma_f32_16x16x32_bf16 v[84:87], v[204:207], a[148:151], v[84:87]
buffer_load_dwordx4 v2, s[20:23], s57 offen offset:2048 lds
v_mul_f32 v162, v162, v170
v_mul_f32 v163, v163, v171
v_cvt_pk_bf16_f32 v168, v163, v162
v_cvt_pk_bf16_f32 v169, v161, v160
buffer_store_dwordx2 v[168:169], v164, s[28:31], s43 offen sc1
v_mfma_f32_16x16x32_bf16 v[88:91], v[192:195], a[104:107], v[88:91]
s_branch SK4
.p2align 12
PAD4:
s_branch PAD8
SK4:
ds_read_b64_tr_b16 v[216:217], v13 offset:16384
ds_read_b64_tr_b16 v[218:219], v13 offset:18432
v_mfma_f32_16x16x32_bf16 v[88:91], v[196:199], a[120:123], v[88:91]
buffer_load_dwordx4 v3, s[20:23], s57 offen offset:3072 lds
v_fma_f32 v22, v66, -v66, s62
v_fma_f32 v23, v67, -v67, s62
v_mfma_f32_16x16x32_bf16 v[88:91], v[200:203], a[136:139], v[88:91]
ds_read_b64_tr_b16 v[220:221], v13 offset:20480
ds_read_b64_tr_b16 v[222:223], v13 offset:22528
v_mul_f32 v22, v22, v66
v_mfma_f32_16x16x32_bf16 v[88:91], v[204:207], a[152:155], v[88:91]
v_mul_f32 v23, v23, v67
v_exp_f32 v22, v22
v_mfma_f32_16x16x32_bf16 v[92:95], v[192:195], a[108:111], v[92:95]
v_exp_f32 v23, v23
v_add_f32 v22, 1.0, v22
v_add_f32 v23, 1.0, v23
v_mfma_f32_16x16x32_bf16 v[92:95], v[196:199], a[124:127], v[92:95]
v_rcp_f32 v22, v22
v_rcp_f32 v23, v23
v_mfma_f32_16x16x32_bf16 v[92:95], v[200:203], a[140:143], v[92:95]
v_mul_f32 v22, v22, v66
v_mul_f32 v23, v23, v67
v_cvt_pk_bf16_f32 v129, v22, v23
v_mfma_f32_16x16x32_bf16 v[92:95], v[204:207], a[156:159], v[92:95]
s_add_u32 m0, s6, 49152
v_fma_f32 v20, v68, -v68, s62
v_fma_f32 v21, v69, -v69, s62
v_mul_f32 v20, v20, v68
s_waitcnt vmcnt(23) lgkmcnt(0)
s_barrier
v_mfma_f32_16x16x32_bf16 v[80:83], v[208:211], a[160:163], v[80:83]
s_add_u32 s57, s58, 1770368
ds_read_b64_tr_b16 v[192:193], v12 offset:0
v_mul_f32 v21, v21, v69
v_mfma_f32_16x16x32_bf16 v[80:83], v[212:215], a[176:179], v[80:83]
buffer_load_dwordx4 v0, s[20:23], s57 offen offset:0 lds
v_exp_f32 v20, v20
v_mfma_f32_16x16x32_bf16 v[80:83], v[216:219], a[192:195], v[80:83]
ds_read_b64_tr_b16 v[194:195], v12 offset:2048
v_exp_f32 v21, v21
v_add_f32 v20, 1.0, v20
v_mfma_f32_16x16x32_bf16 v[80:83], v[220:223], a[208:211], v[80:83]
buffer_load_dwordx4 v1, s[20:23], s57 offen offset:1024 lds
v_add_f32 v21, 1.0, v21
v_rcp_f32 v20, v20
v_mfma_f32_16x16x32_bf16 v[84:87], v[208:211], a[164:167], v[84:87]
ds_read_b64_tr_b16 v[196:197], v12 offset:4096
v_rcp_f32 v21, v21
v_mfma_f32_16x16x32_bf16 v[84:87], v[212:215], a[180:183], v[84:87]
ds_read_b64_tr_b16 v[198:199], v12 offset:6144
v_mul_f32 v20, v20, v68
v_mul_f32 v21, v21, v69
v_cvt_pk_bf16_f32 v130, v20, v21
v_mfma_f32_16x16x32_bf16 v[84:87], v[216:219], a[196:199], v[84:87]
buffer_load_dwordx4 v2, s[20:23], s57 offen offset:2048 lds
v_fma_f32 v22, v70, -v70, s62
v_fma_f32 v23, v71, -v71, s62
v_mfma_f32_16x16x32_bf16 v[84:87], v[220:223], a[212:215], v[84:87]
ds_read_b64_tr_b16 v[200:201], v12 offset:8192
ds_read_b64_tr_b16 v[202:203], v12 offset:10240
v_mul_f32 v22, v22, v70
v_mul_f32 v23, v23, v71
v_mfma_f32_16x16x32_bf16 v[88:91], v[208:211], a[168:171], v[88:91]
buffer_load_dwordx4 v3, s[20:23], s57 offen offset:3072 lds
s_add_u32 m0, s6, 73728
v_exp_f32 v22, v22
v_mfma_f32_16x16x32_bf16 v[88:91], v[212:215], a[184:187], v[88:91]
s_add_u32 s57, s58, 2950016
ds_read_b64_tr_b16 v[204:205], v12 offset:12288
ds_read_b64_tr_b16 v[206:207], v12 offset:14336
v_mfma_f32_16x16x32_bf16 v[88:91], v[216:219], a[200:203], v[88:91]
buffer_load_dwordx4 v0, s[20:23], s57 offen offset:0 lds
v_exp_f32 v23, v23
v_mfma_f32_16x16x32_bf16 v[88:91], v[220:223], a[216:219], v[88:91]
v_add_f32 v22, 1.0, v22
v_add_f32 v23, 1.0, v23
v_rcp_f32 v22, v22
v_mfma_f32_16x16x32_bf16 v[92:95], v[208:211], a[172:175], v[92:95]
v_rcp_f32 v23, v23
v_mul_f32 v22, v22, v70
v_mfma_f32_16x16x32_bf16 v[92:95], v[212:215], a[188:191], v[92:95]
buffer_load_dwordx4 v1, s[20:23], s57 offen offset:1024 lds
v_mul_f32 v23, v23, v71
v_cvt_pk_bf16_f32 v131, v22, v23
v_fma_f32 v20, v72, -v72, s62
v_mfma_f32_16x16x32_bf16 v[92:95], v[216:219], a[204:207], v[92:95]
v_fma_f32 v21, v73, -v73, s62
v_mul_f32 v20, v20, v72
v_mul_f32 v21, v21, v73
v_mfma_f32_16x16x32_bf16 v[92:95], v[220:223], a[220:223], v[92:95]
buffer_load_dwordx4 v2, s[20:23], s57 offen offset:2048 lds
v_exp_f32 v20, v20
v_exp_f32 v21, v21
s_waitcnt lgkmcnt(0)
v_mfma_f32_16x16x32_bf16 v[80:83], v[192:195], a[224:227], v[80:83]
v_add_f32 v20, 1.0, v20
v_add_f32 v21, 1.0, v21
v_mfma_f32_16x16x32_bf16 v[80:83], v[196:199], a[240:243], v[80:83]
buffer_load_dwordx4 v3, s[20:23], s57 offen offset:3072 lds
v_rcp_f32 v20, v20
v_rcp_f32 v21, v21
v_mfma_f32_16x16x32_bf16 v[80:83], v[200:203], v[224:227], v[80:83]
ds_read_b64_tr_b16 v[208:209], v13 offset:24576
v_mul_f32 v20, v20, v72
v_mul_f32 v21, v21, v73
v_mfma_f32_16x16x32_bf16 v[80:83], v[204:207], v[240:243], v[80:83]
s_mov_b32 exec_lo, 0x7fff
s_mov_b32 exec_hi, 0x0
buffer_load_dword v183, v182, s[24:27], s42 offen
s_mov_b64 exec, -1
v_mfma_f32_16x16x32_bf16 v[84:87], v[192:195], a[228:231], v[84:87]
ds_read_b64_tr_b16 v[210:211], v13 offset:26624
v_cvt_pk_bf16_f32 v132, v20, v21
v_fma_f32 v22, v74, -v74, s62
v_mfma_f32_16x16x32_bf16 v[84:87], v[196:199], a[244:247], v[84:87]
ds_read_b64_tr_b16 v[212:213], v13 offset:28672
v_fma_f32 v23, v75, -v75, s62
v_mul_f32 v22, v22, v74
v_mfma_f32_16x16x32_bf16 v[84:87], v[200:203], v[228:231], v[84:87]
ds_read_b64_tr_b16 v[214:215], v13 offset:30720
v_mul_f32 v23, v23, v75
v_exp_f32 v22, v22
v_mfma_f32_16x16x32_bf16 v[84:87], v[204:207], v[244:247], v[84:87]
ds_read_b64_tr_b16 v[216:217], v13 offset:32768
v_exp_f32 v23, v23
v_mfma_f32_16x16x32_bf16 v[88:91], v[192:195], a[232:235], v[88:91]
ds_read_b64_tr_b16 v[218:219], v13 offset:34816
v_add_f32 v22, 1.0, v22
v_add_f32 v23, 1.0, v23
v_mfma_f32_16x16x32_bf16 v[88:91], v[196:199], a[248:251], v[88:91]
ds_read_b64_tr_b16 v[220:221], v13 offset:36864
v_rcp_f32 v22, v22
v_rcp_f32 v23, v23
v_mfma_f32_16x16x32_bf16 v[88:91], v[200:203], v[232:235], v[88:91]
ds_read_b64_tr_b16 v[222:223], v13 offset:38912
v_mul_f32 v22, v22, v74
v_mul_f32 v23, v23, v75
v_mfma_f32_16x16x32_bf16 v[88:91], v[204:207], v[248:251], v[88:91]
v_cvt_pk_bf16_f32 v133, v22, v23
v_fma_f32 v20, v76, -v76, s62
v_fma_f32 v21, v77, -v77, s62
v_mfma_f32_16x16x32_bf16 v[92:95], v[192:195], a[236:239], v[92:95]
v_mul_f32 v20, v20, v76
v_mul_f32 v21, v21, v77
v_exp_f32 v20, v20
v_mfma_f32_16x16x32_bf16 v[92:95], v[196:199], a[252:255], v[92:95]
ds_read_b128 v[24:27], v7 offset:1536
v_exp_f32 v21, v21
v_mfma_f32_16x16x32_bf16 v[92:95], v[200:203], v[236:239], v[92:95]
v_add_f32 v20, 1.0, v20
v_add_f32 v21, 1.0, v21
v_rcp_f32 v20, v20
v_mfma_f32_16x16x32_bf16 v[92:95], v[204:207], v[252:255], v[92:95]
s_add_u32 m0, s6, 0
v_rcp_f32 v21, v21
s_waitcnt vmcnt(10) lgkmcnt(0)
s_barrier
v_mfma_f32_16x16x32_bf16 v[48:51], v[208:211], a[0:3], v[24:27]
s_add_u32 s57, s58, 4129664
ds_read_b64_tr_b16 v[192:193], v13 offset:40960
v_mul_f32 v20, v20, v76
v_mul_f32 v21, v21, v77
v_mfma_f32_16x16x32_bf16 v[48:51], v[212:215], a[16:19], v[48:51]
buffer_load_dwordx4 v0, s[20:23], s57 offen offset:0 lds
v_cvt_pk_bf16_f32 v134, v20, v21
v_mov_b32 v168, s7
v_mfma_f32_16x16x32_bf16 v[48:51], v[216:219], a[32:35], v[48:51]
ds_read_b64_tr_b16 v[194:195], v13 offset:43008
s_lshl_b32 s70, s4, 3
s_add_u32 s70, s70, s5
s_lshl_b32 s70, s70, 2
v_mfma_f32_16x16x32_bf16 v[48:51], v[220:223], a[48:51], v[48:51]
buffer_load_dwordx4 v1, s[20:23], s57 offen offset:1024 lds
v_mfma_f32_16x16x32_bf16 v[52:55], v[208:211], a[4:7], v[24:27]
ds_read_b64_tr_b16 v[196:197], v13 offset:45056
buffer_store_dword v168, v19, s[28:31], s70 offen offset:1024 sc1
v_fma_f32 v22, v78, -v78, s62
v_fma_f32 v23, v79, -v79, s62
v_mfma_f32_16x16x32_bf16 v[52:55], v[212:215], a[20:23], v[52:55]
ds_read_b64_tr_b16 v[198:199], v13 offset:47104
v_mul_f32 v22, v22, v78
v_mul_f32 v23, v23, v79
v_mfma_f32_16x16x32_bf16 v[52:55], v[216:219], a[36:39], v[52:55]
buffer_load_dwordx4 v2, s[20:23], s57 offen offset:2048 lds
v_exp_f32 v22, v22
v_exp_f32 v23, v23
v_mfma_f32_16x16x32_bf16 v[52:55], v[220:223], a[52:55], v[52:55]
ds_read_b64_tr_b16 v[200:201], v13 offset:49152
ds_read_b64_tr_b16 v[202:203], v13 offset:51200
v_add_f32 v22, 1.0, v22
v_mfma_f32_16x16x32_bf16 v[56:59], v[208:211], a[8:11], v[24:27]
buffer_load_dwordx4 v3, s[20:23], s57 offen offset:3072 lds
s_add_u32 m0, s6, 90112
v_add_f32 v23, 1.0, v23
v_mfma_f32_16x16x32_bf16 v[56:59], v[212:215], a[24:27], v[56:59]
s_add_u32 s57, s58, 1024
ds_read_b64_tr_b16 v[204:205], v13 offset:53248
ds_read_b64_tr_b16 v[206:207], v13 offset:55296
v_mfma_f32_16x16x32_bf16 v[56:59], v[216:219], a[40:43], v[56:59]
buffer_load_dwordx4 v0, s[20:23], s57 offen offset:0 lds
v_rcp_f32 v22, v22
v_rcp_f32 v23, v23
v_mfma_f32_16x16x32_bf16 v[56:59], v[220:223], a[56:59], v[56:59]
v_mul_f32 v22, v22, v78
v_mul_f32 v23, v23, v79
v_cvt_pk_bf16_f32 v135, v22, v23
v_mfma_f32_16x16x32_bf16 v[60:63], v[208:211], a[12:15], v[24:27]
s_bfe_u32 s70, s4, 0x10002
v_lshl_add_u32 v166, s70, 13, v6
v_xor_b32 v167, 0x2000, v166
v_mfma_f32_16x16x32_bf16 v[60:63], v[212:215], a[28:31], v[60:63]
buffer_load_dwordx4 v1, s[20:23], s57 offen offset:1024 lds
v_fma_f32 v20, v80, -v80, s62
v_fma_f32 v21, v81, -v81, s62
v_mul_f32 v20, v20, v80
v_mfma_f32_16x16x32_bf16 v[60:63], v[216:219], a[44:47], v[60:63]
v_mul_f32 v21, v21, v81
v_exp_f32 v20, v20
v_mfma_f32_16x16x32_bf16 v[60:63], v[220:223], a[60:63], v[60:63]
buffer_load_dwordx4 v2, s[20:23], s57 offen offset:2048 lds
v_exp_f32 v21, v21
v_add_f32 v20, 1.0, v20
s_waitcnt lgkmcnt(0)
v_mfma_f32_16x16x32_bf16 v[48:51], v[192:195], a[64:67], v[48:51]
v_add_f32 v21, 1.0, v21
v_rcp_f32 v20, v20
v_mfma_f32_16x16x32_bf16 v[48:51], v[196:199], a[80:83], v[48:51]
buffer_load_dwordx4 v3, s[20:23], s57 offen offset:3072 lds
v_rcp_f32 v21, v21
v_mul_f32 v20, v20, v80
v_mfma_f32_16x16x32_bf16 v[48:51], v[200:203], a[96:99], v[48:51]
v_mul_f32 v21, v21, v81
v_cvt_pk_bf16_f32 v136, v20, v21
v_fma_f32 v22, v82, -v82, s62
v_mfma_f32_16x16x32_bf16 v[48:51], v[204:207], a[112:115], v[48:51]
ds_read_b64_tr_b16 v[208:209], v12 offset:16384
v_fma_f32 v23, v83, -v83, s62
v_mul_f32 v22, v22, v82
v_mul_f32 v23, v23, v83
v_mfma_f32_16x16x32_bf16 v[52:55], v[192:195], a[68:71], v[52:55]
ds_read_b64_tr_b16 v[210:211], v12 offset:18432
v_exp_f32 v22, v22
v_mfma_f32_16x16x32_bf16 v[52:55], v[196:199], a[84:87], v[52:55]
ds_read_b64_tr_b16 v[212:213], v12 offset:20480
v_exp_f32 v23, v23
v_add_f32 v22, 1.0, v22
v_mfma_f32_16x16x32_bf16 v[52:55], v[200:203], a[100:103], v[52:55]
ds_read_b64_tr_b16 v[214:215], v12 offset:22528
v_add_f32 v23, 1.0, v23
v_rcp_f32 v22, v22
v_mfma_f32_16x16x32_bf16 v[52:55], v[204:207], a[116:119], v[52:55]
ds_read_b64_tr_b16 v[216:217], v12 offset:24576
v_rcp_f32 v23, v23
v_mfma_f32_16x16x32_bf16 v[56:59], v[192:195], a[72:75], v[56:59]
ds_read_b64_tr_b16 v[218:219], v12 offset:26624
v_mul_f32 v22, v22, v82
v_mul_f32 v23, v23, v83
v_cvt_pk_bf16_f32 v137, v22, v23
v_mfma_f32_16x16x32_bf16 v[56:59], v[196:199], a[88:91], v[56:59]
ds_read_b64_tr_b16 v[220:221], v12 offset:28672
v_fma_f32 v20, v84, -v84, s62
v_fma_f32 v21, v85, -v85, s62
v_mfma_f32_16x16x32_bf16 v[56:59], v[200:203], a[104:107], v[56:59]
ds_read_b64_tr_b16 v[222:223], v12 offset:30720
v_mul_f32 v20, v20, v84
v_mul_f32 v21, v21, v85
v_mfma_f32_16x16x32_bf16 v[56:59], v[204:207], a[120:123], v[56:59]
v_exp_f32 v20, v20
v_exp_f32 v21, v21
v_mfma_f32_16x16x32_bf16 v[60:63], v[192:195], a[76:79], v[60:63]
v_add_f32 v20, 1.0, v20
v_add_f32 v21, 1.0, v21
v_rcp_f32 v20, v20
v_mfma_f32_16x16x32_bf16 v[60:63], v[196:199], a[92:95], v[60:63]
v_rcp_f32 v21, v21
v_mul_f32 v20, v20, v84
v_mfma_f32_16x16x32_bf16 v[60:63], v[200:203], a[108:111], v[60:63]
v_mul_f32 v21, v21, v85
v_cvt_pk_bf16_f32 v138, v20, v21
v_fma_f32 v22, v86, -v86, s62
v_fma_f32 v23, v87, -v87, s62
v_mfma_f32_16x16x32_bf16 v[60:63], v[204:207], a[124:127], v[60:63]
s_add_u32 m0, s6, 106496
v_mul_f32 v22, v22, v86
v_mul_f32 v23, v23, v87
s_waitcnt lgkmcnt(0)
s_barrier
v_mfma_f32_16x16x32_bf16 v[48:51], v[208:211], a[128:131], v[48:51]
s_add_u32 s57, s58, 1180672
v_exp_f32 v22, v22
v_mfma_f32_16x16x32_bf16 v[48:51], v[212:215], a[144:147], v[48:51]
buffer_load_dwordx4 v0, s[20:23], s57 offen offset:0 lds
v_exp_f32 v23, v23
v_add_f32 v22, 1.0, v22
v_mfma_f32_16x16x32_bf16 v[48:51], v[216:219], a[160:163], v[48:51]
v_add_f32 v23, 1.0, v23
v_rcp_f32 v22, v22
v_mfma_f32_16x16x32_bf16 v[48:51], v[220:223], a[176:179], v[48:51]
ds_read_b64_tr_b16 v[192:193], v13 offset:57344
v_rcp_f32 v23, v23
v_mul_f32 v22, v22, v86
v_mfma_f32_16x16x32_bf16 v[52:55], v[208:211], a[132:135], v[52:55]
ds_read_b64_tr_b16 v[194:195], v13 offset:59392
v_mul_f32 v23, v23, v87
v_cvt_pk_bf16_f32 v139, v22, v23
v_fma_f32 v20, v88, -v88, s62
v_mfma_f32_16x16x32_bf16 v[52:55], v[212:215], a[148:151], v[52:55]
ds_read_b64_tr_b16 v[196:197], v13 offset:61440
v_fma_f32 v21, v89, -v89, s62
v_mul_f32 v20, v20, v88
v_mfma_f32_16x16x32_bf16 v[52:55], v[216:219], a[164:167], v[52:55]
ds_read_b64_tr_b16 v[198:199], v13 offset:63488
v_mul_f32 v21, v21, v89
v_exp_f32 v20, v20
v_mfma_f32_16x16x32_bf16 v[52:55], v[220:223], a[180:183], v[52:55]
ds_read_b64_tr_b16 v[200:201], v14 offset:0
v_exp_f32 v21, v21
v_mfma_f32_16x16x32_bf16 v[56:59], v[208:211], a[136:139], v[56:59]
ds_read_b64_tr_b16 v[202:203], v14 offset:2048
v_add_f32 v20, 1.0, v20
v_add_f32 v21, 1.0, v21
v_mfma_f32_16x16x32_bf16 v[56:59], v[212:215], a[152:155], v[56:59]
ds_read_b64_tr_b16 v[204:205], v14 offset:4096
v_rcp_f32 v20, v20
v_rcp_f32 v21, v21
v_mfma_f32_16x16x32_bf16 v[56:59], v[216:219], a[168:171], v[56:59]
ds_read_b64_tr_b16 v[206:207], v14 offset:6144
v_mul_f32 v20, v20, v88
v_mul_f32 v21, v21, v89
v_mfma_f32_16x16x32_bf16 v[56:59], v[220:223], a[184:187], v[56:59]
v_cvt_pk_bf16_f32 v140, v20, v21
v_fma_f32 v22, v90, -v90, s62
v_fma_f32 v23, v91, -v91, s62
v_mfma_f32_16x16x32_bf16 v[60:63], v[208:211], a[140:143], v[60:63]
v_mul_f32 v22, v22, v90
v_mul_f32 v23, v23, v91
v_exp_f32 v22, v22
v_mfma_f32_16x16x32_bf16 v[60:63], v[212:215], a[156:159], v[60:63]
buffer_load_dwordx4 v1, s[20:23], s57 offen offset:1024 lds
v_exp_f32 v23, v23
v_mfma_f32_16x16x32_bf16 v[60:63], v[216:219], a[172:175], v[60:63]
v_add_f32 v22, 1.0, v22
v_add_f32 v23, 1.0, v23
v_rcp_f32 v22, v22
v_mfma_f32_16x16x32_bf16 v[60:63], v[220:223], a[188:191], v[60:63]
buffer_load_dwordx4 v2, s[20:23], s57 offen offset:2048 lds
v_rcp_f32 v23, v23
s_waitcnt lgkmcnt(0)
v_mfma_f32_16x16x32_bf16 v[48:51], v[192:195], a[192:195], v[48:51]
v_mul_f32 v22, v22, v90
v_mul_f32 v23, v23, v91
v_cvt_pk_bf16_f32 v141, v22, v23
v_fma_f32 v20, v92, -v92, s62
v_mfma_f32_16x16x32_bf16 v[48:51], v[196:199], a[208:211], v[48:51]
ds_read_b64_tr_b16 v[208:209], v12 offset:32768
v_fma_f32 v21, v93, -v93, s62
v_mul_f32 v20, v20, v92
v_mfma_f32_16x16x32_bf16 v[48:51], v[200:203], a[224:227], v[48:51]
buffer_load_dwordx4 v3, s[20:23], s57 offen offset:3072 lds
v_mul_f32 v21, v21, v93
v_exp_f32 v20, v20
v_mfma_f32_16x16x32_bf16 v[48:51], v[204:207], a[240:243], v[48:51]
ds_read_b64_tr_b16 v[210:211], v12 offset:34816
v_exp_f32 v21, v21
v_add_f32 v20, 1.0, v20
v_mfma_f32_16x16x32_bf16 v[52:55], v[192:195], a[196:199], v[52:55]
s_mov_b32 exec_lo, 0xfff00000
s_mov_b32 exec_hi, 0x7
buffer_load_dword v183, v182, s[24:27], s42 offen
s_mov_b64 exec, -1
v_mfma_f32_16x16x32_bf16 v[52:55], v[196:199], a[212:215], v[52:55]
ds_read_b64_tr_b16 v[212:213], v12 offset:36864
v_add_f32 v21, 1.0, v21
v_mfma_f32_16x16x32_bf16 v[52:55], v[200:203], a[228:231], v[52:55]
ds_read_b64_tr_b16 v[214:215], v12 offset:38912
v_rcp_f32 v20, v20
v_rcp_f32 v21, v21
v_mfma_f32_16x16x32_bf16 v[52:55], v[204:207], a[244:247], v[52:55]
ds_read_b64_tr_b16 v[216:217], v12 offset:40960
v_mul_f32 v20, v20, v92
v_mul_f32 v21, v21, v93
v_mfma_f32_16x16x32_bf16 v[56:59], v[192:195], a[200:203], v[56:59]
ds_read_b64_tr_b16 v[218:219], v12 offset:43008
v_cvt_pk_bf16_f32 v142, v20, v21
v_fma_f32 v22, v94, -v94, s62
v_mfma_f32_16x16x32_bf16 v[56:59], v[196:199], a[216:219], v[56:59]
ds_read_b64_tr_b16 v[220:221], v12 offset:45056
v_fma_f32 v23, v95, -v95, s62
v_mul_f32 v22, v22, v94
v_mul_f32 v23, v23, v95
v_mfma_f32_16x16x32_bf16 v[56:59], v[200:203], a[232:235], v[56:59]
ds_read_b64_tr_b16 v[222:223], v12 offset:47104
v_exp_f32 v22, v22
v_mfma_f32_16x16x32_bf16 v[56:59], v[204:207], a[248:251], v[56:59]
v_exp_f32 v23, v23
v_add_f32 v22, 1.0, v22
v_add_f32 v23, 1.0, v23
v_mfma_f32_16x16x32_bf16 v[60:63], v[192:195], a[204:207], v[60:63]
v_rcp_f32 v22, v22
v_rcp_f32 v23, v23
v_mfma_f32_16x16x32_bf16 v[60:63], v[196:199], a[220:223], v[60:63]
ds_read_b128 v[28:31], v7 offset:1792
v_mul_f32 v22, v22, v94
v_mul_f32 v23, v23, v95
v_mfma_f32_16x16x32_bf16 v[60:63], v[200:203], a[236:239], v[60:63]
v_cvt_pk_bf16_f32 v143, v22, v23
v_mfma_f32_16x16x32_bf16 v[60:63], v[204:207], a[252:255], v[60:63]
s_add_u32 m0, s6, 122880
s_waitcnt vmcnt(19) lgkmcnt(0)
s_barrier
v_mfma_f32_16x16x32_bf16 v[48:51], v[208:211], v[224:227], v[48:51]
s_add_u32 s57, s58, 2360320
ds_read_b64_tr_b16 v[192:193], v14 offset:8192
v_mfma_f32_16x16x32_bf16 v[48:51], v[212:215], v[240:243], v[48:51]
buffer_load_dwordx4 v0, s[20:23], s57 offen offset:0 lds
v_mfma_f32_16x16x32_bf16 v[52:55], v[208:211], v[228:231], v[52:55]
ds_read_b64_tr_b16 v[194:195], v14 offset:10240
v_mfma_f32_16x16x32_bf16 v[52:55], v[212:215], v[244:247], v[52:55]
buffer_load_dwordx4 v1, s[20:23], s57 offen offset:1024 lds
v_mfma_f32_16x16x32_bf16 v[56:59], v[208:211], v[232:235], v[56:59]
ds_read_b64_tr_b16 v[196:197], v14 offset:12288
v_mfma_f32_16x16x32_bf16 v[56:59], v[212:215], v[248:251], v[56:59]
ds_read_b64_tr_b16 v[198:199], v14 offset:14336
v_mfma_f32_16x16x32_bf16 v[60:63], v[208:211], v[236:239], v[60:63]
buffer_load_dwordx4 v2, s[20:23], s57 offen offset:2048 lds
v_mfma_f32_16x16x32_bf16 v[60:63], v[212:215], v[252:255], v[60:63]
ds_read_b64_tr_b16 v[200:201], v14 offset:16384
v_mfma_f32_16x16x32_bf16 v[64:67], v[216:219], a[0:3], v[28:31]
buffer_load_dwordx4 v3, s[20:23], s57 offen offset:3072 lds
v_mfma_f32_16x16x32_bf16 v[64:67], v[220:223], a[16:19], v[64:67]
ds_read_b64_tr_b16 v[202:203], v14 offset:18432
v_mfma_f32_16x16x32_bf16 v[68:71], v[216:219], a[4:7], v[28:31]
ds_read_b64_tr_b16 v[204:205], v14 offset:20480
ds_read_b64_tr_b16 v[206:207], v14 offset:22528
v_mfma_f32_16x16x32_bf16 v[68:71], v[220:223], a[20:23], v[68:71]
ds_write_b64 v166, v[112:113] offset:16384
v_mfma_f32_16x16x32_bf16 v[72:75], v[216:219], a[8:11], v[28:31]
ds_write_b64 v166, v[114:115] offset:17408
v_fma_f32 v20, v48, -v48, s62
v_fma_f32 v21, v49, -v49, s62
v_mul_f32 v20, v20, v48
v_mfma_f32_16x16x32_bf16 v[72:75], v[220:223], a[24:27], v[72:75]
ds_write_b64 v166, v[116:117] offset:18432
ds_write_b64 v166, v[118:119] offset:19456
v_mul_f32 v21, v21, v49
v_mfma_f32_16x16x32_bf16 v[76:79], v[216:219], a[12:15], v[28:31]
ds_write_b64 v167, v[120:121] offset:16384
ds_write_b64 v167, v[122:123] offset:17408
v_exp_f32 v20, v20
v_mfma_f32_16x16x32_bf16 v[76:79], v[220:223], a[28:31], v[76:79]
ds_write_b64 v167, v[124:125] offset:18432
ds_write_b64 v167, v[126:127] offset:19456
v_exp_f32 v21, v21
s_waitcnt lgkmcnt(8)
v_mfma_f32_16x16x32_bf16 v[64:67], v[192:195], a[32:35], v[64:67]
v_add_f32 v20, 1.0, v20
v_add_f32 v21, 1.0, v21
v_rcp_f32 v20, v20
v_mfma_f32_16x16x32_bf16 v[64:67], v[196:199], a[48:51], v[64:67]
v_rcp_f32 v21, v21
v_mul_f32 v20, v20, v48
v_mfma_f32_16x16x32_bf16 v[64:67], v[200:203], a[64:67], v[64:67]
v_mul_f32 v21, v21, v49
v_cvt_pk_bf16_f32 v144, v20, v21
v_fma_f32 v22, v50, -v50, s62
v_fma_f32 v23, v51, -v51, s62
v_mfma_f32_16x16x32_bf16 v[64:67], v[204:207], a[80:83], v[64:67]
ds_read_b64_tr_b16 v[208:209], v12 offset:49152
v_mul_f32 v22, v22, v50
v_mul_f32 v23, v23, v51
v_mfma_f32_16x16x32_bf16 v[68:71], v[192:195], a[36:39], v[68:71]
ds_read_b64_tr_b16 v[210:211], v12 offset:51200
v_exp_f32 v22, v22
v_exp_f32 v23, v23
v_mfma_f32_16x16x32_bf16 v[68:71], v[196:199], a[52:55], v[68:71]
ds_read_b64_tr_b16 v[212:213], v12 offset:53248
v_add_f32 v22, 1.0, v22
v_add_f32 v23, 1.0, v23
v_mfma_f32_16x16x32_bf16 v[68:71], v[200:203], a[68:71], v[68:71]
ds_read_b64_tr_b16 v[214:215], v12 offset:55296
v_rcp_f32 v22, v22
v_mfma_f32_16x16x32_bf16 v[68:71], v[204:207], a[84:87], v[68:71]
ds_read_b64_tr_b16 v[216:217], v12 offset:57344
v_rcp_f32 v23, v23
v_mul_f32 v22, v22, v50
v_mfma_f32_16x16x32_bf16 v[72:75], v[192:195], a[40:43], v[72:75]
ds_read_b64_tr_b16 v[218:219], v12 offset:59392
v_mul_f32 v23, v23, v51
v_cvt_pk_bf16_f32 v145, v22, v23
v_fma_f32 v20, v52, -v52, s62
v_mfma_f32_16x16x32_bf16 v[72:75], v[196:199], a[56:59], v[72:75]
ds_read_b64_tr_b16 v[220:221], v12 offset:61440
v_fma_f32 v21, v53, -v53, s62
v_mul_f32 v20, v20, v52
v_mul_f32 v21, v21, v53
v_mfma_f32_16x16x32_bf16 v[72:75], v[200:203], a[72:75], v[72:75]
ds_read_b64_tr_b16 v[222:223], v12 offset:63488
v_exp_f32 v20, v20
v_mfma_f32_16x16x32_bf16 v[72:75], v[204:207], a[88:91], v[72:75]
v_exp_f32 v21, v21
v_add_f32 v20, 1.0, v20
v_add_f32 v21, 1.0, v21
v_mfma_f32_16x16x32_bf16 v[76:79], v[192:195], a[44:47], v[76:79]
v_rcp_f32 v20, v20
v_rcp_f32 v21, v21
v_mfma_f32_16x16x32_bf16 v[76:79], v[196:199], a[60:63], v[76:79]
v_mul_f32 v20, v20, v52
v_mul_f32 v21, v21, v53
v_cvt_pk_bf16_f32 v146, v20, v21
v_fma_f32 v22, v54, -v54, s62
v_mfma_f32_16x16x32_bf16 v[76:79], v[200:203], a[76:79], v[76:79]
v_fma_f32 v23, v55, -v55, s62
v_mul_f32 v22, v22, v54
v_mul_f32 v23, v23, v55
v_mfma_f32_16x16x32_bf16 v[76:79], v[204:207], a[92:95], v[76:79]
s_add_u32 m0, s6, 139264
v_exp_f32 v22, v22
s_waitcnt vmcnt(13) lgkmcnt(0)
s_barrier
v_mfma_f32_16x16x32_bf16 v[64:67], v[208:211], a[96:99], v[64:67]
s_add_u32 s57, s58, 3539968
ds_read_b64_tr_b16 v[192:193], v13 offset:8192
v_exp_f32 v23, v23
v_mfma_f32_16x16x32_bf16 v[64:67], v[212:215], a[112:115], v[64:67]
buffer_load_dwordx4 v0, s[20:23], s57 offen offset:0 lds
v_add_f32 v22, 1.0, v22
v_add_f32 v23, 1.0, v23
v_mfma_f32_16x16x32_bf16 v[64:67], v[216:219], a[128:131], v[64:67]
ds_read_b64_tr_b16 v[194:195], v13 offset:10240
v_rcp_f32 v22, v22
v_rcp_f32 v23, v23
v_mfma_f32_16x16x32_bf16 v[64:67], v[220:223], a[144:147], v[64:67]
buffer_load_dwordx4 v1, s[20:23], s57 offen offset:1024 lds
v_mul_f32 v22, v22, v54
v_mul_f32 v23, v23, v55
v_mfma_f32_16x16x32_bf16 v[68:71], v[208:211], a[100:103], v[68:71]
ds_read_b64_tr_b16 v[196:197], v13 offset:12288
v_cvt_pk_bf16_f32 v147, v22, v23
v_fma_f32 v20, v56, -v56, s62
v_fma_f32 v21, v57, -v57, s62
v_mfma_f32_16x16x32_bf16 v[68:71], v[212:215], a[116:119], v[68:71]
ds_read_b64_tr_b16 v[198:199], v13 offset:14336
v_mul_f32 v20, v20, v56
v_mul_f32 v21, v21, v57
v_mfma_f32_16x16x32_bf16 v[68:71], v[216:219], a[132:135], v[68:71]
buffer_load_dwordx4 v2, s[20:23], s57 offen offset:2048 lds
v_exp_f32 v20, v20
v_exp_f32 v21, v21
v_mfma_f32_16x16x32_bf16 v[68:71], v[220:223], a[148:151], v[68:71]
ds_read_b64_tr_b16 v[200:201], v13 offset:16384
v_add_f32 v20, 1.0, v20
v_add_f32 v21, 1.0, v21
v_mfma_f32_16x16x32_bf16 v[72:75], v[208:211], a[104:107], v[72:75]
buffer_load_dwordx4 v3, s[20:23], s57 offen offset:3072 lds
v_rcp_f32 v20, v20
v_mfma_f32_16x16x32_bf16 v[72:75], v[212:215], a[120:123], v[72:75]
ds_read_b64_tr_b16 v[202:203], v13 offset:18432
v_rcp_f32 v21, v21
v_mul_f32 v20, v20, v56
v_mfma_f32_16x16x32_bf16 v[72:75], v[216:219], a[136:139], v[72:75]
ds_read_b64_tr_b16 v[204:205], v13 offset:20480
ds_read_b64_tr_b16 v[206:207], v13 offset:22528
v_mul_f32 v21, v21, v57
v_cvt_pk_bf16_f32 v148, v20, v21
v_mfma_f32_16x16x32_bf16 v[72:75], v[220:223], a[152:155], v[72:75]
buffer_load_dwordx4 v[168:171], v16, s[28:31], 0 offen offset:1024 sc1
v_fma_f32 v22, v58, -v58, s62
v_fma_f32 v23, v59, -v59, s62
v_mul_f32 v22, v22, v58
v_mfma_f32_16x16x32_bf16 v[76:79], v[208:211], a[108:111], v[76:79]
v_mul_f32 v23, v23, v59
v_exp_f32 v22, v22
v_mfma_f32_16x16x32_bf16 v[76:79], v[212:215], a[124:127], v[76:79]
v_exp_f32 v23, v23
v_add_f32 v22, 1.0, v22
v_add_f32 v23, 1.0, v23
v_mfma_f32_16x16x32_bf16 v[76:79], v[216:219], a[140:143], v[76:79]
v_rcp_f32 v22, v22
v_rcp_f32 v23, v23
v_mfma_f32_16x16x32_bf16 v[76:79], v[220:223], a[156:159], v[76:79]
v_mul_f32 v22, v22, v58
v_mul_f32 v23, v23, v59
v_cvt_pk_bf16_f32 v149, v22, v23
v_fma_f32 v20, v60, -v60, s62
s_waitcnt lgkmcnt(0)
v_mfma_f32_16x16x32_bf16 v[64:67], v[192:195], a[160:163], v[64:67]
v_fma_f32 v21, v61, -v61, s62
v_mul_f32 v20, v20, v60
v_mul_f32 v21, v21, v61
v_mfma_f32_16x16x32_bf16 v[64:67], v[196:199], a[176:179], v[64:67]
ds_read_b64_tr_b16 v[208:209], v12 offset:0
v_exp_f32 v20, v20
v_mfma_f32_16x16x32_bf16 v[64:67], v[200:203], a[192:195], v[64:67]
ds_read_b64_tr_b16 v[210:211], v12 offset:2048
v_exp_f32 v21, v21
v_add_f32 v20, 1.0, v20
v_mfma_f32_16x16x32_bf16 v[64:67], v[204:207], a[208:211], v[64:67]
ds_read_b64_tr_b16 v[212:213], v12 offset:4096
v_add_f32 v21, 1.0, v21
v_rcp_f32 v20, v20
v_mfma_f32_16x16x32_bf16 v[68:71], v[192:195], a[164:167], v[68:71]
v_lshlrev_b32 v165, 3, v16
s_mov_b32 exec_hi, 1
buffer_load_dword v183, v165, s[36:39], s66 offen
s_mov_b32 exec_hi, -1
v_mfma_f32_16x16x32_bf16 v[68:71], v[196:199], a[180:183], v[68:71]
ds_read_b64_tr_b16 v[214:215], v12 offset:6144
v_rcp_f32 v21, v21
v_mfma_f32_16x16x32_bf16 v[68:71], v[200:203], a[196:199], v[68:71]
ds_read_b64_tr_b16 v[216:217], v12 offset:8192
v_mul_f32 v20, v20, v60
v_mul_f32 v21, v21, v61
v_cvt_pk_bf16_f32 v150, v20, v21
v_mfma_f32_16x16x32_bf16 v[68:71], v[204:207], a[212:215], v[68:71]
s_mov_b32 exec_lo, 0xf8000
s_mov_b32 exec_hi, 0x0
buffer_load_dword v183, v182, s[24:27], s42 offen
s_mov_b64 exec, -1
v_mfma_f32_16x16x32_bf16 v[72:75], v[192:195], a[168:171], v[72:75]
ds_read_b64_tr_b16 v[218:219], v12 offset:10240
v_fma_f32 v22, v62, -v62, s62
v_fma_f32 v23, v63, -v63, s62
v_mul_f32 v22, v22, v62
v_mfma_f32_16x16x32_bf16 v[72:75], v[196:199], a[184:187], v[72:75]
ds_read_b64_tr_b16 v[220:221], v12 offset:12288
v_mul_f32 v23, v23, v63
v_exp_f32 v22, v22
v_mfma_f32_16x16x32_bf16 v[72:75], v[200:203], a[200:203], v[72:75]
ds_read_b64_tr_b16 v[222:223], v12 offset:14336
v_exp_f32 v23, v23
v_mfma_f32_16x16x32_bf16 v[72:75], v[204:207], a[216:219], v[72:75]
v_add_f32 v22, 1.0, v22
v_add_f32 v23, 1.0, v23
v_rcp_f32 v22, v22
v_mfma_f32_16x16x32_bf16 v[76:79], v[192:195], a[172:175], v[76:79]
v_rcp_f32 v23, v23
v_mul_f32 v22, v22, v62
v_mfma_f32_16x16x32_bf16 v[76:79], v[196:199], a[188:191], v[76:79]
s_branch SK5
.p2align 12
PAD5:
s_branch PAD9
SK5:
v_mul_f32 v23, v23, v63
v_cvt_pk_bf16_f32 v151, v22, v23
v_mfma_f32_16x16x32_bf16 v[76:79], v[200:203], a[204:207], v[76:79]
v_mfma_f32_16x16x32_bf16 v[76:79], v[204:207], a[220:223], v[76:79]
s_waitcnt vmcnt(16) lgkmcnt(0)
s_barrier
v_mfma_f32_16x16x32_bf16 v[64:67], v[208:211], a[224:227], v[64:67]
ds_write_b64 v166, v[128:129] offset:32768
v_mfma_f32_16x16x32_bf16 v[64:67], v[212:215], a[240:243], v[64:67]
ds_write_b64 v166, v[130:131] offset:33792
v_mfma_f32_16x16x32_bf16 v[64:67], v[216:219], v[224:227], v[64:67]
ds_write_b64 v166, v[132:133] offset:34816
v_mfma_f32_16x16x32_bf16 v[64:67], v[220:223], v[240:243], v[64:67]
ds_read_b64_tr_b16 v[192:193], v13 offset:24576
v_mfma_f32_16x16x32_bf16 v[68:71], v[208:211], a[228:231], v[68:71]
ds_read_b64_tr_b16 v[194:195], v13 offset:26624
v_mfma_f32_16x16x32_bf16 v[68:71], v[212:215], a[244:247], v[68:71]
ds_read_b64_tr_b16 v[196:197], v13 offset:28672
v_mfma_f32_16x16x32_bf16 v[68:71], v[216:219], v[228:231], v[68:71]
ds_read_b64_tr_b16 v[198:199], v13 offset:30720
v_mfma_f32_16x16x32_bf16 v[68:71], v[220:223], v[244:247], v[68:71]
ds_read_b64_tr_b16 v[200:201], v13 offset:32768
v_mfma_f32_16x16x32_bf16 v[72:75], v[208:211], a[232:235], v[72:75]
ds_read_b64_tr_b16 v[202:203], v13 offset:34816
v_mfma_f32_16x16x32_bf16 v[72:75], v[212:215], a[248:251], v[72:75]
ds_read_b64_tr_b16 v[204:205], v13 offset:36864
v_mfma_f32_16x16x32_bf16 v[72:75], v[216:219], v[232:235], v[72:75]
ds_read_b64_tr_b16 v[206:207], v13 offset:38912
v_mfma_f32_16x16x32_bf16 v[72:75], v[220:223], v[248:251], v[72:75]
ds_write_b64 v166, v[134:135] offset:35840
ds_write_b64 v167, v[136:137] offset:32768
v_mfma_f32_16x16x32_bf16 v[76:79], v[208:211], a[236:239], v[76:79]
ds_write_b64 v167, v[138:139] offset:33792
ds_write_b64 v167, v[140:141] offset:34816
v_mfma_f32_16x16x32_bf16 v[76:79], v[212:215], a[252:255], v[76:79]
ds_read_b128 v[24:27], v7 offset:2048
ds_write_b64 v167, v[142:143] offset:35840
v_mfma_f32_16x16x32_bf16 v[76:79], v[216:219], v[236:239], v[76:79]
ds_write_b64 v166, v[96:97] offset:0
ds_write_b64 v166, v[98:99] offset:1024
v_mfma_f32_16x16x32_bf16 v[76:79], v[220:223], v[252:255], v[76:79]
ds_write_b64 v166, v[100:101] offset:2048
ds_write_b64 v166, v[102:103] offset:3072
s_waitcnt vmcnt(12) lgkmcnt(5)
s_barrier
v_mfma_f32_16x16x32_bf16 v[80:83], v[192:195], a[0:3], v[24:27]
ds_write_b64 v167, v[104:105] offset:0
v_mfma_f32_16x16x32_bf16 v[80:83], v[196:199], a[16:19], v[80:83]
ds_write_b64 v167, v[106:107] offset:1024
v_mfma_f32_16x16x32_bf16 v[80:83], v[200:203], a[32:35], v[80:83]
ds_write_b64 v167, v[108:109] offset:2048
v_mfma_f32_16x16x32_bf16 v[80:83], v[204:207], a[48:51], v[80:83]
ds_read_b64_tr_b16 v[208:209], v13 offset:40960
v_mfma_f32_16x16x32_bf16 v[84:87], v[192:195], a[4:7], v[24:27]
ds_read_b64_tr_b16 v[210:211], v13 offset:43008
v_fma_f32 v20, v64, -v64, s62
v_fma_f32 v21, v65, -v65, s62
v_mul_f32 v20, v20, v64
v_mul_f32 v21, v21, v65
v_mfma_f32_16x16x32_bf16 v[84:87], v[196:199], a[20:23], v[84:87]
ds_read_b64_tr_b16 v[212:213], v13 offset:45056
v_exp_f32 v20, v20
v_mfma_f32_16x16x32_bf16 v[84:87], v[200:203], a[36:39], v[84:87]
ds_read_b64_tr_b16 v[214:215], v13 offset:47104
v_exp_f32 v21, v21
v_add_f32 v20, 1.0, v20
v_add_f32 v21, 1.0, v21
v_mfma_f32_16x16x32_bf16 v[84:87], v[204:207], a[52:55], v[84:87]
ds_read_b64_tr_b16 v[216:217], v13 offset:49152
v_rcp_f32 v20, v20
v_mfma_f32_16x16x32_bf16 v[88:91], v[192:195], a[8:11], v[24:27]
ds_read_b64_tr_b16 v[218:219], v13 offset:51200
ds_write_b64 v167, v[110:111] offset:3072
v_rcp_f32 v21, v21
v_mul_f32 v20, v20, v64
v_mfma_f32_16x16x32_bf16 v[88:91], v[196:199], a[24:27], v[88:91]
ds_read_b64_tr_b16 v[220:221], v13 offset:53248
ds_write_b64 v6, v[144:145] offset:49152
v_mul_f32 v21, v21, v65
v_cvt_pk_bf16_f32 v152, v20, v21
v_mfma_f32_16x16x32_bf16 v[88:91], v[200:203], a[40:43], v[88:91]
ds_read_b64_tr_b16 v[222:223], v13 offset:55296
ds_write_b64 v6, v[146:147] offset:50176
v_fma_f32 v22, v66, -v66, s62
v_fma_f32 v23, v67, -v67, s62
v_mfma_f32_16x16x32_bf16 v[88:91], v[204:207], a[56:59], v[88:91]
ds_write_b64 v6, v[148:149] offset:51200
ds_write_b64 v6, v[150:151] offset:52224
v_mul_f32 v22, v22, v66
v_mul_f32 v23, v23, v67
v_mfma_f32_16x16x32_bf16 v[92:95], v[192:195], a[12:15], v[24:27]
v_exp_f32 v22, v22
v_exp_f32 v23, v23
v_mfma_f32_16x16x32_bf16 v[92:95], v[196:199], a[28:31], v[92:95]
v_add_f32 v22, 1.0, v22
v_add_f32 v23, 1.0, v23
v_rcp_f32 v22, v22
v_mfma_f32_16x16x32_bf16 v[92:95], v[200:203], a[44:47], v[92:95]
v_rcp_f32 v23, v23
v_mul_f32 v22, v22, v66
v_mul_f32 v23, v23, v67
v_cvt_pk_bf16_f32 v153, v22, v23
v_mfma_f32_16x16x32_bf16 v[92:95], v[204:207], a[60:63], v[92:95]
v_fma_f32 v20, v68, -v68, s62
v_fma_f32 v21, v69, -v69, s62
v_mul_f32 v20, v20, v68
v_mul_f32 v21, v21, v69
s_waitcnt vmcnt(7) lgkmcnt(0)
s_barrier
v_mfma_f32_16x16x32_bf16 v[80:83], v[208:211], a[64:67], v[80:83]
s_add_u32 m0, s6, 73728
ds_read_b128 a[0:3], v4 offset:0
v_exp_f32 v20, v20
v_mfma_f32_16x16x32_bf16 v[80:83], v[212:215], a[80:83], v[80:83]
s_cmp_lt_u32 s3, 2
s_cbranch_scc1 Sa1
s_sub_u32 s57, s85, 73728
buffer_load_dwordx4 v8, s[24:27], s57 offen offset:0 lds
buffer_load_dwordx4 v9, s[24:27], s57 offen offset:1024 lds
buffer_load_dwordx4 v10, s[24:27], s57 offen offset:2048 lds
buffer_load_dwordx4 v11, s[24:27], s57 offen offset:3072 lds
s_branch Sb2
Sa1:
s_add_u32 s57, s58, 4719616
buffer_load_dwordx4 v0, s[20:23], s57 offen offset:0 lds
buffer_load_dwordx4 v1, s[20:23], s57 offen offset:1024 lds
buffer_load_dwordx4 v2, s[20:23], s57 offen offset:2048 lds
buffer_load_dwordx4 v3, s[20:23], s57 offen offset:3072 lds
Sb2:
ds_read_b128 a[4:7], v4 offset:1024
v_mfma_f32_16x16x32_bf16 v[80:83], v[216:219], a[96:99], v[80:83]
ds_read_b128 a[8:11], v4 offset:2048
ds_read_b128 a[12:15], v4 offset:3072
v_exp_f32 v21, v21
v_mfma_f32_16x16x32_bf16 v[80:83], v[220:223], a[112:115], v[80:83]
ds_read_b64_tr_b16 v[192:193], v13 offset:57344
ds_read_b128 a[16:19], v4 offset:4096
v_add_f32 v20, 1.0, v20
v_add_f32 v21, 1.0, v21
v_mfma_f32_16x16x32_bf16 v[84:87], v[208:211], a[68:71], v[84:87]
ds_read_b64_tr_b16 v[194:195], v13 offset:59392
ds_read_b128 a[20:23], v4 offset:5120
v_rcp_f32 v20, v20
v_mfma_f32_16x16x32_bf16 v[84:87], v[212:215], a[84:87], v[84:87]
ds_read_b64_tr_b16 v[196:197], v13 offset:61440
ds_read_b128 a[24:27], v4 offset:6144
v_rcp_f32 v21, v21
v_mul_f32 v20, v20, v68
v_mfma_f32_16x16x32_bf16 v[84:87], v[216:219], a[100:103], v[84:87]
ds_read_b64_tr_b16 v[198:199], v13 offset:63488
ds_read_b128 a[28:31], v4 offset:7168
v_mul_f32 v21, v21, v69
v_cvt_pk_bf16_f32 v154, v20, v21
v_mfma_f32_16x16x32_bf16 v[84:87], v[220:223], a[116:119], v[84:87]
ds_read_b64_tr_b16 v[200:201], v14 offset:0
ds_read_b128 a[32:35], v4 offset:8192
v_fma_f32 v22, v70, -v70, s62
v_fma_f32 v23, v71, -v71, s62
v_mfma_f32_16x16x32_bf16 v[88:91], v[208:211], a[72:75], v[88:91]
ds_read_b64_tr_b16 v[202:203], v14 offset:2048
ds_read_b128 a[36:39], v4 offset:9216
v_mul_f32 v22, v22, v70
v_mul_f32 v23, v23, v71
v_mfma_f32_16x16x32_bf16 v[88:91], v[212:215], a[88:91], v[88:91]
ds_read_b64_tr_b16 v[204:205], v14 offset:4096
ds_read_b128 a[40:43], v4 offset:10240
v_exp_f32 v22, v22
v_mfma_f32_16x16x32_bf16 v[88:91], v[216:219], a[104:107], v[88:91]
s_add_u32 m0, s6, 90112
ds_read_b64_tr_b16 v[206:207], v14 offset:6144
ds_read_b128 a[44:47], v4 offset:11264
v_exp_f32 v23, v23
v_mfma_f32_16x16x32_bf16 v[88:91], v[220:223], a[120:123], v[88:91]
s_add_u32 s57, s85, 73728
ds_read_b128 a[48:51], v4 offset:12288
ds_read_b128 a[52:55], v4 offset:13312
v_add_f32 v22, 1.0, v22
v_mfma_f32_16x16x32_bf16 v[92:95], v[208:211], a[76:79], v[92:95]
buffer_load_dwordx4 v8, s[24:27], s57 offen offset:0 lds
v_add_f32 v23, 1.0, v23
v_rcp_f32 v22, v22
v_mfma_f32_16x16x32_bf16 v[92:95], v[212:215], a[92:95], v[92:95]
ds_read_b128 a[56:59], v4 offset:14336
ds_read_b128 a[60:63], v4 offset:15360
v_rcp_f32 v23, v23
v_mfma_f32_16x16x32_bf16 v[92:95], v[216:219], a[108:111], v[92:95]
buffer_load_dwordx4 v9, s[24:27], s57 offen offset:1024 lds
v_mul_f32 v22, v22, v70
v_mul_f32 v23, v23, v71
v_cvt_pk_bf16_f32 v155, v22, v23
v_mfma_f32_16x16x32_bf16 v[92:95], v[220:223], a[124:127], v[92:95]
v_fma_f32 v20, v72, -v72, s62
v_fma_f32 v21, v73, -v73, s62
v_mul_f32 v20, v20, v72
v_mul_f32 v21, v21, v73
s_waitcnt vmcnt(9) lgkmcnt(5)
s_barrier
v_mfma_f32_16x16x32_bf16 v[80:83], v[192:195], a[128:131], v[80:83]
ds_read_b64_tr_b16 v[208:209], v14 offset:8192
ds_read_b128 a[64:67], v4 offset:16384
v_exp_f32 v20, v20
v_mfma_f32_16x16x32_bf16 v[80:83], v[196:199], a[144:147], v[80:83]
buffer_load_dwordx4 v10, s[24:27], s57 offen offset:2048 lds
ds_read_b128 a[68:71], v4 offset:17408
v_exp_f32 v21, v21
v_add_f32 v20, 1.0, v20
v_mfma_f32_16x16x32_bf16 v[80:83], v[200:203], a[160:163], v[80:83]
ds_read_b64_tr_b16 v[210:211], v14 offset:10240
ds_read_b128 a[72:75], v4 offset:18432
v_add_f32 v21, 1.0, v21
v_mfma_f32_16x16x32_bf16 v[80:83], v[204:207], a[176:179], v[80:83]
ds_read_b64_tr_b16 v[212:213], v14 offset:12288
ds_read_b128 a[76:79], v4 offset:19456
v_rcp_f32 v20, v20
v_mfma_f32_16x16x32_bf16 v[84:87], v[192:195], a[132:135], v[84:87]
buffer_load_dwordx4 v11, s[24:27], s57 offen offset:3072 lds
s_add_u32 m0, s6, 106496
ds_read_b128 a[80:83], v4 offset:20480
v_rcp_f32 v21, v21
v_mfma_f32_16x16x32_bf16 v[84:87], v[196:199], a[148:151], v[84:87]
s_add_u32 s57, s85, 221184
ds_read_b64_tr_b16 v[214:215], v14 offset:14336
ds_read_b128 a[84:87], v4 offset:21504
v_mul_f32 v20, v20, v72
v_mfma_f32_16x16x32_bf16 v[84:87], v[200:203], a[164:167], v[84:87]
buffer_load_dwordx4 v8, s[24:27], s57 offen offset:0 lds
ds_read_b128 a[88:91], v4 offset:22528
v_mul_f32 v21, v21, v73
v_cvt_pk_bf16_f32 v156, v20, v21
s_waitcnt vmcnt(11)
v_mfma_f32_16x16x32_bf16 v[84:87], v[204:207], a[180:183], v[84:87]
ds_read_b64_tr_b16 v[216:217], v14 offset:16384
ds_read_b128 a[92:95], v4 offset:23552
v_xor_b32 v168, s7, v168
v_mfma_f32_16x16x32_bf16 v[88:91], v[192:195], a[136:139], v[88:91]
ds_read_b64_tr_b16 v[218:219], v14 offset:18432
ds_read_b128 a[96:99], v4 offset:24576
v_bitop3_b32 v168, v169, v168, s7 bitop3:0xde
v_bitop3_b32 v168, v170, v168, s7 bitop3:0xde
v_mfma_f32_16x16x32_bf16 v[88:91], v[196:199], a[152:155], v[88:91]
buffer_load_dwordx4 v9, s[24:27], s57 offen offset:1024 lds
ds_read_b128 a[100:103], v4 offset:25600
v_bitop3_b32 v168, v171, v168, s7 bitop3:0xde
v_mfma_f32_16x16x32_bf16 v[88:91], v[200:203], a[168:171], v[88:91]
ds_read_b64_tr_b16 v[220:221], v14 offset:20480
ds_read_b64_tr_b16 v[222:223], v14 offset:22528
v_mfma_f32_16x16x32_bf16 v[88:91], v[204:207], a[184:187], v[88:91]
ds_read_b128 a[104:107], v4 offset:26624
ds_read_b128 a[108:111], v4 offset:27648
v_cmp_ne_u32 vcc, 0, v168
s_cmp_lg_u64 vcc, 0
s_cbranch_scc1 Ps4
Pk3:
v_mfma_f32_16x16x32_bf16 v[92:95], v[192:195], a[140:143], v[92:95]
buffer_load_dwordx4 v10, s[24:27], s57 offen offset:2048 lds
ds_read_b128 a[112:115], v4 offset:28672
v_fma_f32 v22, v74, -v74, s62
v_fma_f32 v23, v75, -v75, s62
v_mfma_f32_16x16x32_bf16 v[92:95], v[196:199], a[156:159], v[92:95]
ds_read_b128 a[116:119], v4 offset:29696
ds_read_b128 a[120:123], v4 offset:30720
v_mul_f32 v22, v22, v74
v_mul_f32 v23, v23, v75
v_mfma_f32_16x16x32_bf16 v[92:95], v[200:203], a[172:175], v[92:95]
buffer_load_dwordx4 v11, s[24:27], s57 offen offset:3072 lds
ds_read_b128 a[124:127], v4 offset:31744
v_exp_f32 v22, v22
v_mfma_f32_16x16x32_bf16 v[92:95], v[204:207], a[188:191], v[92:95]
s_add_u32 m0, s6, 122880
v_exp_f32 v23, v23
v_add_f32 v22, 1.0, v22
s_waitcnt vmcnt(8) lgkmcnt(6)
s_barrier
v_mfma_f32_16x16x32_bf16 v[80:83], v[208:211], a[192:195], v[80:83]
s_add_u32 s57, s85, 368640
ds_read_b64_tr_b16 v[192:193], v13 offset:8192
ds_read_b128 a[128:131], v4 offset:32768
v_add_f32 v23, 1.0, v23
v_mfma_f32_16x16x32_bf16 v[80:83], v[212:215], a[208:211], v[80:83]
buffer_load_dwordx4 v8, s[24:27], s57 offen offset:0 lds
ds_read_b128 a[132:135], v4 offset:33792
v_rcp_f32 v22, v22
v_mfma_f32_16x16x32_bf16 v[80:83], v[216:219], a[224:227], v[80:83]
ds_read_b64_tr_b16 v[194:195], v13 offset:10240
ds_read_b128 a[136:139], v4 offset:34816
v_rcp_f32 v23, v23
v_mul_f32 v22, v22, v74
v_mfma_f32_16x16x32_bf16 v[80:83], v[220:223], a[240:243], v[80:83]
ds_read_b64_tr_b16 v[196:197], v13 offset:12288
ds_read_b128 a[140:143], v4 offset:35840
v_mul_f32 v23, v23, v75
v_cvt_pk_bf16_f32 v157, v22, v23
v_mfma_f32_16x16x32_bf16 v[84:87], v[208:211], a[196:199], v[84:87]
buffer_load_dwordx4 v9, s[24:27], s57 offen offset:1024 lds
ds_read_b128 a[144:147], v4 offset:36864
v_fma_f32 v20, v76, -v76, s62
v_fma_f32 v21, v77, -v77, s62
v_mfma_f32_16x16x32_bf16 v[84:87], v[212:215], a[212:215], v[84:87]
ds_read_b64_tr_b16 v[198:199], v13 offset:14336
ds_read_b128 a[148:151], v4 offset:37888
v_mul_f32 v20, v20, v76
v_mul_f32 v21, v21, v77
v_mfma_f32_16x16x32_bf16 v[84:87], v[216:219], a[228:231], v[84:87]
buffer_load_dwordx4 v10, s[24:27], s57 offen offset:2048 lds
ds_read_b128 a[152:155], v4 offset:38912
v_exp_f32 v20, v20
v_mfma_f32_16x16x32_bf16 v[84:87], v[220:223], a[244:247], v[84:87]
ds_read_b64_tr_b16 v[200:201], v13 offset:16384
ds_read_b128 a[156:159], v4 offset:39936
v_exp_f32 v21, v21
v_add_f32 v20, 1.0, v20
v_mfma_f32_16x16x32_bf16 v[88:91], v[208:211], a[200:203], v[88:91]
ds_read_b64_tr_b16 v[202:203], v13 offset:18432
ds_read_b128 a[160:163], v4 offset:40960
v_add_f32 v21, 1.0, v21
v_mfma_f32_16x16x32_bf16 v[88:91], v[212:215], a[216:219], v[88:91]
buffer_load_dwordx4 v11, s[24:27], s57 offen offset:3072 lds
ds_read_b128 a[164:167], v4 offset:41984
v_rcp_f32 v20, v20
v_mfma_f32_16x16x32_bf16 v[88:91], v[216:219], a[232:235], v[88:91]
s_add_u32 m0, s6, 139264
ds_read_b64_tr_b16 v[204:205], v13 offset:20480
ds_read_b64_tr_b16 v[206:207], v13 offset:22528
v_rcp_f32 v21, v21
v_mfma_f32_16x16x32_bf16 v[88:91], v[220:223], a[248:251], v[88:91]
s_xor_b32 s83, s60, 896
ds_read_b128 a[168:171], v4 offset:43008
ds_read_b128 a[172:175], v4 offset:44032
v_mul_f32 v20, v20, v76
v_mfma_f32_16x16x32_bf16 v[92:95], v[208:211], a[204:207], v[92:95]
buffer_load_dwordx4 v8, s[24:27], s83 offen offset:0 lds
ds_read_b128 a[176:179], v4 offset:45056
v_mul_f32 v21, v21, v77
v_cvt_pk_bf16_f32 v158, v20, v21
v_mfma_f32_16x16x32_bf16 v[92:95], v[212:215], a[220:223], v[92:95]
ds_read_b128 a[180:183], v4 offset:46080
ds_read_b128 a[184:187], v4 offset:47104
v_fma_f32 v22, v78, -v78, s62
v_fma_f32 v23, v79, -v79, s62
v_mfma_f32_16x16x32_bf16 v[92:95], v[216:219], a[236:239], v[92:95]
buffer_load_dwordx4 v9, s[24:27], s83 offen offset:1024 lds
ds_read_b128 a[188:191], v4 offset:48128
v_mul_f32 v22, v22, v78
v_mul_f32 v23, v23, v79
v_mfma_f32_16x16x32_bf16 v[92:95], v[220:223], a[252:255], v[92:95]
v_exp_f32 v22, v22
v_exp_f32 v23, v23
v_add_f32 v22, 1.0, v22
s_waitcnt vmcnt(10) lgkmcnt(6)
s_barrier
v_mfma_f32_16x16x32_bf16 v[80:83], v[192:195], v[224:227], v[80:83]
ds_read_b64_tr_b16 v[208:209], v13 offset:24576
v_add_f32 v23, 1.0, v23
v_rcp_f32 v22, v22
v_mfma_f32_16x16x32_bf16 v[80:83], v[196:199], v[240:243], v[80:83]
buffer_load_dwordx4 v10, s[24:27], s83 offen offset:2048 lds
v_rcp_f32 v23, v23
v_mul_f32 v22, v22, v78
v_mfma_f32_16x16x32_bf16 v[84:87], v[192:195], v[228:231], v[84:87]
ds_read_b64_tr_b16 v[210:211], v13 offset:26624
v_mul_f32 v23, v23, v79
v_cvt_pk_bf16_f32 v159, v22, v23
s_bfe_u32 s70, s66, 0x1000c
v_mfma_f32_16x16x32_bf16 v[84:87], v[196:199], v[244:247], v[84:87]
ds_read_b64_tr_b16 v[212:213], v13 offset:28672
ds_read_b128 a[192:195], v4 offset:49152
s_lshl_b32 s70, s70, 4
s_lshr_b32 s56, s56, s70
s_lshl_b32 s56, s56, 16
v_mfma_f32_16x16x32_bf16 v[88:91], v[192:195], v[232:235], v[88:91]
buffer_load_dwordx4 v11, s[24:27], s83 offen offset:3072 lds
s_add_u32 m0, s6, 73728
s_lshl_b32 s70, s54, 16
v_mov_b32 v132, s70
v_mfma_f32_16x16x32_bf16 v[88:91], v[196:199], v[248:251], v[88:91]
s_add_u32 s57, s83, 147456
ds_read_b64_tr_b16 v[214:215], v13 offset:30720
ds_read_b128 a[196:199], v4 offset:50176
v_add_f32 v132, s56, v132
v_mfma_f32_16x16x32_bf16 v[92:95], v[192:195], v[236:239], v[92:95]
buffer_load_dwordx4 v8, s[24:27], s57 offen offset:0 lds
v_cvt_pk_bf16_f32 v132, v132, v132
v_mov_b32 v133, s54
v_bfi_b32 v132, s64, v133, v132
v_mfma_f32_16x16x32_bf16 v[92:95], v[196:199], v[252:255], v[92:95]
ds_read_b64_tr_b16 v[216:217], v13 offset:32768
ds_read_b128 a[200:203], v4 offset:51200
v_bfe_u32 v134, v15, 3, 1
v_lshlrev_b32 v135, 4, v134
v_mfma_f32_16x16x32_bf16 v[48:51], v[200:203], a[0:3], 0
ds_read_b64_tr_b16 v[218:219], v13 offset:34816
ds_read_b128 a[204:207], v4 offset:52224
v_sub_u32 v135, 16, v135
v_lshlrev_b32 v132, v135, v132
v_mfma_f32_16x16x32_bf16 v[48:51], v[204:207], a[16:19], v[48:51]
buffer_load_dwordx4 v9, s[24:27], s57 offen offset:1024 lds
v_and_b32 v135, 7, v15
v_cmp_eq_u32 vcc, 7, v135
v_mul_u32_u24 v136, 4160, v134
v_lshl_add_u32 v136, v135, 2, v136
v_mfma_f32_16x16x32_bf16 v[52:55], v[200:203], a[4:7], 0
ds_read_b64_tr_b16 v[220:221], v13 offset:36864
ds_read_b64_tr_b16 v[222:223], v13 offset:38912
s_min_u32 s70, s3, 2
s_mul_i32 s71, s70, 12896
v_mfma_f32_16x16x32_bf16 v[52:55], v[204:207], a[20:23], v[52:55]
ds_read_b128 a[208:211], v4 offset:53248
ds_read_b128 a[212:215], v4 offset:54272
s_add_u32 s71, s71, 32768
v_cndmask_b32 v128, 0, v132, vcc
v_mfma_f32_16x16x32_bf16 v[56:59], v[200:203], a[8:11], 0
buffer_load_dwordx4 v10, s[24:27], s57 offen offset:2048 lds
v_add_u32 v129, s71, v136
v_min_u32 v130, 59, v15
s_add_u32 s71, s71, 12416
v_mfma_f32_16x16x32_bf16 v[56:59], v[204:207], a[24:27], v[56:59]
ds_read_b128 a[216:219], v4 offset:55296
ds_read_b128 a[220:223], v4 offset:56320
v_lshl_add_u32 v130, v130, 3, s71
s_lshl_b32 s70, s70, 9
v_mfma_f32_16x16x32_bf16 v[60:63], v[200:203], a[12:15], 0
buffer_load_dwordx4 v11, s[24:27], s57 offen offset:3072 lds
s_add_u32 s70, s70, 71456
v_lshl_add_u32 v131, v15, 3, s70
v_mov_b32 v132, 0
v_mov_b32 v133, 0
v_mfma_f32_16x16x32_bf16 v[60:63], v[204:207], a[28:31], v[60:63]
s_add_u32 m0, s40, 58560
v_and_b32 v134, 1, v15
v_mul_u32_u24 v134, 4160, v134
v_and_b32 v135, 14, v15
s_waitcnt vmcnt(12) lgkmcnt(0)
s_barrier
v_mfma_f32_16x16x32_bf16 v[48:51], v[208:211], a[32:35], v[48:51]
s_add_u32 s57, s55, s41
ds_read_b64_tr_b16 v[192:193], v13 offset:40960
v_lshl_add_u32 v134, v135, 1, v134
v_lshl_add_u32 v134, v17, 1, v134
v_mfma_f32_16x16x32_bf16 v[48:51], v[212:215], a[48:51], v[48:51]
buffer_load_dwordx4 v16, s[36:39], s57 offen offset:0 lds
v_and_b32 v135, 15, v15
v_lshlrev_b32 v135, 5, v135
v_lshlrev_b32 v136, 1, v17
v_mfma_f32_16x16x32_bf16 v[48:51], v[216:219], a[64:67], v[48:51]
ds_read_b64_tr_b16 v[194:195], v13 offset:43008
v_sub_u32 v135, v136, v135
s_lshr_b32 s70, s3, 1
s_mul_i32 s70, s70, 12896
v_mfma_f32_16x16x32_bf16 v[48:51], v[220:223], a[80:83], v[48:51]
ds_read_b64_tr_b16 v[196:197], v13 offset:45056
s_and_b32 s71, s3, 1
s_lshl_b32 s71, s71, 8
s_add_u32 s70, s70, s71
s_add_u32 s70, s70, 32768
v_mfma_f32_16x16x32_bf16 v[52:55], v[208:211], a[36:39], v[52:55]
buffer_load_dwordx4 v16, s[36:39], s57 offen offset:1024 lds
s_add_u32 m0, s6, 0
v_add_u32 v42, s70, v134
s_add_u32 s70, s70, 8800
v_mfma_f32_16x16x32_bf16 v[52:55], v[212:215], a[52:55], v[52:55]
s_add_u32 s57, s85, 516096
ds_read_b64_tr_b16 v[198:199], v13 offset:47104
v_add_u32 v46, s70, v135
v_add_u32 v43, 1024, v42
v_mfma_f32_16x16x32_bf16 v[52:55], v[216:219], a[68:71], v[52:55]
buffer_load_dwordx4 v8, s[24:27], s57 offen offset:0 lds
v_add_u32 v44, 2048, v42
v_add_u32 v45, 3072, v42
v_fma_f32 v20, v80, -v80, s62
v_mfma_f32_16x16x32_bf16 v[52:55], v[220:223], a[84:87], v[52:55]
ds_read_b64_tr_b16 v[200:201], v13 offset:49152
v_fma_f32 v21, v81, -v81, s62
v_mul_f32 v20, v20, v80
v_mul_f32 v21, v21, v81
v_mfma_f32_16x16x32_bf16 v[56:59], v[208:211], a[40:43], v[56:59]
ds_read_b64_tr_b16 v[202:203], v13 offset:51200
v_exp_f32 v20, v20
v_exp_f32 v21, v21
v_mfma_f32_16x16x32_bf16 v[56:59], v[212:215], a[56:59], v[56:59]
buffer_load_dwordx4 v9, s[24:27], s57 offen offset:1024 lds
v_add_f32 v20, 1.0, v20
v_add_f32 v21, 1.0, v21
v_mfma_f32_16x16x32_bf16 v[56:59], v[216:219], a[72:75], v[56:59]
ds_read_b64_tr_b16 v[204:205], v13 offset:53248
ds_read_b64_tr_b16 v[206:207], v13 offset:55296
v_rcp_f32 v20, v20
v_mfma_f32_16x16x32_bf16 v[56:59], v[220:223], a[88:91], v[56:59]
v_rcp_f32 v21, v21
v_mul_f32 v20, v20, v80
v_mul_f32 v21, v21, v81
v_cvt_pk_bf16_f32 v160, v20, v21
v_mfma_f32_16x16x32_bf16 v[60:63], v[208:211], a[44:47], v[60:63]
buffer_load_dwordx4 v10, s[24:27], s57 offen offset:2048 lds
v_fma_f32 v22, v82, -v82, s62
v_fma_f32 v23, v83, -v83, s62
v_mul_f32 v22, v22, v82
v_mfma_f32_16x16x32_bf16 v[60:63], v[212:215], a[60:63], v[60:63]
v_mul_f32 v23, v23, v83
v_exp_f32 v22, v22
v_exp_f32 v23, v23
v_mfma_f32_16x16x32_bf16 v[60:63], v[216:219], a[76:79], v[60:63]
buffer_load_dwordx4 v11, s[24:27], s57 offen offset:3072 lds
v_add_f32 v22, 1.0, v22
v_add_f32 v23, 1.0, v23
v_mfma_f32_16x16x32_bf16 v[60:63], v[220:223], a[92:95], v[60:63]
v_rcp_f32 v22, v22
v_rcp_f32 v23, v23
v_mul_f32 v22, v22, v82
s_waitcnt vmcnt(14) lgkmcnt(0)
s_barrier
v_mfma_f32_16x16x32_bf16 v[48:51], v[192:195], a[96:99], v[48:51]
s_lshr_b32 s86, s6, 2
s_add_u32 m0, s86, 66880
s_lshr_b32 s57, s55, 12
s_mul_i32 s57, s57, 4096
s_add_u32 s57, s57, s86
s_add_u32 s57, s57, 4194304
ds_read_b64_tr_b16 v[208:209], v13 offset:57344
v_mfma_f32_16x16x32_bf16 v[48:51], v[196:199], a[112:115], v[48:51]
buffer_load_dwordx4 v16, s[28:31], s57 offen sc1 lds
v_mfma_f32_16x16x32_bf16 v[48:51], v[200:203], a[128:131], v[48:51]
s_add_u32 m0, s6, 90112
ds_read_b64_tr_b16 v[210:211], v13 offset:59392
v_mul_f32 v23, v23, v83
v_cvt_pk_bf16_f32 v161, v22, v23
v_mfma_f32_16x16x32_bf16 v[48:51], v[204:207], a[144:147], v[48:51]
s_add_u32 s57, s83, 294912
ds_read_b64_tr_b16 v[212:213], v13 offset:61440
v_fma_f32 v20, v84, -v84, s62
v_fma_f32 v21, v85, -v85, s62
v_mul_f32 v20, v20, v84
v_mfma_f32_16x16x32_bf16 v[52:55], v[192:195], a[100:103], v[52:55]
buffer_load_dwordx4 v8, s[24:27], s57 offen offset:0 lds
v_mul_f32 v21, v21, v85
v_exp_f32 v20, v20
v_mfma_f32_16x16x32_bf16 v[52:55], v[196:199], a[116:119], v[52:55]
ds_read_b64_tr_b16 v[214:215], v13 offset:63488
v_exp_f32 v21, v21
v_add_f32 v20, 1.0, v20
v_mfma_f32_16x16x32_bf16 v[52:55], v[200:203], a[132:135], v[52:55]
buffer_load_dwordx4 v9, s[24:27], s57 offen offset:1024 lds
v_add_f32 v21, 1.0, v21
v_rcp_f32 v20, v20
v_mfma_f32_16x16x32_bf16 v[52:55], v[204:207], a[148:151], v[52:55]
ds_read_b64_tr_b16 v[216:217], v14 offset:0
v_rcp_f32 v21, v21
v_mul_f32 v20, v20, v84
v_mfma_f32_16x16x32_bf16 v[56:59], v[192:195], a[104:107], v[56:59]
ds_read_b64_tr_b16 v[218:219], v14 offset:2048
v_mul_f32 v21, v21, v85
v_cvt_pk_bf16_f32 v162, v20, v21
v_fma_f32 v22, v86, -v86, s62
v_fma_f32 v23, v87, -v87, s62
v_mfma_f32_16x16x32_bf16 v[56:59], v[196:199], a[120:123], v[56:59]
buffer_load_dwordx4 v10, s[24:27], s57 offen offset:2048 lds
v_mul_f32 v22, v22, v86
v_mul_f32 v23, v23, v87
v_mfma_f32_16x16x32_bf16 v[56:59], v[200:203], a[136:139], v[56:59]
ds_read_b64_tr_b16 v[220:221], v14 offset:4096
ds_read_b64_tr_b16 v[222:223], v14 offset:6144
v_exp_f32 v22, v22
v_mfma_f32_16x16x32_bf16 v[56:59], v[204:207], a[152:155], v[56:59]
v_exp_f32 v23, v23
v_add_f32 v22, 1.0, v22
v_add_f32 v23, 1.0, v23
v_mfma_f32_16x16x32_bf16 v[60:63], v[192:195], a[108:111], v[60:63]
buffer_load_dwordx4 v11, s[24:27], s57 offen offset:3072 lds
s_add_u32 m0, s6, 106496
v_rcp_f32 v22, v22
v_mfma_f32_16x16x32_bf16 v[60:63], v[196:199], a[124:127], v[60:63]
s_add_u32 s57, s83, 442368
v_rcp_f32 v23, v23
v_mul_f32 v22, v22, v86
v_mul_f32 v23, v23, v87
v_mfma_f32_16x16x32_bf16 v[60:63], v[200:203], a[140:143], v[60:63]
buffer_load_dwordx4 v8, s[24:27], s57 offen offset:0 lds
v_cvt_pk_bf16_f32 v163, v22, v23
v_fma_f32 v20, v88, -v88, s62
v_fma_f32 v21, v89, -v89, s62
v_mfma_f32_16x16x32_bf16 v[60:63], v[204:207], a[156:159], v[60:63]
v_mul_f32 v20, v20, v88
v_mul_f32 v21, v21, v89
v_exp_f32 v20, v20
s_waitcnt vmcnt(16) lgkmcnt(0)
s_barrier
v_mfma_f32_16x16x32_bf16 v[48:51], v[208:211], a[160:163], v[48:51]
ds_read_b64_tr_b16 v[192:193], v14 offset:8192
v_exp_f32 v21, v21
v_add_f32 v20, 1.0, v20
v_mfma_f32_16x16x32_bf16 v[48:51], v[212:215], a[176:179], v[48:51]
buffer_load_dwordx4 v9, s[24:27], s57 offen offset:1024 lds
v_add_f32 v21, 1.0, v21
v_rcp_f32 v20, v20
v_mfma_f32_16x16x32_bf16 v[48:51], v[216:219], a[192:195], v[48:51]
ds_read_b64_tr_b16 v[194:195], v14 offset:10240
v_rcp_f32 v21, v21
v_mul_f32 v20, v20, v88
v_mul_f32 v21, v21, v89
v_mfma_f32_16x16x32_bf16 v[48:51], v[220:223], a[208:211], v[48:51]
ds_read_b64_tr_b16 v[196:197], v14 offset:12288
v_cvt_pk_bf16_f32 v164, v20, v21
v_fma_f32 v22, v90, -v90, s62
v_fma_f32 v23, v91, -v91, s62
v_mfma_f32_16x16x32_bf16 v[52:55], v[208:211], a[164:167], v[52:55]
buffer_load_dwordx4 v10, s[24:27], s57 offen offset:2048 lds
v_mul_f32 v22, v22, v90
v_mul_f32 v23, v23, v91
v_exp_f32 v22, v22
v_mfma_f32_16x16x32_bf16 v[52:55], v[212:215], a[180:183], v[52:55]
ds_read_b64_tr_b16 v[198:199], v14 offset:14336
v_exp_f32 v23, v23
v_mfma_f32_16x16x32_bf16 v[52:55], v[216:219], a[196:199], v[52:55]
s_branch SK6
.p2align 12
PAD6:
s_branch L_back
SK6:
buffer_load_dwordx4 v11, s[24:27], s57 offen offset:3072 lds
v_add_f32 v22, 1.0, v22
v_add_f32 v23, 1.0, v23
v_rcp_f32 v22, v22
v_mfma_f32_16x16x32_bf16 v[52:55], v[220:223], a[212:215], v[52:55]
ds_read_b64_tr_b16 v[200:201], v14 offset:16384
v_rcp_f32 v23, v23
v_mul_f32 v22, v22, v90
v_mfma_f32_16x16x32_bf16 v[56:59], v[208:211], a[168:171], v[56:59]
ds_read_b64_tr_b16 v[202:203], v14 offset:18432
v_mul_f32 v23, v23, v91
v_cvt_pk_bf16_f32 v165, v22, v23
v_fma_f32 v20, v92, -v92, s62
v_mfma_f32_16x16x32_bf16 v[56:59], v[212:215], a[184:187], v[56:59]
s_mov_b32 exec_lo, 0x0
s_mov_b32 exec_hi, 0x1ff8
buffer_load_dword v183, v182, s[24:27], s42 offen
s_mov_b64 exec, -1
v_mfma_f32_16x16x32_bf16 v[56:59], v[216:219], a[200:203], v[56:59]
s_add_u32 m0, s6, 122880
ds_read_b64_tr_b16 v[204:205], v14 offset:20480
ds_read_b64_tr_b16 v[206:207], v14 offset:22528
v_fma_f32 v21, v93, -v93, s62
v_mul_f32 v20, v20, v92
v_mfma_f32_16x16x32_bf16 v[56:59], v[220:223], a[216:219], v[56:59]
s_xor_b32 s57, s84, 896
v_mul_f32 v21, v21, v93
v_exp_f32 v20, v20
v_mfma_f32_16x16x32_bf16 v[60:63], v[208:211], a[172:175], v[60:63]
buffer_load_dwordx4 v8, s[24:27], s57 offen offset:0 lds
v_exp_f32 v21, v21
v_add_f32 v20, 1.0, v20
v_mfma_f32_16x16x32_bf16 v[60:63], v[212:215], a[188:191], v[60:63]
v_add_f32 v21, 1.0, v21
v_rcp_f32 v20, v20
v_rcp_f32 v21, v21
v_mfma_f32_16x16x32_bf16 v[60:63], v[216:219], a[204:207], v[60:63]
buffer_load_dwordx4 v9, s[24:27], s57 offen offset:1024 lds
v_mul_f32 v20, v20, v92
v_mul_f32 v21, v21, v93
v_cvt_pk_bf16_f32 v166, v20, v21
v_mfma_f32_16x16x32_bf16 v[60:63], v[220:223], a[220:223], v[60:63]
v_fma_f32 v22, v94, -v94, s62
v_fma_f32 v23, v95, -v95, s62
v_mul_f32 v22, v22, v94
v_mul_f32 v23, v23, v95
s_waitcnt vmcnt(18) lgkmcnt(0)
s_barrier
v_mfma_f32_16x16x32_bf16 v[64:67], v[192:195], a[0:3], 0
ds_read_b64_tr_b16 v[208:209], v13 offset:8192
v_exp_f32 v22, v22
v_exp_f32 v23, v23
v_mfma_f32_16x16x32_bf16 v[64:67], v[196:199], a[16:19], v[64:67]
buffer_load_dwordx4 v10, s[24:27], s57 offen offset:2048 lds
v_add_f32 v22, 1.0, v22
v_add_f32 v23, 1.0, v23
v_mfma_f32_16x16x32_bf16 v[64:67], v[200:203], a[32:35], v[64:67]
ds_read_b64_tr_b16 v[210:211], v13 offset:10240
v_rcp_f32 v22, v22
v_rcp_f32 v23, v23
v_mfma_f32_16x16x32_bf16 v[64:67], v[204:207], a[48:51], v[64:67]
ds_read_b64_tr_b16 v[212:213], v13 offset:12288
v_mul_f32 v22, v22, v94
v_mul_f32 v23, v23, v95
v_cvt_pk_bf16_f32 v167, v22, v23
v_mfma_f32_16x16x32_bf16 v[68:71], v[192:195], a[4:7], 0
buffer_load_dwordx4 v11, s[24:27], s57 offen offset:3072 lds
s_add_u32 m0, s6, 139264
v_mfma_f32_16x16x32_bf16 v[68:71], v[196:199], a[20:23], v[68:71]
s_xor_b32 s83, s60, 768
s_add_u32 s57, s83, 73728
ds_read_b64_tr_b16 v[214:215], v13 offset:14336
v_mfma_f32_16x16x32_bf16 v[68:71], v[200:203], a[36:39], v[68:71]
buffer_load_dwordx4 v8, s[24:27], s57 offen offset:0 lds
s_lshl_b32 s70, s3, 7
v_mfma_f32_16x16x32_bf16 v[68:71], v[204:207], a[52:55], v[68:71]
ds_read_b64_tr_b16 v[216:217], v13 offset:16384
s_add_u32 s70, s70, 58560
v_add_u32 v88, s70, v134
v_mfma_f32_16x16x32_bf16 v[72:75], v[192:195], a[8:11], 0
ds_read_b64_tr_b16 v[218:219], v13 offset:18432
s_add_u32 s70, s70, 8800
v_mfma_f32_16x16x32_bf16 v[72:75], v[196:199], a[24:27], v[72:75]
buffer_load_dwordx4 v9, s[24:27], s57 offen offset:1024 lds
s_and_b32 s71, s4, 3
s_lshl_b32 s71, s71, 9
v_mfma_f32_16x16x32_bf16 v[72:75], v[200:203], a[40:43], v[72:75]
ds_read_b64_tr_b16 v[220:221], v13 offset:20480
ds_read_b64_tr_b16 v[222:223], v13 offset:22528
v_mfma_f32_16x16x32_bf16 v[72:75], v[204:207], a[56:59], v[72:75]
s_add_u32 s72, s70, s71
s_sub_u32 s70, s70, s71
v_add_u32 v92, s72, v135
v_mfma_f32_16x16x32_bf16 v[76:79], v[192:195], a[12:15], 0
buffer_load_dwordx4 v10, s[24:27], s57 offen offset:2048 lds
v_add_u32 v93, s70, v135
v_add_u32 v89, 1024, v88
v_add_u32 v90, 2048, v88
v_add_u32 v91, 3072, v88
v_add_u32 v7, 155648, v6
v_add_u32 v5, 155648, v4
ds_write_b64 v7, v[152:153] offset:0
ds_write_b64 v7, v[154:155] offset:1024
ds_write_b64 v7, v[156:157] offset:2048
ds_write_b64 v7, v[158:159] offset:3072
ds_write_b64 v6, v[160:161] offset:16384
ds_write_b64 v6, v[162:163] offset:17408
ds_write_b64 v6, v[164:165] offset:18432
ds_write_b64 v6, v[166:167] offset:19456
ds_write_b32 v129, v128
ds_write_b64 v130, v[132:133]
ds_write_b64 v131, v[132:133]
v_mfma_f32_16x16x32_bf16 v[76:79], v[196:199], a[28:31], v[76:79]
v_mfma_f32_16x16x32_bf16 v[76:79], v[200:203], a[44:47], v[76:79]
buffer_load_dwordx4 v11, s[24:27], s57 offen offset:3072 lds
v_mfma_f32_16x16x32_bf16 v[76:79], v[204:207], a[60:63], v[76:79]
s_add_u32 m0, s40, 32768
s_waitcnt vmcnt(17) lgkmcnt(0)
s_barrier
v_mfma_f32_16x16x32_bf16 v[64:67], v[208:211], a[64:67], v[64:67]
s_add_u32 s57, s67, s41
ds_read_b64_tr_b16 v[192:193], v12 offset:0
ds_read_b128 a[224:227], v5 offset:0
ds_read_b128 v[128:131], v92 offset:0
v_mfma_f32_16x16x32_bf16 v[64:67], v[212:215], a[80:83], v[64:67]
buffer_load_dwordx4 v16, s[36:39], s57 offen offset:0 lds
ds_read_b128 a[228:231], v5 offset:1024
ds_read2_b32 v[132:133], v88 offset0:0 offset1:1
v_mfma_f32_16x16x32_bf16 v[64:67], v[216:219], a[96:99], v[64:67]
ds_read_b64_tr_b16 v[194:195], v12 offset:2048
ds_read_b128 a[232:235], v5 offset:2048
ds_read2_b32 v[134:135], v88 offset0:2 offset1:3
v_mfma_f32_16x16x32_bf16 v[64:67], v[220:223], a[112:115], v[64:67]
ds_read_b64_tr_b16 v[196:197], v12 offset:4096
ds_read_b128 a[236:239], v5 offset:3072
ds_read_b128 v[136:139], v93 offset:3584
v_mfma_f32_16x16x32_bf16 v[68:71], v[208:211], a[68:71], v[68:71]
buffer_load_dwordx4 v16, s[36:39], s57 offen offset:1024 lds
s_add_u32 m0, s6, 73728
ds_read_b128 a[240:243], v5 offset:4096
ds_read_b128 v[140:143], v92 offset:512
v_mfma_f32_16x16x32_bf16 v[68:71], v[212:215], a[84:87], v[68:71]
s_add_u32 s57, s83, 221184
ds_read_b64_tr_b16 v[198:199], v12 offset:6144
ds_read_b128 a[244:247], v5 offset:5120
ds_read2_b32 v[144:145], v88 offset0:128 offset1:129
v_mfma_f32_16x16x32_bf16 v[68:71], v[216:219], a[100:103], v[68:71]
buffer_load_dwordx4 v8, s[24:27], s57 offen offset:0 lds
ds_read_b128 a[248:251], v5 offset:6144
ds_read2_b32 v[146:147], v88 offset0:130 offset1:131
v_mfma_f32_16x16x32_bf16 v[68:71], v[220:223], a[116:119], v[68:71]
ds_read_b64_tr_b16 v[200:201], v12 offset:8192
ds_read_b128 a[252:255], v5 offset:7168
ds_read_b128 v[148:151], v93 offset:4096
v_mfma_f32_16x16x32_bf16 v[72:75], v[208:211], a[72:75], v[72:75]
ds_read_b64_tr_b16 v[202:203], v12 offset:10240
ds_read_b128 v[224:227], v4 offset:16384
ds_read_b128 v[228:231], v4 offset:17408
v_mfma_f32_16x16x32_bf16 v[72:75], v[212:215], a[88:91], v[72:75]
buffer_load_dwordx4 v9, s[24:27], s57 offen offset:1024 lds
ds_read_b128 v[232:235], v4 offset:18432
v_mfma_f32_16x16x32_bf16 v[72:75], v[216:219], a[104:107], v[72:75]
ds_read_b64_tr_b16 v[204:205], v12 offset:12288
ds_read_b64_tr_b16 v[206:207], v12 offset:14336
ds_read_b128 v[236:239], v4 offset:19456
v_mfma_f32_16x16x32_bf16 v[72:75], v[220:223], a[120:123], v[72:75]
ds_read_b128 v[240:243], v4 offset:20480
ds_read_b128 v[244:247], v4 offset:21504
ds_read_b128 v[248:251], v4 offset:22528
v_mfma_f32_16x16x32_bf16 v[76:79], v[208:211], a[76:79], v[76:79]
buffer_load_dwordx4 v10, s[24:27], s57 offen offset:2048 lds
ds_read_b128 v[252:255], v4 offset:23552
v_mfma_f32_16x16x32_bf16 v[76:79], v[212:215], a[92:95], v[76:79]
ds_read2_b32 v[170:171], v89 offset0:130 offset1:131
v_mfma_f32_16x16x32_bf16 v[76:79], v[216:219], a[108:111], v[76:79]
v_mfma_f32_16x16x32_bf16 v[76:79], v[220:223], a[124:127], v[76:79]
s_waitcnt vmcnt(18) lgkmcnt(1)
s_barrier
v_mfma_f32_16x16x32_bf16 v[48:51], v[192:195], a[224:227], v[48:51]
ds_read_b128 v[152:155], v92 offset:1024
v_mfma_f32_16x16x32_bf16 v[48:51], v[196:199], a[240:243], v[48:51]
ds_read2_b32 v[156:157], v89 offset0:0 offset1:1
v_mfma_f32_16x16x32_bf16 v[48:51], v[200:203], v[224:227], v[48:51]
ds_read2_b32 v[158:159], v89 offset0:2 offset1:3
v_mfma_f32_16x16x32_bf16 v[0:3], v[128:131], v[132:135], 0
ds_read_b128 v[160:163], v93 offset:4608
ds_read_b128 v[128:131], v93 offset:5120
v_mfma_f32_16x16x32_bf16 v[48:51], v[204:207], v[240:243], v[48:51]
ds_read_b128 v[164:167], v92 offset:1536
v_mfma_f32_16x16x32_bf16 v[52:55], v[192:195], a[228:231], v[52:55]
ds_read_b64_tr_b16 v[208:209], v13 offset:24576
v_mfma_f32_16x16x32_bf16 v[52:55], v[196:199], a[244:247], v[52:55]
ds_read_b64_tr_b16 v[210:211], v13 offset:26624
v_mfma_f32_16x16x32_bf16 v[52:55], v[200:203], v[228:231], v[52:55]
ds_read_b64_tr_b16 v[212:213], v13 offset:28672
v_mfma_f32_16x16x32_bf16 v[4:7], v[136:139], v[132:135], 0
ds_read_b64_tr_b16 v[214:215], v13 offset:30720
v_mfma_f32_16x16x32_bf16 v[52:55], v[204:207], v[244:247], v[52:55]
ds_read_b64_tr_b16 v[216:217], v13 offset:32768
v_mfma_f32_16x16x32_bf16 v[56:59], v[192:195], a[232:235], v[56:59]
ds_read_b64_tr_b16 v[218:219], v13 offset:34816
v_mfma_f32_16x16x32_bf16 v[56:59], v[196:199], a[248:251], v[56:59]
ds_read_b64_tr_b16 v[220:221], v13 offset:36864
v_mfma_f32_16x16x32_bf16 v[56:59], v[200:203], v[232:235], v[56:59]
buffer_load_dwordx4 v11, s[24:27], s57 offen offset:3072 lds
v_mfma_f32_16x16x32_bf16 v[0:3], v[140:143], v[144:147], v[0:3]
ds_read_b64_tr_b16 v[222:223], v13 offset:38912
v_mfma_f32_16x16x32_bf16 v[56:59], v[204:207], v[248:251], v[56:59]
s_lshr_b32 s86, s6, 2
s_add_u32 m0, s86, 41088
s_lshr_b32 s57, s67, 12
s_mul_i32 s57, s57, 4096
s_add_u32 s57, s57, s86
s_add_u32 s57, s57, 4194304
ds_read2_b32 v[168:169], v89 offset0:128 offset1:129
v_mfma_f32_16x16x32_bf16 v[60:63], v[192:195], a[236:239], v[60:63]
buffer_load_dwordx4 v16, s[28:31], s57 offen sc1 lds
v_mfma_f32_16x16x32_bf16 v[60:63], v[196:199], a[252:255], v[60:63]
s_add_u32 m0, s40, 45664
ds_read_b128 v[140:143], v92 offset:2560
v_mfma_f32_16x16x32_bf16 v[60:63], v[200:203], v[236:239], v[60:63]
s_add_u32 s57, s67, s41
s_add_u32 s57, s57, 4096
v_mfma_f32_16x16x32_bf16 v[4:7], v[148:151], v[144:147], v[4:7]
buffer_load_dwordx4 v16, s[36:39], s57 offen offset:0 lds
v_mfma_f32_16x16x32_bf16 v[60:63], v[204:207], v[252:255], v[60:63]
ds_read2_b32 v[144:145], v90 offset0:128 offset1:129
s_waitcnt vmcnt(17) lgkmcnt(2)
s_barrier
v_mfma_f32_16x16x32_bf16 v[64:67], v[208:211], a[128:131], v[64:67]
ds_read_b128 v[132:135], v92 offset:2048
ds_read2_b32 v[146:147], v90 offset0:130 offset1:131
v_xor_b32 v19, 1, v47
v_mfma_f32_16x16x32_bf16 v[64:67], v[212:215], a[144:147], v[64:67]
ds_read2_b32 v[136:137], v90 offset0:0 offset1:1
ds_read_b128 v[148:151], v92 offset:3072
s_lshr_b32 s75, s6, 1
v_mfma_f32_16x16x32_bf16 v[64:67], v[216:219], a[160:163], v[64:67]
buffer_load_dwordx4 v16, s[36:39], s57 offen offset:1024 lds
s_add_u32 s75, s75, s67
v_mfma_f32_16x16x32_bf16 v[0:3], v[152:155], v[156:159], v[0:3]
ds_read_b64_tr_b16 v[192:193], v13 offset:40960
ds_read2_b32 v[152:153], v91 offset0:0 offset1:1
s_add_u32 s75, s75, 4194304
v_mfma_f32_16x16x32_bf16 v[64:67], v[220:223], a[176:179], v[64:67]
s_lshr_b32 s86, s6, 2
s_add_u32 m0, s86, 53984
s_lshr_b32 s57, s67, 12
s_mul_i32 s57, s57, 4096
s_add_u32 s57, s57, s86
s_add_u32 s57, s57, 4198400
ds_read_b64_tr_b16 v[194:195], v13 offset:43008
ds_read2_b32 v[154:155], v91 offset0:2 offset1:3
v_mfma_f32_16x16x32_bf16 v[68:71], v[208:211], a[132:135], v[68:71]
buffer_load_dwordx4 v16, s[28:31], s57 offen sc1 lds
v_mfma_f32_16x16x32_bf16 v[68:71], v[212:215], a[148:151], v[68:71]
s_add_u32 m0, s6, 0
ds_read_b64_tr_b16 v[196:197], v13 offset:45056
v_mfma_f32_16x16x32_bf16 v[68:71], v[216:219], a[164:167], v[68:71]
s_add_u32 s57, s83, 368640
ds_read_b64_tr_b16 v[198:199], v13 offset:47104
v_mfma_f32_16x16x32_bf16 v[4:7], v[160:163], v[156:159], v[4:7]
buffer_load_dwordx4 v8, s[24:27], s57 offen offset:0 lds
ds_read_b128 v[156:159], v92 offset:3584
v_mfma_f32_16x16x32_bf16 v[68:71], v[220:223], a[180:183], v[68:71]
ds_read_b64_tr_b16 v[200:201], v13 offset:49152
ds_read2_b32 v[160:161], v91 offset0:128 offset1:129
v_cvt_pk_bf16_f32 v48, v48, v49
v_mfma_f32_16x16x32_bf16 v[72:75], v[208:211], a[136:139], v[72:75]
ds_read_b64_tr_b16 v[202:203], v13 offset:51200
ds_read2_b32 v[162:163], v91 offset0:130 offset1:131
v_mfma_f32_16x16x32_bf16 v[72:75], v[212:215], a[152:155], v[72:75]
ds_read_b64_tr_b16 v[204:205], v13 offset:53248
v_cvt_pk_bf16_f32 v49, v50, v51
v_cvt_pk_bf16_f32 v50, v52, v53
v_mfma_f32_16x16x32_bf16 v[72:75], v[216:219], a[168:171], v[72:75]
buffer_load_dwordx4 v9, s[24:27], s57 offen offset:1024 lds
v_cvt_pk_bf16_f32 v51, v54, v55
v_mfma_f32_16x16x32_bf16 v[0:3], v[164:167], v[168:171], v[0:3]
ds_read_b64_tr_b16 v[206:207], v13 offset:55296
v_bfi_b32 v48, s61, v18, v48
v_bfi_b32 v49, s61, v47, v49
v_mfma_f32_16x16x32_bf16 v[72:75], v[220:223], a[184:187], v[72:75]
ds_read2_b32 v[138:139], v90 offset0:2 offset1:3
v_bfi_b32 v50, s61, v18, v50
v_bfi_b32 v51, s61, v47, v51
v_mfma_f32_16x16x32_bf16 v[76:79], v[208:211], a[140:143], v[76:79]
buffer_load_dwordx4 v10, s[24:27], s57 offen offset:2048 lds
v_mfma_f32_16x16x32_bf16 v[76:79], v[212:215], a[156:159], v[76:79]
buffer_store_dwordx4 v[48:51], v16, s[28:31], s68 offen offset:0 sc1
v_cvt_pk_bf16_f32 v56, v56, v57
v_cvt_pk_bf16_f32 v57, v58, v59
v_mfma_f32_16x16x32_bf16 v[76:79], v[216:219], a[172:175], v[76:79]
v_cvt_pk_bf16_f32 v58, v60, v61
v_cvt_pk_bf16_f32 v59, v62, v63
v_bfi_b32 v56, s61, v18, v56
v_mfma_f32_16x16x32_bf16 v[4:7], v[128:131], v[168:171], v[4:7]
buffer_load_dwordx4 v11, s[24:27], s57 offen offset:3072 lds
v_bfi_b32 v57, s61, v47, v57
v_mfma_f32_16x16x32_bf16 v[76:79], v[220:223], a[188:191], v[76:79]
ds_read_b128 v[168:171], v93 offset:3648
v_bfi_b32 v58, s61, v18, v58
v_bfi_b32 v59, s61, v47, v59
s_waitcnt vmcnt(19) lgkmcnt(1)
s_barrier
v_mfma_f32_16x16x32_bf16 v[64:67], v[192:195], a[192:195], v[64:67]
s_add_u32 m0, s6, 16384
ds_read_b128 v[164:167], v92 offset:64
buffer_store_dwordx4 v[56:59], v16, s[28:31], s68 offen offset:1024 sc1
v_mfma_f32_16x16x32_bf16 v[64:67], v[196:199], a[208:211], v[64:67]
s_add_u32 s57, s83, 516096
ds_read2_b32 v[128:129], v88 offset0:16 offset1:17
v_mfma_f32_16x16x32_bf16 v[64:67], v[200:203], a[224:227], v[64:67]
buffer_load_dwordx4 v8, s[24:27], s57 offen offset:0 lds
v_mfma_f32_16x16x32_bf16 v[0:3], v[132:135], v[136:139], v[0:3]
ds_read_b64_tr_b16 v[208:209], v13 offset:57344
ds_read_b128 v[132:135], v92 offset:576
v_mfma_f32_16x16x32_bf16 v[64:67], v[204:207], a[240:243], v[64:67]
ds_read_b64_tr_b16 v[210:211], v13 offset:59392
ds_read2_b32 v[136:137], v88 offset0:144 offset1:145
v_mfma_f32_16x16x32_bf16 v[68:71], v[192:195], a[196:199], v[68:71]
buffer_load_dwordx4 v9, s[24:27], s57 offen offset:1024 lds
ds_read2_b32 v[138:139], v88 offset0:146 offset1:147
v_mfma_f32_16x16x32_bf16 v[68:71], v[196:199], a[212:215], v[68:71]
ds_read_b64_tr_b16 v[212:213], v13 offset:61440
v_mfma_f32_16x16x32_bf16 v[68:71], v[200:203], a[228:231], v[68:71]
ds_read_b64_tr_b16 v[214:215], v13 offset:63488
v_mfma_f32_16x16x32_bf16 v[0:3], v[140:143], v[144:147], v[0:3]
buffer_load_dwordx4 v10, s[24:27], s57 offen offset:2048 lds
ds_read_b128 v[140:143], v93 offset:4160
v_mfma_f32_16x16x32_bf16 v[68:71], v[204:207], a[244:247], v[68:71]
ds_read_b64_tr_b16 v[216:217], v14 offset:0
v_mfma_f32_16x16x32_bf16 v[72:75], v[192:195], a[200:203], v[72:75]
ds_read_b64_tr_b16 v[218:219], v14 offset:2048
v_mfma_f32_16x16x32_bf16 v[72:75], v[196:199], a[216:219], v[72:75]
ds_read_b64_tr_b16 v[220:221], v14 offset:4096
v_mfma_f32_16x16x32_bf16 v[72:75], v[200:203], a[232:235], v[72:75]
buffer_load_dwordx4 v11, s[24:27], s57 offen offset:3072 lds
v_mfma_f32_16x16x32_bf16 v[0:3], v[148:151], v[152:155], v[0:3]
s_add_u32 m0, s6, 90112
ds_read_b64_tr_b16 v[222:223], v14 offset:6144
v_mfma_f32_16x16x32_bf16 v[72:75], v[204:207], a[248:251], v[72:75]
s_xor_b32 s83, s60, 640
ds_read2_b32 v[130:131], v88 offset0:18 offset1:19
v_mfma_f32_16x16x32_bf16 v[76:79], v[192:195], a[204:207], v[76:79]
buffer_load_dwordx4 v8, s[24:27], s83 offen offset:0 lds
v_mfma_f32_16x16x32_bf16 v[76:79], v[196:199], a[220:223], v[76:79]
ds_read_b128 v[152:155], v93 offset:4672
v_mfma_f32_16x16x32_bf16 v[76:79], v[200:203], a[236:239], v[76:79]
v_mfma_f32_16x16x32_bf16 v[0:3], v[156:159], v[160:163], v[0:3]
buffer_load_dwordx4 v9, s[24:27], s83 offen offset:1024 lds
v_mfma_f32_16x16x32_bf16 v[76:79], v[204:207], a[252:255], v[76:79]
ds_read_b128 v[156:159], v92 offset:1600
s_waitcnt vmcnt(16) lgkmcnt(2)
s_barrier
v_mfma_f32_16x16x32_bf16 v[64:67], v[208:211], v[224:227], v[64:67]
ds_read_b128 v[144:147], v92 offset:1088
ds_read2_b32 v[160:161], v89 offset0:144 offset1:145
v_mfma_f32_16x16x32_bf16 v[64:67], v[212:215], v[240:243], v[64:67]
ds_read2_b32 v[148:149], v89 offset0:16 offset1:17
ds_read2_b32 v[162:163], v89 offset0:146 offset1:147
v_mfma_f32_16x16x32_bf16 v[68:71], v[208:211], v[228:231], v[68:71]
buffer_load_dwordx4 v10, s[24:27], s83 offen offset:2048 lds
v_mfma_f32_16x16x32_bf16 v[0:3], v[164:167], v[128:131], v[0:3]
ds_read_b64_tr_b16 v[192:193], v14 offset:8192
ds_read_b128 v[164:167], v93 offset:5184
v_mfma_f32_16x16x32_bf16 v[68:71], v[212:215], v[244:247], v[68:71]
ds_read_b64_tr_b16 v[194:195], v14 offset:10240
v_mfma_f32_16x16x32_bf16 v[72:75], v[208:211], v[232:235], v[72:75]
buffer_load_dwordx4 v11, s[24:27], s83 offen offset:3072 lds
v_mfma_f32_16x16x32_bf16 v[72:75], v[212:215], v[248:251], v[72:75]
s_add_u32 m0, s6, 106496
ds_read_b64_tr_b16 v[196:197], v14 offset:12288
v_mfma_f32_16x16x32_bf16 v[76:79], v[208:211], v[236:239], v[76:79]
s_add_u32 s57, s83, 147456
ds_read_b64_tr_b16 v[198:199], v14 offset:14336
v_mfma_f32_16x16x32_bf16 v[4:7], v[168:171], v[128:131], v[4:7]
buffer_load_dwordx4 v8, s[24:27], s57 offen offset:0 lds
v_mfma_f32_16x16x32_bf16 v[76:79], v[212:215], v[252:255], v[76:79]
ds_read_b64_tr_b16 v[200:201], v14 offset:16384
v_mfma_f32_16x16x32_bf16 v[48:51], v[216:219], a[0:3], 0
ds_read_b64_tr_b16 v[202:203], v14 offset:18432
v_mfma_f32_16x16x32_bf16 v[48:51], v[220:223], a[16:19], v[48:51]
ds_read_b64_tr_b16 v[204:205], v14 offset:20480
v_mfma_f32_16x16x32_bf16 v[52:55], v[216:219], a[4:7], 0
buffer_load_dwordx4 v9, s[24:27], s57 offen offset:1024 lds
v_mfma_f32_16x16x32_bf16 v[0:3], v[132:135], v[136:139], v[0:3]
ds_read_b64_tr_b16 v[206:207], v14 offset:22528
v_mfma_f32_16x16x32_bf16 v[52:55], v[220:223], a[20:23], v[52:55]
ds_read2_b32 v[150:151], v89 offset0:18 offset1:19
v_mfma_f32_16x16x32_bf16 v[56:59], v[216:219], a[8:11], 0
buffer_load_dwordx4 v10, s[24:27], s57 offen offset:2048 lds
s_xor_b32 s43, s68, 0x72000
v_cvt_pk_bf16_f32 v64, v64, v65
v_mfma_f32_16x16x32_bf16 v[56:59], v[220:223], a[24:27], v[56:59]
v_cvt_pk_bf16_f32 v65, v66, v67
v_cvt_pk_bf16_f32 v66, v68, v69
v_cvt_pk_bf16_f32 v67, v70, v71
v_mfma_f32_16x16x32_bf16 v[60:63], v[216:219], a[12:15], 0
v_bfi_b32 v64, s61, v18, v64
v_bfi_b32 v65, s61, v47, v65
v_mfma_f32_16x16x32_bf16 v[4:7], v[140:143], v[136:139], v[4:7]
buffer_load_dwordx4 v11, s[24:27], s57 offen offset:3072 lds
v_bfi_b32 v66, s61, v18, v66
v_bfi_b32 v67, s61, v47, v67
v_mfma_f32_16x16x32_bf16 v[60:63], v[220:223], a[28:31], v[60:63]
ds_read2_b32 v[136:137], v90 offset0:144 offset1:145
s_waitcnt lgkmcnt(1)
v_mfma_f32_16x16x32_bf16 v[48:51], v[192:195], a[32:35], v[48:51]
s_add_u32 m0, s6, 122880
ds_read_b128 v[128:131], v92 offset:2112
ds_read2_b32 v[138:139], v90 offset0:146 offset1:147
buffer_store_dwordx4 v[64:67], v16, s[28:31], s43 offen offset:0 sc1
v_mfma_f32_16x16x32_bf16 v[48:51], v[196:199], a[48:51], v[48:51]
s_add_u32 s57, s83, 294912
ds_read2_b32 v[168:169], v90 offset0:16 offset1:17
ds_read_b128 v[140:143], v92 offset:3136
v_mfma_f32_16x16x32_bf16 v[48:51], v[200:203], a[64:67], v[48:51]
buffer_load_dwordx4 v8, s[24:27], s57 offen offset:0 lds
v_mfma_f32_16x16x32_bf16 v[0:3], v[144:147], v[148:151], v[0:3]
ds_read_b64_tr_b16 v[208:209], v13 offset:8192
ds_read2_b32 v[144:145], v91 offset0:16 offset1:17
v_cvt_pk_bf16_f32 v72, v72, v73
v_mfma_f32_16x16x32_bf16 v[48:51], v[204:207], a[80:83], v[48:51]
ds_read_b64_tr_b16 v[210:211], v13 offset:10240
ds_read2_b32 v[146:147], v91 offset0:18 offset1:19
v_mfma_f32_16x16x32_bf16 v[52:55], v[192:195], a[36:39], v[52:55]
buffer_load_dwordx4 v9, s[24:27], s57 offen offset:1024 lds
v_cvt_pk_bf16_f32 v73, v74, v75
v_cvt_pk_bf16_f32 v74, v76, v77
v_mfma_f32_16x16x32_bf16 v[52:55], v[196:199], a[52:55], v[52:55]
ds_read_b64_tr_b16 v[212:213], v13 offset:12288
v_cvt_pk_bf16_f32 v75, v78, v79
v_mfma_f32_16x16x32_bf16 v[52:55], v[200:203], a[68:71], v[52:55]
ds_read_b64_tr_b16 v[214:215], v13 offset:14336
v_bfi_b32 v72, s61, v18, v72
v_bfi_b32 v73, s61, v47, v73
v_mfma_f32_16x16x32_bf16 v[4:7], v[152:155], v[148:151], v[4:7]
buffer_load_dwordx4 v10, s[24:27], s57 offen offset:2048 lds
ds_read_b128 v[148:151], v92 offset:3648
v_mfma_f32_16x16x32_bf16 v[52:55], v[204:207], a[84:87], v[52:55]
ds_read_b64_tr_b16 v[216:217], v13 offset:16384
ds_read2_b32 v[152:153], v91 offset0:144 offset1:145
v_bfi_b32 v74, s61, v18, v74
v_mfma_f32_16x16x32_bf16 v[56:59], v[192:195], a[40:43], v[56:59]
ds_read_b64_tr_b16 v[218:219], v13 offset:18432
ds_read2_b32 v[154:155], v91 offset0:146 offset1:147
v_bfi_b32 v75, s61, v47, v75
buffer_store_dwordx4 v[72:75], v16, s[28:31], s43 offen offset:1024 sc1
v_mfma_f32_16x16x32_bf16 v[56:59], v[196:199], a[56:59], v[56:59]
ds_read_b64_tr_b16 v[220:221], v13 offset:20480
v_mfma_f32_16x16x32_bf16 v[56:59], v[200:203], a[72:75], v[56:59]
buffer_load_dwordx4 v11, s[24:27], s57 offen offset:3072 lds
v_mfma_f32_16x16x32_bf16 v[0:3], v[156:159], v[160:163], v[0:3]
ds_read_b64_tr_b16 v[222:223], v13 offset:22528
v_mfma_f32_16x16x32_bf16 v[56:59], v[204:207], a[88:91], v[56:59]
ds_read2_b32 v[170:171], v90 offset0:18 offset1:19
v_mfma_f32_16x16x32_bf16 v[60:63], v[192:195], a[44:47], v[60:63]
ds_read_b128 v[132:135], v92 offset:2624
v_mfma_f32_16x16x32_bf16 v[60:63], v[196:199], a[60:63], v[60:63]
v_mfma_f32_16x16x32_bf16 v[60:63], v[200:203], a[76:79], v[60:63]
v_mfma_f32_16x16x32_bf16 v[4:7], v[164:167], v[160:163], v[4:7]
v_mfma_f32_16x16x32_bf16 v[60:63], v[204:207], a[92:95], v[60:63]
s_waitcnt vmcnt(14) lgkmcnt(0)
s_barrier
v_mfma_f32_16x16x32_bf16 v[48:51], v[208:211], a[96:99], v[48:51]
s_add_u32 m0, s6, 73728
ds_read_b128 v[156:159], v46 offset:0
ds_read_b128 v[164:167], v46 offset:512
v_mfma_f32_16x16x32_bf16 v[48:51], v[212:215], a[112:115], v[48:51]
s_add_u32 s57, s83, 442368
ds_read2_b32 v[160:161], v42 offset0:0 offset1:1
v_mfma_f32_16x16x32_bf16 v[48:51], v[216:219], a[128:131], v[48:51]
buffer_load_dwordx4 v8, s[24:27], s57 offen offset:0 lds
v_mfma_f32_16x16x32_bf16 v[0:3], v[128:131], v[168:171], v[0:3]
ds_read_b64_tr_b16 v[192:193], v12 offset:0
ds_read2_b32 v[128:129], v42 offset0:128 offset1:129
v_mfma_f32_16x16x32_bf16 v[48:51], v[220:223], a[144:147], v[48:51]
ds_read_b64_tr_b16 v[194:195], v12 offset:2048
ds_read2_b32 v[130:131], v42 offset0:130 offset1:131
v_mfma_f32_16x16x32_bf16 v[52:55], v[208:211], a[100:103], v[52:55]
buffer_load_dwordx4 v9, s[24:27], s57 offen offset:1024 lds
ds_read_b128 v[168:171], v46 offset:1024
v_mfma_f32_16x16x32_bf16 v[52:55], v[212:215], a[116:119], v[52:55]
ds_read_b64_tr_b16 v[196:197], v12 offset:4096
v_mfma_f32_16x16x32_bf16 v[52:55], v[216:219], a[132:135], v[52:55]
ds_read_b64_tr_b16 v[198:199], v12 offset:6144
v_mfma_f32_16x16x32_bf16 v[0:3], v[132:135], v[136:139], v[0:3]
buffer_load_dwordx4 v10, s[24:27], s57 offen offset:2048 lds
ds_read2_b32 v[132:133], v43 offset0:0 offset1:1
v_mfma_f32_16x16x32_bf16 v[52:55], v[220:223], a[148:151], v[52:55]
ds_read_b64_tr_b16 v[200:201], v12 offset:8192
ds_read2_b32 v[134:135], v43 offset0:2 offset1:3
v_mfma_f32_16x16x32_bf16 v[56:59], v[208:211], a[104:107], v[56:59]
ds_read_b64_tr_b16 v[202:203], v12 offset:10240
ds_read_b128 v[136:139], v46 offset:1536
v_mfma_f32_16x16x32_bf16 v[56:59], v[212:215], a[120:123], v[56:59]
buffer_load_dwordx4 v11, s[24:27], s57 offen offset:3072 lds
v_mfma_f32_16x16x32_bf16 v[56:59], v[216:219], a[136:139], v[56:59]
ds_read_b64_tr_b16 v[204:205], v12 offset:12288
v_mfma_f32_16x16x32_bf16 v[0:3], v[140:143], v[144:147], v[0:3]
s_add_u32 m0, s6, 139264
ds_read_b64_tr_b16 v[206:207], v12 offset:14336
v_mfma_f32_16x16x32_bf16 v[56:59], v[220:223], a[152:155], v[56:59]
s_xor_b32 s57, s84, 640
ds_read2_b32 v[162:163], v42 offset0:2 offset1:3
v_mfma_f32_16x16x32_bf16 v[60:63], v[208:211], a[108:111], v[60:63]
buffer_load_dwordx4 v8, s[24:27], s57 offen offset:0 lds
v_mfma_f32_16x16x32_bf16 v[60:63], v[212:215], a[124:127], v[60:63]
v_mfma_f32_16x16x32_bf16 v[60:63], v[216:219], a[140:143], v[60:63]
v_mfma_f32_16x16x32_bf16 v[0:3], v[148:151], v[152:155], v[0:3]
buffer_load_dwordx4 v9, s[24:27], s57 offen offset:1024 lds
v_mfma_f32_16x16x32_bf16 v[60:63], v[220:223], a[156:159], v[60:63]
s_waitcnt lgkmcnt(0)
v_mfma_f32_16x16x32_bf16 v[48:51], v[192:195], a[160:163], v[48:51]
ds_read2_b32 v[140:141], v43 offset0:128 offset1:129
v_mfma_f32_16x16x32_bf16 v[124:127], v[156:159], v[160:163], 0
ds_read2_b32 v[142:143], v43 offset0:130 offset1:131
v_mfma_f32_16x16x32_bf16 v[48:51], v[196:199], a[176:179], v[48:51]
buffer_load_dwordx4 v10, s[24:27], s57 offen offset:2048 lds
v_mfma_f32_16x16x32_bf16 v[48:51], v[200:203], a[192:195], v[48:51]
ds_read_b128 v[144:147], v46 offset:2048
v_mfma_f32_16x16x32_bf16 v[120:123], v[164:167], v[160:163], 0
ds_read_b128 v[148:151], v46 offset:2560
v_mfma_f32_16x16x32_bf16 v[48:51], v[204:207], a[208:211], v[48:51]
ds_read_b128 v[152:155], v46 offset:3072
v_mfma_f32_16x16x32_bf16 v[52:55], v[192:195], a[164:167], v[52:55]
buffer_load_dwordx4 v11, s[24:27], s57 offen offset:3072 lds
v_mfma_f32_16x16x32_bf16 v[124:127], v[164:167], v[128:131], v[124:127]
ds_read_b128 v[156:159], v46 offset:3584
v_mfma_f32_16x16x32_bf16 v[52:55], v[196:199], a[180:183], v[52:55]
v_mfma_f32_16x16x32_bf16 v[52:55], v[200:203], a[196:199], v[52:55]
ds_read_b64_tr_b16 v[208:209], v12 offset:16384
v_mfma_f32_16x16x32_bf16 v[116:119], v[168:171], v[160:163], 0
ds_read_b64_tr_b16 v[210:211], v12 offset:18432
v_mfma_f32_16x16x32_bf16 v[52:55], v[204:207], a[212:215], v[52:55]
ds_read_b64_tr_b16 v[212:213], v12 offset:20480
v_mfma_f32_16x16x32_bf16 v[56:59], v[192:195], a[168:171], v[56:59]
ds_read_b64_tr_b16 v[214:215], v12 offset:22528
v_mfma_f32_16x16x32_bf16 v[120:123], v[168:171], v[128:131], v[120:123]
ds_read_b64_tr_b16 v[216:217], v12 offset:24576
v_mfma_f32_16x16x32_bf16 v[56:59], v[196:199], a[184:187], v[56:59]
s_branch SK7
.p2align 12
PAD7:
s_branch L_back
SK7:
ds_read_b64_tr_b16 v[218:219], v12 offset:26624
v_mfma_f32_16x16x32_bf16 v[124:127], v[168:171], v[132:135], v[124:127]
ds_read_b64_tr_b16 v[220:221], v12 offset:28672
v_mfma_f32_16x16x32_bf16 v[56:59], v[200:203], a[200:203], v[56:59]
ds_read_b64_tr_b16 v[222:223], v12 offset:30720
v_mfma_f32_16x16x32_bf16 v[56:59], v[204:207], a[216:219], v[56:59]
v_mfma_f32_16x16x32_bf16 v[112:115], v[136:139], v[160:163], 0
v_mfma_f32_16x16x32_bf16 v[60:63], v[192:195], a[172:175], v[60:63]
v_mfma_f32_16x16x32_bf16 v[60:63], v[196:199], a[188:191], v[60:63]
v_mfma_f32_16x16x32_bf16 v[116:119], v[136:139], v[128:131], v[116:119]
v_mfma_f32_16x16x32_bf16 v[60:63], v[200:203], a[204:207], v[60:63]
v_mfma_f32_16x16x32_bf16 v[60:63], v[204:207], a[220:223], v[60:63]
v_mfma_f32_16x16x32_bf16 v[120:123], v[136:139], v[132:135], v[120:123]
s_waitcnt vmcnt(14) lgkmcnt(0)
s_barrier
v_mfma_f32_16x16x32_bf16 v[48:51], v[208:211], a[224:227], v[48:51]
s_add_u32 m0, s6, 0
ds_read2_b32 v[164:165], v44 offset0:0 offset1:1
v_and_b32 v22, 0xf0, v16
v_mfma_f32_16x16x32_bf16 v[124:127], v[136:139], v[140:143], v[124:127]
s_xor_b32 s83, s60, 512
s_add_u32 s57, s83, 73728
ds_read2_b32 v[166:167], v44 offset0:2 offset1:3
v_mfma_f32_16x16x32_bf16 v[48:51], v[212:215], a[240:243], v[48:51]
buffer_load_dwordx4 v8, s[24:27], s57 offen offset:0 lds
v_lshl_add_u32 v23, v17, 13, v22
v_mfma_f32_16x16x32_bf16 v[48:51], v[216:219], v[224:227], v[48:51]
buffer_load_dwordx4 v[80:83], v23, s[28:31], s77 offen sc1
s_add_u32 s71, s77, 0x40000
v_mfma_f32_16x16x32_bf16 v[108:111], v[144:147], v[160:163], 0
buffer_load_dwordx4 v[84:87], v23, s[28:31], s71 offen sc1
v_and_b32 v20, 1, v15
v_lshlrev_b32 v20, 4, v20
v_mfma_f32_16x16x32_bf16 v[48:51], v[220:223], v[240:243], v[48:51]
s_movk_i32 s70, 0x3f80
v_lshlrev_b32 v20, v20, s70
s_mov_b32 vcc_lo, 0x00030003
v_mfma_f32_16x16x32_bf16 v[52:55], v[208:211], a[228:231], v[52:55]
buffer_load_dwordx4 v9, s[24:27], s57 offen offset:1024 lds
s_mov_b32 vcc_hi, 0x00030003
v_mfma_f32_16x16x32_bf16 v[104:107], v[148:151], v[160:163], 0
ds_read_b64_tr_b16 v[192:193], v13 offset:24576
v_cndmask_b32 v88, 0, v20, vcc
s_lshl_b64 vcc, vcc, 4
v_mfma_f32_16x16x32_bf16 v[52:55], v[212:215], a[244:247], v[52:55]
ds_read_b64_tr_b16 v[194:195], v13 offset:26624
v_cndmask_b32 v90, 0, v20, vcc
v_mfma_f32_16x16x32_bf16 v[52:55], v[216:219], v[228:231], v[52:55]
ds_read_b64_tr_b16 v[196:197], v13 offset:28672
s_lshl_b64 vcc, vcc, 4
v_cndmask_b32 v89, 0, v20, vcc
v_mfma_f32_16x16x32_bf16 v[100:103], v[152:155], v[160:163], 0
buffer_load_dwordx4 v10, s[24:27], s57 offen offset:2048 lds
s_lshl_b64 vcc, vcc, 4
v_mfma_f32_16x16x32_bf16 v[52:55], v[220:223], v[244:247], v[52:55]
ds_read_b64_tr_b16 v[198:199], v13 offset:30720
v_cndmask_b32 v91, 0, v20, vcc
v_mfma_f32_16x16x32_bf16 v[56:59], v[208:211], a[232:235], v[56:59]
ds_read_b64_tr_b16 v[200:201], v13 offset:32768
v_mfma_f32_16x16x32_bf16 v[96:99], v[156:159], v[160:163], 0
ds_read_b64_tr_b16 v[202:203], v13 offset:34816
v_mfma_f32_16x16x32_bf16 v[56:59], v[212:215], a[248:251], v[56:59]
buffer_load_dwordx4 v11, s[24:27], s57 offen offset:3072 lds
v_mfma_f32_16x16x32_bf16 v[112:115], v[144:147], v[128:131], v[112:115]
ds_read_b64_tr_b16 v[204:205], v13 offset:36864
v_mfma_f32_16x16x32_bf16 v[56:59], v[216:219], v[232:235], v[56:59]
ds_read_b64_tr_b16 v[206:207], v13 offset:38912
v_mfma_f32_16x16x32_bf16 v[56:59], v[220:223], v[248:251], v[56:59]
s_add_u32 m0, s6, 16384
v_mfma_f32_16x16x32_bf16 v[108:111], v[148:151], v[128:131], v[108:111]
s_add_u32 s57, s83, 221184
v_mfma_f32_16x16x32_bf16 v[60:63], v[208:211], a[236:239], v[60:63]
buffer_load_dwordx4 v8, s[24:27], s57 offen offset:0 lds
v_mfma_f32_16x16x32_bf16 v[60:63], v[212:215], a[252:255], v[60:63]
v_mfma_f32_16x16x32_bf16 v[104:107], v[152:155], v[128:131], v[104:107]
v_mfma_f32_16x16x32_bf16 v[60:63], v[216:219], v[236:239], v[60:63]
v_mfma_f32_16x16x32_bf16 v[60:63], v[220:223], v[252:255], v[60:63]
buffer_load_dwordx4 v9, s[24:27], s57 offen offset:1024 lds
v_mfma_f32_16x16x32_bf16 v[100:103], v[156:159], v[128:131], v[100:103]
s_waitcnt lgkmcnt(0)
v_mfma_f32_16x16x32_bf16 v[64:67], v[192:195], a[0:3], 0
ds_read2_b32 v[168:169], v44 offset0:128 offset1:129
v_mfma_f32_16x16x32_bf16 v[116:119], v[144:147], v[132:135], v[116:119]
ds_read2_b32 v[170:171], v44 offset0:130 offset1:131
v_mfma_f32_16x16x32_bf16 v[64:67], v[196:199], a[16:19], v[64:67]
buffer_load_dwordx4 v10, s[24:27], s57 offen offset:2048 lds
v_mfma_f32_16x16x32_bf16 v[64:67], v[200:203], a[32:35], v[64:67]
ds_read2_b32 v[136:137], v45 offset0:0 offset1:1
v_mfma_f32_16x16x32_bf16 v[112:115], v[148:151], v[132:135], v[112:115]
ds_read2_b32 v[138:139], v45 offset0:2 offset1:3
v_mfma_f32_16x16x32_bf16 v[64:67], v[204:207], a[48:51], v[64:67]
ds_read2_b32 v[160:161], v45 offset0:128 offset1:129
v_mfma_f32_16x16x32_bf16 v[68:71], v[192:195], a[4:7], 0
buffer_load_dwordx4 v11, s[24:27], s57 offen offset:3072 lds
v_mfma_f32_16x16x32_bf16 v[108:111], v[152:155], v[132:135], v[108:111]
ds_read2_b32 v[162:163], v45 offset0:130 offset1:131
s_xor_b32 s43, s75, 0x0
v_cvt_pk_bf16_f32 v48, v48, v49
v_mfma_f32_16x16x32_bf16 v[68:71], v[196:199], a[20:23], v[68:71]
v_cvt_pk_bf16_f32 v49, v50, v51
v_cvt_pk_bf16_f32 v50, v52, v53
v_cvt_pk_bf16_f32 v51, v54, v55
v_mfma_f32_16x16x32_bf16 v[68:71], v[200:203], a[36:39], v[68:71]
ds_read_b64_tr_b16 v[208:209], v13 offset:40960
v_bfi_b32 v48, s61, v18, v48
v_mfma_f32_16x16x32_bf16 v[104:107], v[156:159], v[132:135], v[104:107]
ds_read_b64_tr_b16 v[210:211], v13 offset:43008
v_bfi_b32 v49, s61, v47, v49
v_bfi_b32 v50, s61, v18, v50
v_mfma_f32_16x16x32_bf16 v[68:71], v[204:207], a[52:55], v[68:71]
ds_read_b64_tr_b16 v[212:213], v13 offset:45056
v_bfi_b32 v51, s61, v47, v51
v_mfma_f32_16x16x32_bf16 v[72:75], v[192:195], a[8:11], 0
ds_read_b64_tr_b16 v[214:215], v13 offset:47104
v_mfma_f32_16x16x32_bf16 v[120:123], v[144:147], v[140:143], v[120:123]
ds_read_b64_tr_b16 v[216:217], v13 offset:49152
buffer_store_dwordx4 v[48:51], v16, s[28:31], s43 offen offset:0 sc1
v_cvt_pk_bf16_f32 v56, v56, v57
v_mfma_f32_16x16x32_bf16 v[72:75], v[196:199], a[24:27], v[72:75]
ds_read_b64_tr_b16 v[218:219], v13 offset:51200
v_cvt_pk_bf16_f32 v57, v58, v59
v_cvt_pk_bf16_f32 v58, v60, v61
v_mfma_f32_16x16x32_bf16 v[116:119], v[148:151], v[140:143], v[116:119]
ds_read_b64_tr_b16 v[220:221], v13 offset:53248
v_cvt_pk_bf16_f32 v59, v62, v63
v_mfma_f32_16x16x32_bf16 v[72:75], v[200:203], a[40:43], v[72:75]
ds_read_b64_tr_b16 v[222:223], v13 offset:55296
v_bfi_b32 v56, s61, v18, v56
v_bfi_b32 v57, s61, v47, v57
v_mfma_f32_16x16x32_bf16 v[72:75], v[204:207], a[56:59], v[72:75]
v_bfi_b32 v58, s61, v18, v58
v_bfi_b32 v59, s61, v47, v59
buffer_store_dwordx4 v[56:59], v16, s[28:31], s43 offen offset:1024 sc1
v_mfma_f32_16x16x32_bf16 v[112:115], v[152:155], v[140:143], v[112:115]
v_mfma_f32_16x16x32_bf16 v[76:79], v[192:195], a[12:15], 0
v_mfma_f32_16x16x32_bf16 v[76:79], v[196:199], a[28:31], v[76:79]
v_mfma_f32_16x16x32_bf16 v[108:111], v[156:159], v[140:143], v[108:111]
v_mfma_f32_16x16x32_bf16 v[76:79], v[200:203], a[44:47], v[76:79]
v_mfma_f32_16x16x32_bf16 v[76:79], v[204:207], a[60:63], v[76:79]
v_mfma_f32_16x16x32_bf16 v[124:127], v[144:147], v[164:167], v[124:127]
ds_read2_b32 v[144:145], v42 offset0:144 offset1:145
s_waitcnt vmcnt(16) lgkmcnt(1)
s_barrier
v_mfma_f32_16x16x32_bf16 v[64:67], v[208:211], a[64:67], v[64:67]
s_add_u32 m0, s6, 90112
ds_read_b128 v[128:131], v46 offset:64
v_mfma_f32_16x16x32_bf16 v[120:123], v[148:151], v[164:167], v[120:123]
s_add_u32 s57, s83, 368640
ds_read2_b32 v[132:133], v42 offset0:16 offset1:17
v_mfma_f32_16x16x32_bf16 v[64:67], v[212:215], a[80:83], v[64:67]
buffer_load_dwordx4 v8, s[24:27], s57 offen offset:0 lds
v_mfma_f32_16x16x32_bf16 v[64:67], v[216:219], a[96:99], v[64:67]
ds_read2_b32 v[134:135], v42 offset0:18 offset1:19
v_mfma_f32_16x16x32_bf16 v[116:119], v[152:155], v[164:167], v[116:119]
ds_read_b128 v[140:143], v46 offset:576
v_mfma_f32_16x16x32_bf16 v[64:67], v[220:223], a[112:115], v[64:67]
ds_read2_b32 v[146:147], v42 offset0:146 offset1:147
v_mfma_f32_16x16x32_bf16 v[68:71], v[208:211], a[68:71], v[68:71]
buffer_load_dwordx4 v9, s[24:27], s57 offen offset:1024 lds
v_mfma_f32_16x16x32_bf16 v[112:115], v[156:159], v[164:167], v[112:115]
ds_read_b128 v[164:167], v46 offset:1088
v_mfma_f32_16x16x32_bf16 v[68:71], v[212:215], a[84:87], v[68:71]
v_mfma_f32_16x16x32_bf16 v[68:71], v[216:219], a[100:103], v[68:71]
ds_read_b64_tr_b16 v[192:193], v13 offset:57344
v_mfma_f32_16x16x32_bf16 v[124:127], v[148:151], v[168:171], v[124:127]
ds_read_b64_tr_b16 v[194:195], v13 offset:59392
v_mfma_f32_16x16x32_bf16 v[68:71], v[220:223], a[116:119], v[68:71]
ds_read_b64_tr_b16 v[196:197], v13 offset:61440
v_mfma_f32_16x16x32_bf16 v[72:75], v[208:211], a[72:75], v[72:75]
ds_read_b64_tr_b16 v[198:199], v13 offset:63488
v_mfma_f32_16x16x32_bf16 v[120:123], v[152:155], v[168:171], v[120:123]
ds_read_b64_tr_b16 v[200:201], v14 offset:0
s_xor_b32 s71, s68, 0x2000
v_mfma_f32_16x16x32_bf16 v[72:75], v[212:215], a[88:91], v[72:75]
ds_read_b64_tr_b16 v[202:203], v14 offset:2048
v_mfma_f32_16x16x32_bf16 v[116:119], v[156:159], v[168:171], v[116:119]
ds_read_b64_tr_b16 v[204:205], v14 offset:4096
buffer_load_dwordx4 v[24:27], v16, s[28:31], s71 offen sc1
v_mfma_f32_16x16x32_bf16 v[72:75], v[216:219], a[104:107], v[72:75]
ds_read_b64_tr_b16 v[206:207], v14 offset:6144
v_mfma_f32_16x16x32_bf16 v[72:75], v[220:223], a[120:123], v[72:75]
buffer_load_dwordx4 v10, s[24:27], s57 offen offset:2048 lds
buffer_load_dwordx4 v[28:31], v16, s[28:31], s71 offen offset:1024 sc1
v_mfma_f32_16x16x32_bf16 v[124:127], v[152:155], v[136:139], v[124:127]
ds_read2_b32 v[148:149], v43 offset0:16 offset1:17
v_mfma_f32_16x16x32_bf16 v[76:79], v[208:211], a[76:79], v[76:79]
ds_read2_b32 v[150:151], v43 offset0:18 offset1:19
v_mfma_f32_16x16x32_bf16 v[76:79], v[212:215], a[92:95], v[76:79]
ds_read_b128 v[168:171], v46 offset:1600
v_mfma_f32_16x16x32_bf16 v[120:123], v[156:159], v[136:139], v[120:123]
buffer_load_dwordx4 v11, s[24:27], s57 offen offset:3072 lds
v_mfma_f32_16x16x32_bf16 v[76:79], v[216:219], a[108:111], v[76:79]
v_mfma_f32_16x16x32_bf16 v[76:79], v[220:223], a[124:127], v[76:79]
s_add_u32 m0, s6, 106496
s_waitcnt vmcnt(15)
v_xor_b32 v20, v80, v18
v_mfma_f32_16x16x32_bf16 v[124:127], v[156:159], v[160:163], v[124:127]
s_add_u32 s57, s83, 516096
v_bitop3_b32 v20, v81, v20, v47 bitop3:0xde
v_bitop3_b32 v20, v82, v20, v18 bitop3:0xde
s_waitcnt lgkmcnt(0)
v_mfma_f32_16x16x32_bf16 v[64:67], v[192:195], a[128:131], v[64:67]
buffer_load_dwordx4 v8, s[24:27], s57 offen offset:0 lds
v_bitop3_b32 v20, v83, v20, v47 bitop3:0xde
v_mfma_f32_16x16x32_bf16 v[124:127], v[128:131], v[132:135], v[124:127]
ds_read2_b32 v[152:153], v43 offset0:144 offset1:145
v_bitop3_b32 v20, v84, v20, v18 bitop3:0xde
v_bitop3_b32 v20, v85, v20, v47 bitop3:0xde
v_mfma_f32_16x16x32_bf16 v[64:67], v[196:199], a[144:147], v[64:67]
ds_read2_b32 v[154:155], v43 offset0:146 offset1:147
v_bitop3_b32 v20, v86, v20, v18 bitop3:0xde
v_mfma_f32_16x16x32_bf16 v[64:67], v[200:203], a[160:163], v[64:67]
ds_read_b128 v[136:139], v46 offset:2112
v_bitop3_b32 v20, v87, v20, v47 bitop3:0xde
v_and_b32 v20, s61, v20
v_mfma_f32_16x16x32_bf16 v[120:123], v[140:143], v[132:135], v[120:123]
buffer_load_dwordx4 v9, s[24:27], s57 offen offset:1024 lds
v_mfma_f32_16x16x32_bf16 v[64:67], v[204:207], a[176:179], v[64:67]
ds_read_b128 v[156:159], v46 offset:2624
v_cmp_ne_u32 vcc, 0, v20
s_cmp_lg_u64 vcc, 0
s_cbranch_scc1 Ps7
Pk6:
v_mfma_f32_16x16x32_bf16 v[68:71], v[192:195], a[132:135], v[68:71]
ds_read_b128 v[160:163], v46 offset:3136
v_mfma_f32_16x16x32_bf16 v[124:127], v[140:143], v[144:147], v[124:127]
ds_read_b64_tr_b16 v[208:209], v13 offset:8192
v_mfma_f32_16x16x32_bf16 v[92:95], v[88:91], v[80:83], 0
v_mfma_f32_16x16x32_bf16 v[68:71], v[196:199], a[148:151], v[68:71]
ds_read_b64_tr_b16 v[210:211], v13 offset:10240
v_mfma_f32_16x16x32_bf16 v[92:95], v[88:91], v[84:87], v[92:95]
v_mfma_f32_16x16x32_bf16 v[68:71], v[200:203], a[164:167], v[68:71]
buffer_load_dwordx4 v10, s[24:27], s57 offen offset:2048 lds
v_lshlrev_b32 v20, 16, v181
v_mfma_f32_16x16x32_bf16 v[116:119], v[164:167], v[132:135], v[116:119]
ds_read_b64_tr_b16 v[212:213], v13 offset:12288
v_and_b32 v21, s64, v181
v_lshlrev_b32 v22, 16, v180
v_mfma_f32_16x16x32_bf16 v[68:71], v[204:207], a[180:183], v[68:71]
ds_read_b64_tr_b16 v[214:215], v13 offset:14336
v_and_b32 v23, s64, v180
v_mfma_f32_16x16x32_bf16 v[72:75], v[192:195], a[136:139], v[72:75]
ds_read_b64_tr_b16 v[216:217], v13 offset:16384
v_fma_f32 v20, v20, v41, v40
v_fma_f32 v21, v21, v41, v40
v_mfma_f32_16x16x32_bf16 v[120:123], v[164:167], v[144:147], v[120:123]
buffer_load_dwordx4 v11, s[24:27], s57 offen offset:3072 lds
v_add_f32 v20, v20, v22
v_mfma_f32_16x16x32_bf16 v[72:75], v[196:199], a[152:155], v[72:75]
ds_read_b64_tr_b16 v[218:219], v13 offset:18432
v_add_f32 v21, v21, v23
v_fma_f32 v40, v92, s65, v20
v_mfma_f32_16x16x32_bf16 v[124:127], v[164:167], v[148:151], v[124:127]
ds_read_b64_tr_b16 v[220:221], v13 offset:20480
v_fma_f32 v41, v93, s65, v21
v_mfma_f32_16x16x32_bf16 v[72:75], v[200:203], a[168:171], v[72:75]
ds_read_b64_tr_b16 v[222:223], v13 offset:22528
v_mfma_f32_16x16x32_bf16 v[72:75], v[204:207], a[184:187], v[72:75]
ds_read_b128 v[128:131], v46 offset:3648
v_mfma_f32_16x16x32_bf16 v[112:115], v[168:171], v[132:135], v[112:115]
v_mfma_f32_16x16x32_bf16 v[76:79], v[192:195], a[140:143], v[76:79]
v_mfma_f32_16x16x32_bf16 v[76:79], v[196:199], a[156:159], v[76:79]
v_mfma_f32_16x16x32_bf16 v[116:119], v[168:171], v[144:147], v[116:119]
v_mfma_f32_16x16x32_bf16 v[76:79], v[200:203], a[172:175], v[76:79]
v_mfma_f32_16x16x32_bf16 v[76:79], v[204:207], a[188:191], v[76:79]
v_mfma_f32_16x16x32_bf16 v[120:123], v[168:171], v[148:151], v[120:123]
s_waitcnt vmcnt(16) lgkmcnt(0)
s_barrier
v_mfma_f32_16x16x32_bf16 v[64:67], v[208:211], a[192:195], v[64:67]
s_add_u32 m0, s6, 73728
ds_read2_b32 v[140:141], v44 offset0:16 offset1:17
v_mfma_f32_16x16x32_bf16 v[124:127], v[168:171], v[152:155], v[124:127]
s_xor_b32 s83, s60, 384
ds_read2_b32 v[142:143], v44 offset0:18 offset1:19
v_mfma_f32_16x16x32_bf16 v[64:67], v[212:215], a[208:211], v[64:67]
buffer_load_dwordx4 v8, s[24:27], s83 offen offset:0 lds
v_mfma_f32_16x16x32_bf16 v[64:67], v[216:219], a[224:227], v[64:67]
ds_read2_b32 v[164:165], v44 offset0:144 offset1:145
v_mfma_f32_16x16x32_bf16 v[108:111], v[136:139], v[132:135], v[108:111]
ds_read2_b32 v[168:169], v45 offset0:16 offset1:17
v_mfma_f32_16x16x32_bf16 v[64:67], v[220:223], a[240:243], v[64:67]
v_mfma_f32_16x16x32_bf16 v[68:71], v[208:211], a[196:199], v[68:71]
buffer_load_dwordx4 v9, s[24:27], s83 offen offset:1024 lds
v_mfma_f32_16x16x32_bf16 v[104:107], v[156:159], v[132:135], v[104:107]
v_mfma_f32_16x16x32_bf16 v[68:71], v[212:215], a[212:215], v[68:71]
ds_read_b64_tr_b16 v[192:193], v14 offset:8192
v_mfma_f32_16x16x32_bf16 v[68:71], v[216:219], a[228:231], v[68:71]
ds_read_b64_tr_b16 v[194:195], v14 offset:10240
v_mfma_f32_16x16x32_bf16 v[100:103], v[160:163], v[132:135], v[100:103]
buffer_load_dwordx4 v10, s[24:27], s83 offen offset:2048 lds
v_mfma_f32_16x16x32_bf16 v[68:71], v[220:223], a[244:247], v[68:71]
ds_read_b64_tr_b16 v[196:197], v14 offset:12288
v_mfma_f32_16x16x32_bf16 v[72:75], v[208:211], a[200:203], v[72:75]
ds_read_b64_tr_b16 v[198:199], v14 offset:14336
v_mfma_f32_16x16x32_bf16 v[96:99], v[128:131], v[132:135], v[96:99]
ds_read_b64_tr_b16 v[200:201], v14 offset:16384
v_mfma_f32_16x16x32_bf16 v[72:75], v[212:215], a[216:219], v[72:75]
ds_read_b64_tr_b16 v[202:203], v14 offset:18432
v_mfma_f32_16x16x32_bf16 v[112:115], v[136:139], v[144:147], v[112:115]
ds_read_b64_tr_b16 v[204:205], v14 offset:20480
v_mfma_f32_16x16x32_bf16 v[72:75], v[216:219], a[232:235], v[72:75]
ds_read_b64_tr_b16 v[206:207], v14 offset:22528
v_mfma_f32_16x16x32_bf16 v[72:75], v[220:223], a[248:251], v[72:75]
ds_read2_b32 v[132:133], v45 offset0:144 offset1:145
v_mfma_f32_16x16x32_bf16 v[108:111], v[156:159], v[144:147], v[108:111]
v_mfma_f32_16x16x32_bf16 v[76:79], v[208:211], a[204:207], v[76:79]
v_mfma_f32_16x16x32_bf16 v[76:79], v[212:215], a[220:223], v[76:79]
v_mfma_f32_16x16x32_bf16 v[104:107], v[160:163], v[144:147], v[104:107]
v_mfma_f32_16x16x32_bf16 v[76:79], v[216:219], a[236:239], v[76:79]
v_mfma_f32_16x16x32_bf16 v[76:79], v[220:223], a[252:255], v[76:79]
v_mfma_f32_16x16x32_bf16 v[100:103], v[128:131], v[144:147], v[100:103]
s_waitcnt lgkmcnt(1)
v_mfma_f32_16x16x32_bf16 v[64:67], v[192:195], v[224:227], v[64:67]
ds_read2_b32 v[166:167], v44 offset0:146 offset1:147
v_mfma_f32_16x16x32_bf16 v[116:119], v[136:139], v[148:151], v[116:119]
ds_read2_b32 v[170:171], v45 offset0:18 offset1:19
v_mfma_f32_16x16x32_bf16 v[64:67], v[196:199], v[240:243], v[64:67]
ds_read2_b32 v[134:135], v45 offset0:146 offset1:147
v_mfma_f32_16x16x32_bf16 v[68:71], v[192:195], v[228:231], v[68:71]
v_mfma_f32_16x16x32_bf16 v[112:115], v[156:159], v[148:151], v[112:115]
v_mfma_f32_16x16x32_bf16 v[68:71], v[196:199], v[244:247], v[68:71]
buffer_load_dwordx4 v11, s[24:27], s83 offen offset:3072 lds
v_mfma_f32_16x16x32_bf16 v[72:75], v[192:195], v[232:235], v[72:75]
v_mfma_f32_16x16x32_bf16 v[108:111], v[160:163], v[148:151], v[108:111]
s_add_u32 m0, s6, 122880
ds_read_b64_tr_b16 v[208:209], v12 offset:0
v_mfma_f32_16x16x32_bf16 v[72:75], v[196:199], v[248:251], v[72:75]
s_add_u32 s57, s83, 147456
ds_read_b64_tr_b16 v[210:211], v12 offset:2048
v_mfma_f32_16x16x32_bf16 v[76:79], v[192:195], v[236:239], v[76:79]
buffer_load_dwordx4 v8, s[24:27], s57 offen offset:0 lds
v_mfma_f32_16x16x32_bf16 v[104:107], v[128:131], v[148:151], v[104:107]
ds_read_b64_tr_b16 v[212:213], v12 offset:4096
v_mfma_f32_16x16x32_bf16 v[76:79], v[196:199], v[252:255], v[76:79]
ds_read_b64_tr_b16 v[214:215], v12 offset:6144
v_mfma_f32_16x16x32_bf16 v[48:51], v[200:203], a[0:3], 0
ds_read_b64_tr_b16 v[216:217], v12 offset:8192
s_waitcnt vmcnt(10)
v_mfma_f32_16x16x32_bf16 v[120:123], v[136:139], v[152:155], v[120:123]
buffer_load_dwordx4 v9, s[24:27], s57 offen offset:1024 lds
v_xor_b32 v20, v24, v18
v_bitop3_b32 v20, v25, v20, v47 bitop3:0xde
v_bitop3_b32 v20, v26, v20, v18 bitop3:0xde
v_mfma_f32_16x16x32_bf16 v[48:51], v[204:207], a[16:19], v[48:51]
ds_read_b64_tr_b16 v[218:219], v12 offset:10240
v_bitop3_b32 v20, v27, v20, v47 bitop3:0xde
v_bitop3_b32 v20, v28, v20, v18 bitop3:0xde
v_bitop3_b32 v20, v29, v20, v47 bitop3:0xde
v_mfma_f32_16x16x32_bf16 v[116:119], v[156:159], v[152:155], v[116:119]
ds_read_b64_tr_b16 v[220:221], v12 offset:12288
v_bitop3_b32 v20, v30, v20, v18 bitop3:0xde
v_bitop3_b32 v20, v31, v20, v47 bitop3:0xde
v_and_b32 v20, s61, v20
v_mfma_f32_16x16x32_bf16 v[52:55], v[200:203], a[4:7], 0
ds_read_b64_tr_b16 v[222:223], v12 offset:14336
v_cmp_ne_u32 vcc, 0, v20
s_cmp_lg_u64 vcc, 0
s_cbranch_scc1 Ps10
Pk9:
v_lshlrev_b32 v20, 16, v178
v_mfma_f32_16x16x32_bf16 v[52:55], v[204:207], a[20:23], v[52:55]
buffer_load_dwordx4 v10, s[24:27], s57 offen offset:2048 lds
v_and_b32 v21, s64, v178
v_mfma_f32_16x16x32_bf16 v[112:115], v[160:163], v[152:155], v[112:115]
ds_read2_b32 v[150:151], v42 offset0:34 offset1:35
v_lshlrev_b32 v22, 16, v179
v_and_b32 v23, s64, v179
v_mfma_f32_16x16x32_bf16 v[56:59], v[200:203], a[8:11], 0
v_mul_f32 v20, s63, v20
v_mul_f32 v21, s63, v21
v_mfma_f32_16x16x32_bf16 v[56:59], v[204:207], a[24:27], v[56:59]
v_mul_f32 v22, s63, v22
v_mul_f32 v23, s63, v23
s_nop 0
v_mfma_f32_16x16x32_bf16 v[108:111], v[128:131], v[152:155], v[108:111]
buffer_load_dwordx4 v11, s[24:27], s57 offen offset:3072 lds
s_nop 0
v_mfma_f32_16x16x32_bf16 v[80:83], v[174:177], v[24:27], v[20:23]
v_mfma_f32_16x16x32_bf16 v[84:87], v[172:175], v[24:27], v[20:23]
v_mfma_f32_16x16x32_bf16 v[88:91], v[174:177], v[28:31], v[20:23]
v_mfma_f32_16x16x32_bf16 v[92:95], v[172:175], v[28:31], v[20:23]
s_nop 2
v_mfma_f32_16x16x32_bf16 v[60:63], v[200:203], a[12:15], 0
v_mfma_f32_16x16x32_bf16 v[60:63], v[204:207], a[28:31], v[60:63]
s_xor_b32 s43, s68, 0x2000
v_cvt_pk_bf16_f32 v64, v64, v65
v_mfma_f32_16x16x32_bf16 v[124:127], v[136:139], v[140:143], v[124:127]
ds_read2_b32 v[136:137], v42 offset0:160 offset1:161
v_cvt_pk_bf16_f32 v65, v66, v67
v_cvt_pk_bf16_f32 v66, v68, v69
s_waitcnt vmcnt(12) lgkmcnt(2)
s_barrier
v_mfma_f32_16x16x32_bf16 v[48:51], v[208:211], a[32:35], v[48:51]
s_add_u32 m0, s6, 0
ds_read_b128 v[144:147], v46 offset:128
v_mfma_f32_16x16x32_bf16 v[120:123], v[156:159], v[140:143], v[120:123]
s_add_u32 s57, s83, 294912
ds_read2_b32 v[148:149], v42 offset0:32 offset1:33
v_cvt_pk_bf16_f32 v67, v70, v71
v_mfma_f32_16x16x32_bf16 v[48:51], v[212:215], a[48:51], v[48:51]
buffer_load_dwordx4 v8, s[24:27], s57 offen offset:0 lds
v_bfi_b32 v64, s61, v18, v64
v_mfma_f32_16x16x32_bf16 v[48:51], v[216:219], a[64:67], v[48:51]
ds_read_b128 v[152:155], v46 offset:640
v_bfi_b32 v65, s61, v19, v65
v_mfma_f32_16x16x32_bf16 v[116:119], v[160:163], v[140:143], v[116:119]
ds_read2_b32 v[138:139], v42 offset0:162 offset1:163
v_mfma_f32_16x16x32_bf16 v[48:51], v[220:223], a[80:83], v[48:51]
buffer_store_dwordx4 v[64:67], v16, s[28:31], s43 offen offset:0 sc1
v_cvt_pk_bf16_f32 v72, v72, v73
v_cvt_pk_bf16_f32 v73, v74, v75
v_mfma_f32_16x16x32_bf16 v[52:55], v[208:211], a[36:39], v[52:55]
buffer_load_dwordx4 v9, s[24:27], s57 offen offset:1024 lds
v_cvt_pk_bf16_f32 v74, v76, v77
v_cvt_pk_bf16_f32 v75, v78, v79
v_mfma_f32_16x16x32_bf16 v[112:115], v[128:131], v[140:143], v[112:115]
ds_read_b64_tr_b16 v[192:193], v12 offset:16384
v_bfi_b32 v72, s61, v18, v72
v_mfma_f32_16x16x32_bf16 v[52:55], v[212:215], a[52:55], v[52:55]
ds_read_b64_tr_b16 v[194:195], v12 offset:18432
v_bfi_b32 v73, s61, v19, v73
v_mfma_f32_16x16x32_bf16 v[52:55], v[216:219], a[68:71], v[52:55]
ds_read_b64_tr_b16 v[196:197], v12 offset:20480
v_mfma_f32_16x16x32_bf16 v[124:127], v[156:159], v[164:167], v[124:127]
buffer_load_dwordx4 v10, s[24:27], s57 offen offset:2048 lds
buffer_store_dwordx4 v[72:75], v16, s[28:31], s43 offen offset:1024 sc1
v_mfma_f32_16x16x32_bf16 v[52:55], v[220:223], a[84:87], v[52:55]
ds_read_b64_tr_b16 v[198:199], v12 offset:22528
v_mfma_f32_16x16x32_bf16 v[56:59], v[208:211], a[40:43], v[56:59]
ds_read_b64_tr_b16 v[200:201], v12 offset:24576
v_mfma_f32_16x16x32_bf16 v[120:123], v[160:163], v[164:167], v[120:123]
ds_read_b64_tr_b16 v[202:203], v12 offset:26624
v_mfma_f32_16x16x32_bf16 v[56:59], v[212:215], a[56:59], v[56:59]
buffer_load_dwordx4 v11, s[24:27], s57 offen offset:3072 lds
v_mfma_f32_16x16x32_bf16 v[116:119], v[128:131], v[164:167], v[116:119]
ds_read_b64_tr_b16 v[204:205], v12 offset:28672
ds_read_b128 v[164:167], v46 offset:1664
v_mfma_f32_16x16x32_bf16 v[56:59], v[216:219], a[72:75], v[56:59]
ds_read_b64_tr_b16 v[206:207], v12 offset:30720
v_mfma_f32_16x16x32_bf16 v[56:59], v[220:223], a[88:91], v[56:59]
s_add_u32 m0, s6, 139264
ds_read_b128 v[140:143], v46 offset:1152
v_mfma_f32_16x16x32_bf16 v[124:127], v[160:163], v[168:171], v[124:127]
s_add_u32 s57, s83, 442368
ds_read2_b32 v[156:157], v43 offset0:32 offset1:33
v_mfma_f32_16x16x32_bf16 v[60:63], v[208:211], a[44:47], v[60:63]
buffer_load_dwordx4 v8, s[24:27], s57 offen offset:0 lds
v_mfma_f32_16x16x32_bf16 v[60:63], v[212:215], a[60:63], v[60:63]
ds_read2_b32 v[158:159], v43 offset0:34 offset1:35
v_mfma_f32_16x16x32_bf16 v[120:123], v[128:131], v[168:171], v[120:123]
v_mfma_f32_16x16x32_bf16 v[60:63], v[216:219], a[76:79], v[60:63]
v_mfma_f32_16x16x32_bf16 v[60:63], v[220:223], a[92:95], v[60:63]
buffer_load_dwordx4 v9, s[24:27], s57 offen offset:1024 lds
v_mfma_f32_16x16x32_bf16 v[124:127], v[128:131], v[132:135], v[124:127]
s_waitcnt lgkmcnt(0)
v_mfma_f32_16x16x32_bf16 v[48:51], v[192:195], a[96:99], v[48:51]
ds_read2_b32 v[160:161], v43 offset0:160 offset1:161
s_xor_b32 s71, s75, 0x180000
v_mfma_f32_16x16x32_bf16 v[124:127], v[144:147], v[148:151], v[124:127]
ds_read2_b32 v[162:163], v43 offset0:162 offset1:163
v_mfma_f32_16x16x32_bf16 v[48:51], v[196:199], a[112:115], v[48:51]
buffer_load_dwordx4 v10, s[24:27], s57 offen offset:2048 lds
buffer_load_dwordx4 v[24:27], v16, s[28:31], s71 offen sc1
v_mfma_f32_16x16x32_bf16 v[48:51], v[200:203], a[128:131], v[48:51]
ds_read_b128 v[168:171], v46 offset:2176
v_mfma_f32_16x16x32_bf16 v[120:123], v[152:155], v[148:151], v[120:123]
ds_read_b128 v[128:131], v46 offset:2688
buffer_load_dwordx4 v[28:31], v16, s[28:31], s71 offen offset:1024 sc1
v_mfma_f32_16x16x32_bf16 v[48:51], v[204:207], a[144:147], v[48:51]
ds_read_b128 v[132:135], v46 offset:3200
v_mfma_f32_16x16x32_bf16 v[52:55], v[192:195], a[100:103], v[52:55]
buffer_load_dwordx4 v11, s[24:27], s57 offen offset:3072 lds
v_mfma_f32_16x16x32_bf16 v[124:127], v[152:155], v[136:139], v[124:127]
ds_read_b128 v[144:147], v46 offset:3712
v_mfma_f32_16x16x32_bf16 v[52:55], v[196:199], a[116:119], v[52:55]
v_mfma_f32_16x16x32_bf16 v[52:55], v[200:203], a[132:135], v[52:55]
ds_read_b64_tr_b16 v[208:209], v13 offset:24576
v_mfma_f32_16x16x32_bf16 v[116:119], v[140:143], v[148:151], v[116:119]
ds_read_b64_tr_b16 v[210:211], v13 offset:26624
v_mfma_f32_16x16x32_bf16 v[52:55], v[204:207], a[148:151], v[52:55]
ds_read_b64_tr_b16 v[212:213], v13 offset:28672
v_mfma_f32_16x16x32_bf16 v[56:59], v[192:195], a[104:107], v[56:59]
ds_read_b64_tr_b16 v[214:215], v13 offset:30720
v_mfma_f32_16x16x32_bf16 v[120:123], v[140:143], v[136:139], v[120:123]
ds_read_b64_tr_b16 v[216:217], v13 offset:32768
v_mfma_f32_16x16x32_bf16 v[56:59], v[196:199], a[120:123], v[56:59]
ds_read_b64_tr_b16 v[218:219], v13 offset:34816
v_mfma_f32_16x16x32_bf16 v[124:127], v[140:143], v[156:159], v[124:127]
ds_read_b64_tr_b16 v[220:221], v13 offset:36864
v_mfma_f32_16x16x32_bf16 v[56:59], v[200:203], a[136:139], v[56:59]
ds_read_b64_tr_b16 v[222:223], v13 offset:38912
v_mfma_f32_16x16x32_bf16 v[56:59], v[204:207], a[152:155], v[56:59]
v_mfma_f32_16x16x32_bf16 v[112:115], v[164:167], v[148:151], v[112:115]
v_mfma_f32_16x16x32_bf16 v[60:63], v[192:195], a[108:111], v[60:63]
v_mfma_f32_16x16x32_bf16 v[60:63], v[196:199], a[124:127], v[60:63]
v_mfma_f32_16x16x32_bf16 v[116:119], v[164:167], v[136:139], v[116:119]
v_mfma_f32_16x16x32_bf16 v[60:63], v[200:203], a[140:143], v[60:63]
v_mfma_f32_16x16x32_bf16 v[60:63], v[204:207], a[156:159], v[60:63]
v_mfma_f32_16x16x32_bf16 v[120:123], v[164:167], v[156:159], v[120:123]
s_waitcnt vmcnt(16) lgkmcnt(0)
s_barrier
v_mfma_f32_16x16x32_bf16 v[48:51], v[208:211], a[160:163], v[48:51]
s_add_u32 m0, s6, 16384
ds_read2_b32 v[152:153], v44 offset0:32 offset1:33
v_mfma_f32_16x16x32_bf16 v[124:127], v[164:167], v[160:163], v[124:127]
s_xor_b32 s57, s84, 384
ds_read2_b32 v[154:155], v44 offset0:34 offset1:35
v_mfma_f32_16x16x32_bf16 v[48:51], v[212:215], a[176:179], v[48:51]
buffer_load_dwordx4 v8, s[24:27], s57 offen offset:0 lds
v_mfma_f32_16x16x32_bf16 v[48:51], v[216:219], a[192:195], v[48:51]
v_mfma_f32_16x16x32_bf16 v[108:111], v[168:171], v[148:151], v[108:111]
v_mfma_f32_16x16x32_bf16 v[48:51], v[220:223], a[208:211], v[48:51]
v_mfma_f32_16x16x32_bf16 v[52:55], v[208:211], a[164:167], v[52:55]
buffer_load_dwordx4 v9, s[24:27], s57 offen offset:1024 lds
v_mfma_f32_16x16x32_bf16 v[104:107], v[128:131], v[148:151], v[104:107]
ds_read_b64_tr_b16 v[192:193], v13 offset:40960
v_mfma_f32_16x16x32_bf16 v[52:55], v[212:215], a[180:183], v[52:55]
ds_read_b64_tr_b16 v[194:195], v13 offset:43008
v_mfma_f32_16x16x32_bf16 v[52:55], v[216:219], a[196:199], v[52:55]
ds_read_b64_tr_b16 v[196:197], v13 offset:45056
v_mfma_f32_16x16x32_bf16 v[100:103], v[132:135], v[148:151], v[100:103]
buffer_load_dwordx4 v10, s[24:27], s57 offen offset:2048 lds
v_mfma_f32_16x16x32_bf16 v[52:55], v[220:223], a[212:215], v[52:55]
ds_read_b64_tr_b16 v[198:199], v13 offset:47104
v_mfma_f32_16x16x32_bf16 v[56:59], v[208:211], a[168:171], v[56:59]
ds_read_b64_tr_b16 v[200:201], v13 offset:49152
v_mfma_f32_16x16x32_bf16 v[96:99], v[144:147], v[148:151], v[96:99]
ds_read_b64_tr_b16 v[202:203], v13 offset:51200
v_mfma_f32_16x16x32_bf16 v[56:59], v[212:215], a[184:187], v[56:59]
buffer_load_dwordx4 v11, s[24:27], s57 offen offset:3072 lds
v_mfma_f32_16x16x32_bf16 v[112:115], v[168:171], v[136:139], v[112:115]
ds_read_b64_tr_b16 v[204:205], v13 offset:53248
v_mfma_f32_16x16x32_bf16 v[56:59], v[216:219], a[200:203], v[56:59]
ds_read_b64_tr_b16 v[206:207], v13 offset:55296
v_mfma_f32_16x16x32_bf16 v[56:59], v[220:223], a[216:219], v[56:59]
s_add_u32 m0, s6, 90112
v_mfma_f32_16x16x32_bf16 v[108:111], v[128:131], v[136:139], v[108:111]
s_xor_b32 s83, s60, 256
s_add_u32 s57, s83, 73728
v_mfma_f32_16x16x32_bf16 v[60:63], v[208:211], a[172:175], v[60:63]
s_branch SK8
.p2align 12
PAD8:
s_branch L_back
SK8:
buffer_load_dwordx4 v8, s[24:27], s57 offen offset:0 lds
v_mfma_f32_16x16x32_bf16 v[60:63], v[212:215], a[188:191], v[60:63]
v_mfma_f32_16x16x32_bf16 v[104:107], v[132:135], v[136:139], v[104:107]
v_mfma_f32_16x16x32_bf16 v[60:63], v[216:219], a[204:207], v[60:63]
v_mfma_f32_16x16x32_bf16 v[60:63], v[220:223], a[220:223], v[60:63]
buffer_load_dwordx4 v9, s[24:27], s57 offen offset:1024 lds
v_mfma_f32_16x16x32_bf16 v[100:103], v[144:147], v[136:139], v[100:103]
s_waitcnt lgkmcnt(0)
v_mfma_f32_16x16x32_bf16 v[48:51], v[192:195], a[224:227], v[48:51]
ds_read2_b32 v[140:141], v44 offset0:160 offset1:161
v_mfma_f32_16x16x32_bf16 v[116:119], v[168:171], v[156:159], v[116:119]
ds_read2_b32 v[142:143], v44 offset0:162 offset1:163
v_mfma_f32_16x16x32_bf16 v[48:51], v[196:199], a[240:243], v[48:51]
buffer_load_dwordx4 v10, s[24:27], s57 offen offset:2048 lds
v_mfma_f32_16x16x32_bf16 v[48:51], v[200:203], v[224:227], v[48:51]
ds_read2_b32 v[164:165], v45 offset0:32 offset1:33
v_mfma_f32_16x16x32_bf16 v[112:115], v[128:131], v[156:159], v[112:115]
ds_read2_b32 v[166:167], v45 offset0:34 offset1:35
v_mfma_f32_16x16x32_bf16 v[48:51], v[204:207], v[240:243], v[48:51]
ds_read2_b32 v[148:149], v45 offset0:160 offset1:161
v_mfma_f32_16x16x32_bf16 v[52:55], v[192:195], a[228:231], v[52:55]
buffer_load_dwordx4 v11, s[24:27], s57 offen offset:3072 lds
v_mfma_f32_16x16x32_bf16 v[108:111], v[132:135], v[156:159], v[108:111]
ds_read2_b32 v[150:151], v45 offset0:162 offset1:163
v_mfma_f32_16x16x32_bf16 v[52:55], v[196:199], a[244:247], v[52:55]
v_mfma_f32_16x16x32_bf16 v[52:55], v[200:203], v[228:231], v[52:55]
ds_read_b64_tr_b16 v[208:209], v13 offset:8192
v_mfma_f32_16x16x32_bf16 v[104:107], v[144:147], v[156:159], v[104:107]
ds_read_b64_tr_b16 v[210:211], v13 offset:10240
v_mfma_f32_16x16x32_bf16 v[52:55], v[204:207], v[244:247], v[52:55]
ds_read_b64_tr_b16 v[212:213], v13 offset:12288
v_mfma_f32_16x16x32_bf16 v[56:59], v[192:195], a[232:235], v[56:59]
ds_read_b64_tr_b16 v[214:215], v13 offset:14336
v_mfma_f32_16x16x32_bf16 v[120:123], v[168:171], v[160:163], v[120:123]
ds_read_b64_tr_b16 v[216:217], v13 offset:16384
v_mfma_f32_16x16x32_bf16 v[56:59], v[196:199], a[248:251], v[56:59]
ds_read_b64_tr_b16 v[218:219], v13 offset:18432
v_mfma_f32_16x16x32_bf16 v[116:119], v[128:131], v[160:163], v[116:119]
ds_read_b64_tr_b16 v[220:221], v13 offset:20480
v_mfma_f32_16x16x32_bf16 v[56:59], v[200:203], v[232:235], v[56:59]
ds_read_b64_tr_b16 v[222:223], v13 offset:22528
v_mfma_f32_16x16x32_bf16 v[56:59], v[204:207], v[248:251], v[56:59]
ds_read2_b32 v[158:159], v42 offset0:50 offset1:51
v_mfma_f32_16x16x32_bf16 v[112:115], v[132:135], v[160:163], v[112:115]
v_mfma_f32_16x16x32_bf16 v[60:63], v[192:195], a[236:239], v[60:63]
v_mfma_f32_16x16x32_bf16 v[60:63], v[196:199], a[252:255], v[60:63]
v_mfma_f32_16x16x32_bf16 v[108:111], v[144:147], v[160:163], v[108:111]
v_mfma_f32_16x16x32_bf16 v[60:63], v[200:203], v[236:239], v[60:63]
v_mfma_f32_16x16x32_bf16 v[60:63], v[204:207], v[252:255], v[60:63]
s_waitcnt vmcnt(9)
v_xor_b32 v20, v24, v18
v_mfma_f32_16x16x32_bf16 v[124:127], v[168:171], v[152:155], v[124:127]
ds_read2_b32 v[168:169], v42 offset0:176 offset1:177
v_bitop3_b32 v20, v25, v20, v47 bitop3:0xde
v_bitop3_b32 v20, v26, v20, v18 bitop3:0xde
s_waitcnt lgkmcnt(2)
s_barrier
v_mfma_f32_16x16x32_bf16 v[64:67], v[208:211], a[0:3], 0
s_add_u32 m0, s6, 73728
ds_read_b128 v[136:139], v46 offset:192
v_bitop3_b32 v20, v27, v20, v47 bitop3:0xde
v_mfma_f32_16x16x32_bf16 v[120:123], v[128:131], v[152:155], v[120:123]
s_add_u32 s57, s83, 221184
ds_read2_b32 v[156:157], v42 offset0:48 offset1:49
v_bitop3_b32 v20, v28, v20, v18 bitop3:0xde
v_mfma_f32_16x16x32_bf16 v[64:67], v[212:215], a[16:19], v[64:67]
buffer_load_dwordx4 v8, s[24:27], s57 offen offset:0 lds
v_bitop3_b32 v20, v29, v20, v47 bitop3:0xde
v_bitop3_b32 v20, v30, v20, v18 bitop3:0xde
v_mfma_f32_16x16x32_bf16 v[64:67], v[216:219], a[32:35], v[64:67]
ds_read_b128 v[160:163], v46 offset:704
v_bitop3_b32 v20, v31, v20, v47 bitop3:0xde
v_and_b32 v20, s61, v20
v_cmp_ne_u32 vcc, 0, v20
s_cmp_lg_u64 vcc, 0
s_cbranch_scc1 Ps13
Pk12:
v_xor_b32 v47, 0x10000, v47
v_mfma_f32_16x16x32_bf16 v[116:119], v[132:135], v[152:155], v[116:119]
ds_read2_b32 v[170:171], v42 offset0:178 offset1:179
v_mfma_f32_16x16x32_bf16 v[64:67], v[220:223], a[48:51], v[64:67]
v_mfma_f32_16x16x32_bf16 v[80:83], v[174:177], v[24:27], v[80:83]
v_mfma_f32_16x16x32_bf16 v[68:71], v[208:211], a[4:7], 0
buffer_load_dwordx4 v9, s[24:27], s57 offen offset:1024 lds
v_mfma_f32_16x16x32_bf16 v[112:115], v[144:147], v[152:155], v[112:115]
ds_read_b64_tr_b16 v[192:193], v13 offset:57344
v_mfma_f32_16x16x32_bf16 v[84:87], v[172:175], v[24:27], v[84:87]
v_mfma_f32_16x16x32_bf16 v[68:71], v[212:215], a[20:23], v[68:71]
ds_read_b64_tr_b16 v[194:195], v13 offset:59392
v_mfma_f32_16x16x32_bf16 v[88:91], v[174:177], v[28:31], v[88:91]
v_mfma_f32_16x16x32_bf16 v[92:95], v[172:175], v[28:31], v[92:95]
v_mfma_f32_16x16x32_bf16 v[68:71], v[216:219], a[36:39], v[68:71]
ds_read_b64_tr_b16 v[196:197], v13 offset:61440
v_mfma_f32_16x16x32_bf16 v[124:127], v[128:131], v[140:143], v[124:127]
buffer_load_dwordx4 v10, s[24:27], s57 offen offset:2048 lds
s_xor_b32 s43, s75, 0x180000
v_mfma_f32_16x16x32_bf16 v[68:71], v[220:223], a[52:55], v[68:71]
ds_read_b64_tr_b16 v[198:199], v13 offset:63488
v_cvt_pk_bf16_f32 v48, v48, v49
v_mfma_f32_16x16x32_bf16 v[72:75], v[208:211], a[8:11], 0
ds_read_b64_tr_b16 v[200:201], v14 offset:0
v_cvt_pk_bf16_f32 v49, v50, v51
v_cvt_pk_bf16_f32 v50, v52, v53
v_mfma_f32_16x16x32_bf16 v[120:123], v[132:135], v[140:143], v[120:123]
ds_read_b64_tr_b16 v[202:203], v14 offset:2048
v_cvt_pk_bf16_f32 v51, v54, v55
v_mfma_f32_16x16x32_bf16 v[72:75], v[212:215], a[24:27], v[72:75]
buffer_load_dwordx4 v11, s[24:27], s57 offen offset:3072 lds
v_bfi_b32 v48, s61, v18, v48
v_bfi_b32 v49, s61, v19, v49
v_mfma_f32_16x16x32_bf16 v[116:119], v[144:147], v[140:143], v[116:119]
ds_read_b64_tr_b16 v[204:205], v14 offset:4096
ds_read_b128 v[140:143], v46 offset:1728
v_mfma_f32_16x16x32_bf16 v[72:75], v[216:219], a[40:43], v[72:75]
ds_read_b64_tr_b16 v[206:207], v14 offset:6144
buffer_store_dwordx4 v[48:51], v16, s[28:31], s43 offen offset:0 sc1
v_cvt_pk_bf16_f32 v56, v56, v57
v_mfma_f32_16x16x32_bf16 v[72:75], v[220:223], a[56:59], v[72:75]
s_add_u32 m0, s6, 106496
ds_read_b128 v[152:155], v46 offset:1216
v_mfma_f32_16x16x32_bf16 v[124:127], v[132:135], v[164:167], v[124:127]
s_add_u32 s57, s83, 368640
ds_read2_b32 v[128:129], v43 offset0:48 offset1:49
v_cvt_pk_bf16_f32 v57, v58, v59
v_mfma_f32_16x16x32_bf16 v[76:79], v[208:211], a[12:15], 0
buffer_load_dwordx4 v8, s[24:27], s57 offen offset:0 lds
v_cvt_pk_bf16_f32 v58, v60, v61
v_mfma_f32_16x16x32_bf16 v[76:79], v[212:215], a[28:31], v[76:79]
ds_read2_b32 v[130:131], v43 offset0:50 offset1:51
v_cvt_pk_bf16_f32 v59, v62, v63
v_bfi_b32 v56, s61, v18, v56
v_mfma_f32_16x16x32_bf16 v[120:123], v[144:147], v[164:167], v[120:123]
v_bfi_b32 v57, s61, v19, v57
buffer_store_dwordx4 v[56:59], v16, s[28:31], s43 offen offset:1024 sc1
v_mfma_f32_16x16x32_bf16 v[76:79], v[216:219], a[44:47], v[76:79]
v_mfma_f32_16x16x32_bf16 v[76:79], v[220:223], a[60:63], v[76:79]
buffer_load_dwordx4 v9, s[24:27], s57 offen offset:1024 lds
v_mfma_f32_16x16x32_bf16 v[124:127], v[144:147], v[148:151], v[124:127]
s_waitcnt lgkmcnt(0)
v_mfma_f32_16x16x32_bf16 v[64:67], v[192:195], a[64:67], v[64:67]
ds_read2_b32 v[132:133], v43 offset0:176 offset1:177
v_mfma_f32_16x16x32_bf16 v[124:127], v[136:139], v[156:159], v[124:127]
ds_read2_b32 v[134:135], v43 offset0:178 offset1:179
v_mfma_f32_16x16x32_bf16 v[64:67], v[196:199], a[80:83], v[64:67]
buffer_load_dwordx4 v10, s[24:27], s57 offen offset:2048 lds
v_mfma_f32_16x16x32_bf16 v[64:67], v[200:203], a[96:99], v[64:67]
ds_read_b128 v[164:167], v46 offset:2240
v_mfma_f32_16x16x32_bf16 v[120:123], v[160:163], v[156:159], v[120:123]
ds_read_b128 v[144:147], v46 offset:2752
v_mfma_f32_16x16x32_bf16 v[64:67], v[204:207], a[112:115], v[64:67]
ds_read_b128 v[148:151], v46 offset:3264
v_mfma_f32_16x16x32_bf16 v[68:71], v[192:195], a[68:71], v[68:71]
buffer_load_dwordx4 v11, s[24:27], s57 offen offset:3072 lds
v_mfma_f32_16x16x32_bf16 v[124:127], v[160:163], v[168:171], v[124:127]
ds_read_b128 v[136:139], v46 offset:3776
v_mfma_f32_16x16x32_bf16 v[68:71], v[196:199], a[84:87], v[68:71]
v_mfma_f32_16x16x32_bf16 v[68:71], v[200:203], a[100:103], v[68:71]
ds_read_b64_tr_b16 v[208:209], v12 offset:0
v_mfma_f32_16x16x32_bf16 v[116:119], v[152:155], v[156:159], v[116:119]
ds_read_b64_tr_b16 v[210:211], v12 offset:2048
v_mfma_f32_16x16x32_bf16 v[68:71], v[204:207], a[116:119], v[68:71]
ds_read_b64_tr_b16 v[212:213], v12 offset:4096
v_mfma_f32_16x16x32_bf16 v[72:75], v[192:195], a[72:75], v[72:75]
ds_read_b64_tr_b16 v[214:215], v12 offset:6144
v_mfma_f32_16x16x32_bf16 v[120:123], v[152:155], v[168:171], v[120:123]
ds_read_b64_tr_b16 v[216:217], v12 offset:8192
s_xor_b32 s71, s68, 0x52000
v_mfma_f32_16x16x32_bf16 v[72:75], v[196:199], a[88:91], v[72:75]
ds_read_b64_tr_b16 v[218:219], v12 offset:10240
v_mfma_f32_16x16x32_bf16 v[124:127], v[152:155], v[128:131], v[124:127]
ds_read_b64_tr_b16 v[220:221], v12 offset:12288
buffer_load_dwordx4 v[24:27], v16, s[28:31], s71 offen sc1
v_mfma_f32_16x16x32_bf16 v[72:75], v[200:203], a[104:107], v[72:75]
ds_read_b64_tr_b16 v[222:223], v12 offset:14336
v_mfma_f32_16x16x32_bf16 v[72:75], v[204:207], a[120:123], v[72:75]
buffer_load_dwordx4 v[28:31], v16, s[28:31], s71 offen offset:1024 sc1
v_mfma_f32_16x16x32_bf16 v[112:115], v[140:143], v[156:159], v[112:115]
v_mfma_f32_16x16x32_bf16 v[76:79], v[192:195], a[76:79], v[76:79]
v_mfma_f32_16x16x32_bf16 v[76:79], v[196:199], a[92:95], v[76:79]
v_mfma_f32_16x16x32_bf16 v[116:119], v[140:143], v[168:171], v[116:119]
v_mfma_f32_16x16x32_bf16 v[76:79], v[200:203], a[108:111], v[76:79]
v_mfma_f32_16x16x32_bf16 v[76:79], v[204:207], a[124:127], v[76:79]
v_mfma_f32_16x16x32_bf16 v[120:123], v[140:143], v[128:131], v[120:123]
s_waitcnt vmcnt(16) lgkmcnt(0)
s_barrier
v_mfma_f32_16x16x32_bf16 v[64:67], v[208:211], a[128:131], v[64:67]
s_add_u32 m0, s6, 0
ds_read2_b32 v[160:161], v44 offset0:48 offset1:49
v_mfma_f32_16x16x32_bf16 v[124:127], v[140:143], v[132:135], v[124:127]
s_add_u32 s57, s83, 516096
ds_read2_b32 v[162:163], v44 offset0:50 offset1:51
v_mfma_f32_16x16x32_bf16 v[64:67], v[212:215], a[144:147], v[64:67]
buffer_load_dwordx4 v8, s[24:27], s57 offen offset:0 lds
v_mfma_f32_16x16x32_bf16 v[64:67], v[216:219], a[160:163], v[64:67]
v_mfma_f32_16x16x32_bf16 v[108:111], v[164:167], v[156:159], v[108:111]
v_mfma_f32_16x16x32_bf16 v[64:67], v[220:223], a[176:179], v[64:67]
v_mfma_f32_16x16x32_bf16 v[68:71], v[208:211], a[132:135], v[68:71]
buffer_load_dwordx4 v9, s[24:27], s57 offen offset:1024 lds
v_mfma_f32_16x16x32_bf16 v[104:107], v[144:147], v[156:159], v[104:107]
ds_read_b64_tr_b16 v[192:193], v14 offset:8192
v_mfma_f32_16x16x32_bf16 v[68:71], v[212:215], a[148:151], v[68:71]
ds_read_b64_tr_b16 v[194:195], v14 offset:10240
v_mfma_f32_16x16x32_bf16 v[68:71], v[216:219], a[164:167], v[68:71]
ds_read_b64_tr_b16 v[196:197], v14 offset:12288
v_mfma_f32_16x16x32_bf16 v[100:103], v[148:151], v[156:159], v[100:103]
buffer_load_dwordx4 v10, s[24:27], s57 offen offset:2048 lds
v_mfma_f32_16x16x32_bf16 v[68:71], v[220:223], a[180:183], v[68:71]
ds_read_b64_tr_b16 v[198:199], v14 offset:14336
v_mfma_f32_16x16x32_bf16 v[72:75], v[208:211], a[136:139], v[72:75]
ds_read_b64_tr_b16 v[200:201], v14 offset:16384
v_mfma_f32_16x16x32_bf16 v[96:99], v[136:139], v[156:159], v[96:99]
ds_read_b64_tr_b16 v[202:203], v14 offset:18432
v_mfma_f32_16x16x32_bf16 v[72:75], v[212:215], a[152:155], v[72:75]
ds_read_b64_tr_b16 v[204:205], v14 offset:20480
v_mfma_f32_16x16x32_bf16 v[112:115], v[164:167], v[168:171], v[112:115]
buffer_load_dwordx4 v11, s[24:27], s57 offen offset:3072 lds
v_mfma_f32_16x16x32_bf16 v[72:75], v[216:219], a[168:171], v[72:75]
ds_read_b64_tr_b16 v[206:207], v14 offset:22528
v_mfma_f32_16x16x32_bf16 v[72:75], v[220:223], a[184:187], v[72:75]
s_add_u32 m0, s6, 122880
v_mfma_f32_16x16x32_bf16 v[108:111], v[144:147], v[168:171], v[108:111]
s_xor_b32 s83, s60, 128
v_mfma_f32_16x16x32_bf16 v[76:79], v[208:211], a[140:143], v[76:79]
buffer_load_dwordx4 v8, s[24:27], s83 offen offset:0 lds
v_mfma_f32_16x16x32_bf16 v[76:79], v[212:215], a[156:159], v[76:79]
v_mfma_f32_16x16x32_bf16 v[104:107], v[148:151], v[168:171], v[104:107]
v_mfma_f32_16x16x32_bf16 v[76:79], v[216:219], a[172:175], v[76:79]
v_mfma_f32_16x16x32_bf16 v[76:79], v[220:223], a[188:191], v[76:79]
buffer_load_dwordx4 v9, s[24:27], s83 offen offset:1024 lds
v_mfma_f32_16x16x32_bf16 v[100:103], v[136:139], v[168:171], v[100:103]
s_waitcnt lgkmcnt(0)
v_mfma_f32_16x16x32_bf16 v[64:67], v[192:195], a[192:195], v[64:67]
ds_read2_b32 v[152:153], v44 offset0:176 offset1:177
v_mfma_f32_16x16x32_bf16 v[116:119], v[164:167], v[128:131], v[116:119]
ds_read2_b32 v[154:155], v44 offset0:178 offset1:179
v_mfma_f32_16x16x32_bf16 v[64:67], v[196:199], a[208:211], v[64:67]
buffer_load_dwordx4 v10, s[24:27], s83 offen offset:2048 lds
v_mfma_f32_16x16x32_bf16 v[64:67], v[200:203], a[224:227], v[64:67]
ds_read2_b32 v[140:141], v45 offset0:48 offset1:49
v_mfma_f32_16x16x32_bf16 v[112:115], v[144:147], v[128:131], v[112:115]
ds_read2_b32 v[142:143], v45 offset0:50 offset1:51
v_mfma_f32_16x16x32_bf16 v[64:67], v[204:207], a[240:243], v[64:67]
ds_read2_b32 v[156:157], v45 offset0:176 offset1:177
v_mfma_f32_16x16x32_bf16 v[68:71], v[192:195], a[196:199], v[68:71]
buffer_load_dwordx4 v11, s[24:27], s83 offen offset:3072 lds
v_mfma_f32_16x16x32_bf16 v[108:111], v[148:151], v[128:131], v[108:111]
ds_read2_b32 v[158:159], v45 offset0:178 offset1:179
v_mfma_f32_16x16x32_bf16 v[68:71], v[196:199], a[212:215], v[68:71]
v_mfma_f32_16x16x32_bf16 v[68:71], v[200:203], a[228:231], v[68:71]
ds_read_b64_tr_b16 v[208:209], v12 offset:16384
v_mfma_f32_16x16x32_bf16 v[104:107], v[136:139], v[128:131], v[104:107]
ds_read_b64_tr_b16 v[210:211], v12 offset:18432
v_mfma_f32_16x16x32_bf16 v[68:71], v[204:207], a[244:247], v[68:71]
ds_read_b64_tr_b16 v[212:213], v12 offset:20480
v_mfma_f32_16x16x32_bf16 v[72:75], v[192:195], a[200:203], v[72:75]
ds_read_b64_tr_b16 v[214:215], v12 offset:22528
v_mfma_f32_16x16x32_bf16 v[120:123], v[164:167], v[132:135], v[120:123]
ds_read_b64_tr_b16 v[216:217], v12 offset:24576
v_mfma_f32_16x16x32_bf16 v[72:75], v[196:199], a[216:219], v[72:75]
ds_read_b64_tr_b16 v[218:219], v12 offset:26624
v_mfma_f32_16x16x32_bf16 v[116:119], v[144:147], v[132:135], v[116:119]
ds_read_b64_tr_b16 v[220:221], v12 offset:28672
v_mfma_f32_16x16x32_bf16 v[72:75], v[200:203], a[232:235], v[72:75]
ds_read_b64_tr_b16 v[222:223], v12 offset:30720
v_mfma_f32_16x16x32_bf16 v[72:75], v[204:207], a[248:251], v[72:75]
v_mfma_f32_16x16x32_bf16 v[112:115], v[148:151], v[132:135], v[112:115]
v_mfma_f32_16x16x32_bf16 v[76:79], v[192:195], a[204:207], v[76:79]
v_mfma_f32_16x16x32_bf16 v[76:79], v[196:199], a[220:223], v[76:79]
v_mfma_f32_16x16x32_bf16 v[108:111], v[136:139], v[132:135], v[108:111]
v_mfma_f32_16x16x32_bf16 v[76:79], v[200:203], a[236:239], v[76:79]
v_mfma_f32_16x16x32_bf16 v[76:79], v[204:207], a[252:255], v[76:79]
v_mfma_f32_16x16x32_bf16 v[124:127], v[164:167], v[160:163], v[124:127]
s_waitcnt vmcnt(16) lgkmcnt(0)
s_barrier
v_mfma_f32_16x16x32_bf16 v[64:67], v[208:211], v[224:227], v[64:67]
s_mul_i32 s70, s3, 10240
s_add_u32 s70, s70, 32768
v_add_u32 v42, s70, v16
v_mfma_f32_16x16x32_bf16 v[120:123], v[144:147], v[160:163], v[120:123]
s_lshr_b32 s70, s6, 1
v_add_u32 v43, s70, v16
s_lshr_b32 s70, s3, 1
v_mfma_f32_16x16x32_bf16 v[64:67], v[212:215], v[240:243], v[64:67]
s_lshl_b32 s70, s70, 10
s_and_b32 s71, s3, 1
v_mfma_f32_16x16x32_bf16 v[68:71], v[208:211], v[228:231], v[68:71]
s_lshl_b32 s71, s71, 3
s_add_u32 s70, s70, s71
s_add_u32 s70, s70, 40960
v_mfma_f32_16x16x32_bf16 v[116:119], v[148:151], v[160:163], v[116:119]
v_add_u32 v44, s70, v16
v_mfma_f32_16x16x32_bf16 v[68:71], v[212:215], v[244:247], v[68:71]
v_mfma_f32_16x16x32_bf16 v[72:75], v[208:211], v[232:235], v[72:75]
v_mfma_f32_16x16x32_bf16 v[112:115], v[136:139], v[160:163], v[112:115]
v_mfma_f32_16x16x32_bf16 v[72:75], v[212:215], v[248:251], v[72:75]
v_mfma_f32_16x16x32_bf16 v[76:79], v[208:211], v[236:239], v[76:79]
ds_read_b64_tr_b16 v[192:193], v13 offset:24576
v_mfma_f32_16x16x32_bf16 v[124:127], v[144:147], v[152:155], v[124:127]
ds_read_b64_tr_b16 v[194:195], v13 offset:26624
v_mfma_f32_16x16x32_bf16 v[76:79], v[212:215], v[252:255], v[76:79]
ds_read_b64_tr_b16 v[196:197], v13 offset:28672
v_mfma_f32_16x16x32_bf16 v[48:51], v[216:219], a[0:3], 0
ds_read_b64_tr_b16 v[198:199], v13 offset:30720
s_waitcnt vmcnt(8)
v_mfma_f32_16x16x32_bf16 v[120:123], v[148:151], v[152:155], v[120:123]
ds_read_b64_tr_b16 v[200:201], v13 offset:32768
v_mfma_f32_16x16x32_bf16 v[48:51], v[220:223], a[16:19], v[48:51]
ds_read_b64_tr_b16 v[202:203], v13 offset:34816
v_xor_b32 v20, v24, v18
v_mfma_f32_16x16x32_bf16 v[116:119], v[136:139], v[152:155], v[116:119]
ds_read_b64_tr_b16 v[204:205], v13 offset:36864
v_bitop3_b32 v20, v25, v20, v19 bitop3:0xde
v_bitop3_b32 v20, v28, v20, v18 bitop3:0xde
v_mfma_f32_16x16x32_bf16 v[52:55], v[216:219], a[4:7], 0
ds_read_b64_tr_b16 v[206:207], v13 offset:38912
v_bitop3_b32 v20, v29, v20, v19 bitop3:0xde
v_and_b32 v20, s61, v20
v_cmp_ne_u32 vcc, 0, v20
s_cmp_lg_u64 vcc, 0
s_cbranch_scc1 Ps16
Pk15:
v_mfma_f32_16x16x32_bf16 v[52:55], v[220:223], a[20:23], v[52:55]
v_mfma_f32_16x16x32_bf16 v[124:127], v[148:151], v[140:143], v[124:127]
v_mfma_f32_16x16x32_bf16 v[80:83], v[174:177], v[24:27], v[80:83]
v_mfma_f32_16x16x32_bf16 v[56:59], v[216:219], a[8:11], 0
v_mfma_f32_16x16x32_bf16 v[84:87], v[172:175], v[24:27], v[84:87]
v_mfma_f32_16x16x32_bf16 v[56:59], v[220:223], a[24:27], v[56:59]
v_mfma_f32_16x16x32_bf16 v[88:91], v[174:177], v[28:31], v[88:91]
v_mfma_f32_16x16x32_bf16 v[92:95], v[172:175], v[28:31], v[92:95]
v_mfma_f32_16x16x32_bf16 v[120:123], v[136:139], v[140:143], v[120:123]
s_xor_b32 s43, s68, 0x52000
v_cvt_pk_bf16_f32 v64, v64, v65
v_mfma_f32_16x16x32_bf16 v[60:63], v[216:219], a[12:15], 0
v_cvt_pk_bf16_f32 v65, v66, v67
v_cvt_pk_bf16_f32 v66, v68, v69
v_mfma_f32_16x16x32_bf16 v[60:63], v[220:223], a[28:31], v[60:63]
v_cvt_pk_bf16_f32 v67, v70, v71
v_bfi_b32 v64, s61, v18, v64
v_bfi_b32 v65, s61, v47, v65
v_mfma_f32_16x16x32_bf16 v[124:127], v[136:139], v[156:159], v[124:127]
buffer_store_dwordx4 v[64:67], v16, s[28:31], s43 offen offset:0 sc1
v_cvt_pk_bf16_f32 v72, v72, v73
v_cvt_pk_bf16_f32 v73, v74, v75
s_waitcnt lgkmcnt(0)
v_mfma_f32_16x16x32_bf16 v[48:51], v[192:195], a[32:35], v[48:51]
v_cvt_pk_bf16_f32 v74, v76, v77
v_cvt_pk_bf16_f32 v75, v78, v79
v_mfma_f32_16x16x32_bf16 v[48:51], v[196:199], a[48:51], v[48:51]
ds_write_b128 v42, v[0:3] offset:8192
ds_write_b128 v42, v[4:7] offset:9216
v_bfi_b32 v72, s61, v18, v72
v_mfma_f32_16x16x32_bf16 v[48:51], v[200:203], a[64:67], v[48:51]
ds_read_b64_tr_b16 v[208:209], v13 offset:8192
ds_write_b128 v42, v[96:99] offset:0
v_mfma_f32_16x16x32_bf16 v[48:51], v[204:207], a[80:83], v[48:51]
ds_read_b64_tr_b16 v[210:211], v13 offset:10240
ds_write_b128 v42, v[100:103] offset:1024
v_bfi_b32 v73, s61, v47, v73
v_mfma_f32_16x16x32_bf16 v[52:55], v[192:195], a[36:39], v[52:55]
ds_read_b64_tr_b16 v[212:213], v13 offset:12288
ds_write_b128 v42, v[104:107] offset:2048
v_mfma_f32_16x16x32_bf16 v[52:55], v[196:199], a[52:55], v[52:55]
ds_read_b64_tr_b16 v[214:215], v13 offset:14336
ds_write_b128 v42, v[108:111] offset:3072
buffer_store_dwordx4 v[72:75], v16, s[28:31], s43 offen offset:1024 sc1
v_mfma_f32_16x16x32_bf16 v[52:55], v[200:203], a[68:71], v[52:55]
ds_read_b64_tr_b16 v[216:217], v13 offset:16384
ds_write_b128 v42, v[112:115] offset:4096
v_mfma_f32_16x16x32_bf16 v[52:55], v[204:207], a[84:87], v[52:55]
ds_read_b64_tr_b16 v[218:219], v13 offset:18432
ds_write_b128 v42, v[116:119] offset:5120
v_mfma_f32_16x16x32_bf16 v[56:59], v[192:195], a[40:43], v[56:59]
s_add_u32 m0, s6, 16384
ds_read_b64_tr_b16 v[220:221], v13 offset:20480
ds_write_b128 v42, v[120:123] offset:6144
ds_write_b128 v42, v[124:127] offset:7168
v_mfma_f32_16x16x32_bf16 v[56:59], v[196:199], a[56:59], v[56:59]
s_add_u32 s57, s83, 147456
ds_read_b64_tr_b16 v[222:223], v13 offset:22528
v_mfma_f32_16x16x32_bf16 v[56:59], v[200:203], a[72:75], v[56:59]
buffer_load_dwordx4 v8, s[24:27], s57 offen offset:0 lds
v_mfma_f32_16x16x32_bf16 v[56:59], v[204:207], a[88:91], v[56:59]
v_mfma_f32_16x16x32_bf16 v[60:63], v[192:195], a[44:47], v[60:63]
v_mfma_f32_16x16x32_bf16 v[60:63], v[196:199], a[60:63], v[60:63]
buffer_load_dwordx4 v9, s[24:27], s57 offen offset:1024 lds
v_mfma_f32_16x16x32_bf16 v[60:63], v[200:203], a[76:79], v[60:63]
v_mfma_f32_16x16x32_bf16 v[60:63], v[204:207], a[92:95], v[60:63]
buffer_load_dwordx4 v10, s[24:27], s57 offen offset:2048 lds
s_waitcnt lgkmcnt(0)
s_barrier
v_mfma_f32_16x16x32_bf16 v[48:51], v[208:211], a[96:99], v[48:51]
ds_read_b64_tr_b16 v[192:193], v13 offset:40960
ds_read_b128 v[128:131], v43 offset:32768
s_xor_b32 s71, s75, 0x80000
v_mfma_f32_16x16x32_bf16 v[48:51], v[212:215], a[112:115], v[48:51]
ds_read_b64_tr_b16 v[194:195], v13 offset:43008
ds_read_b128 v[132:135], v43 offset:43008
v_mfma_f32_16x16x32_bf16 v[48:51], v[216:219], a[128:131], v[48:51]
buffer_load_dwordx4 v11, s[24:27], s57 offen offset:3072 lds
ds_read_b128 v[136:139], v43 offset:53248
buffer_load_dwordx4 v[24:27], v16, s[28:31], s71 offen sc1
v_mfma_f32_16x16x32_bf16 v[48:51], v[220:223], a[144:147], v[48:51]
s_add_u32 m0, s6, 139264
ds_read_b64_tr_b16 v[196:197], v13 offset:45056
ds_read_b128 v[140:143], v43 offset:63488
v_mfma_f32_16x16x32_bf16 v[52:55], v[208:211], a[100:103], v[52:55]
s_add_u32 s57, s83, 294912
ds_read_b64_tr_b16 v[198:199], v13 offset:47104
ds_read_b128 v[144:147], v43 offset:33792
v_mfma_f32_16x16x32_bf16 v[52:55], v[212:215], a[116:119], v[52:55]
buffer_load_dwordx4 v8, s[24:27], s57 offen offset:0 lds
ds_read_b128 v[148:151], v43 offset:44032
buffer_load_dwordx4 v[28:31], v16, s[28:31], s71 offen offset:1024 sc1
v_mfma_f32_16x16x32_bf16 v[52:55], v[216:219], a[132:135], v[52:55]
ds_read_b64_tr_b16 v[200:201], v13 offset:49152
ds_read_b128 v[152:155], v43 offset:54272
v_mfma_f32_16x16x32_bf16 v[52:55], v[220:223], a[148:151], v[52:55]
buffer_load_dwordx4 v9, s[24:27], s57 offen offset:1024 lds
ds_read_b128 v[156:159], v43 offset:64512
v_lshlrev_b32 v96, 16, v184
v_mfma_f32_16x16x32_bf16 v[56:59], v[208:211], a[104:107], v[56:59]
ds_read_b64_tr_b16 v[202:203], v13 offset:51200
ds_read_b64 v[160:161], v44 offset:0
v_fma_f32 v112, v96, v33, v32
v_mfma_f32_16x16x32_bf16 v[56:59], v[212:215], a[120:123], v[56:59]
ds_read_b64_tr_b16 v[204:205], v13 offset:53248
ds_read_b64_tr_b16 v[206:207], v13 offset:55296
v_and_b32 v97, s64, v184
v_mfma_f32_16x16x32_bf16 v[56:59], v[216:219], a[136:139], v[56:59]
buffer_load_dwordx4 v10, s[24:27], s57 offen offset:2048 lds
ds_read_b64 v[162:163], v44 offset:10240
v_fma_f32 v113, v97, v33, v32
v_mfma_f32_16x16x32_bf16 v[56:59], v[220:223], a[152:155], v[56:59]
ds_read_b64 v[164:165], v44 offset:20480
ds_read_b64 v[166:167], v44 offset:30720
v_mfma_f32_16x16x32_bf16 v[60:63], v[208:211], a[108:111], v[60:63]
v_lshlrev_b32 v98, 16, v185
v_fma_f32 v114, v98, v33, v32
v_and_b32 v99, s64, v185
v_mfma_f32_16x16x32_bf16 v[60:63], v[212:215], a[124:127], v[60:63]
buffer_load_dwordx4 v11, s[24:27], s57 offen offset:3072 lds
s_add_u32 m0, s6, 73728
v_fma_f32 v115, v99, v33, v32
v_mfma_f32_16x16x32_bf16 v[60:63], v[216:219], a[140:143], v[60:63]
s_add_u32 s57, s83, 442368
v_lshlrev_b32 v100, 16, v186
v_fma_f32 v116, v100, v35, v34
v_mfma_f32_16x16x32_bf16 v[60:63], v[220:223], a[156:159], v[60:63]
buffer_load_dwordx4 v8, s[24:27], s57 offen offset:0 lds
v_and_b32 v101, s64, v186
v_fma_f32 v117, v101, v35, v34
v_lshlrev_b32 v102, 16, v187
s_waitcnt vmcnt(13) lgkmcnt(0)
s_barrier
v_mfma_f32_16x16x32_bf16 v[48:51], v[192:195], a[160:163], v[48:51]
ds_read_b64_tr_b16 v[208:209], v12 offset:0
v_fma_f32 v118, v102, v35, v34
v_and_b32 v103, s64, v187
v_mfma_f32_16x16x32_bf16 v[48:51], v[196:199], a[176:179], v[48:51]
ds_read_b64_tr_b16 v[210:211], v12 offset:2048
v_fma_f32 v119, v103, v35, v34
v_and_b32 v42, 0xf0, v16
v_mfma_f32_16x16x32_bf16 v[48:51], v[200:203], a[192:195], v[48:51]
buffer_load_dwordx4 v9, s[24:27], s57 offen offset:1024 lds
v_lshl_add_u32 v42, v17, 13, v42
v_add_f32 v128, v128, v132
v_add_f32 v129, v129, v133
v_mfma_f32_16x16x32_bf16 v[48:51], v[204:207], a[208:211], v[48:51]
ds_read_b64_tr_b16 v[212:213], v12 offset:4096
v_add_f32 v130, v130, v134
v_add_f32 v131, v131, v135
v_mfma_f32_16x16x32_bf16 v[52:55], v[192:195], a[164:167], v[52:55]
ds_read_b64_tr_b16 v[214:215], v12 offset:6144
v_add_f32 v136, v136, v140
v_add_f32 v137, v137, v141
v_mfma_f32_16x16x32_bf16 v[52:55], v[196:199], a[180:183], v[52:55]
buffer_load_dwordx4 v10, s[24:27], s57 offen offset:2048 lds
v_add_f32 v138, v138, v142
v_add_f32 v139, v139, v143
v_mfma_f32_16x16x32_bf16 v[52:55], v[200:203], a[196:199], v[52:55]
ds_read_b64_tr_b16 v[216:217], v12 offset:8192
v_cvt_pk_bf16_f32 v128, v128, v129
v_cvt_pk_bf16_f32 v129, v130, v131
v_mfma_f32_16x16x32_bf16 v[52:55], v[204:207], a[212:215], v[52:55]
buffer_load_dwordx4 v11, s[24:27], s57 offen offset:3072 lds
v_cvt_pk_bf16_f32 v130, v136, v137
v_cvt_pk_bf16_f32 v131, v138, v139
v_bfi_b32 v128, s61, v18, v128
v_mfma_f32_16x16x32_bf16 v[56:59], v[192:195], a[168:171], v[56:59]
s_add_u32 m0, s6, 32768
ds_read_b64_tr_b16 v[218:219], v12 offset:10240
v_bfi_b32 v129, s61, v47, v129
v_mfma_f32_16x16x32_bf16 v[56:59], v[196:199], a[184:187], v[56:59]
s_xor_b32 s57, s84, 128
ds_read_b64_tr_b16 v[220:221], v12 offset:12288
ds_read_b64_tr_b16 v[222:223], v12 offset:14336
v_mfma_f32_16x16x32_bf16 v[56:59], v[200:203], a[200:203], v[56:59]
buffer_load_dwordx4 v8, s[24:27], s57 offen offset:0 lds
buffer_store_dwordx4 v[128:131], v42, s[28:31], s77 offen sc1
s_add_u32 s71, s77, 0x40000
v_add_f32 v144, v144, v148
v_mfma_f32_16x16x32_bf16 v[56:59], v[204:207], a[216:219], v[56:59]
v_add_f32 v145, v145, v149
v_add_f32 v146, v146, v150
v_add_f32 v147, v147, v151
v_mfma_f32_16x16x32_bf16 v[60:63], v[192:195], a[172:175], v[60:63]
v_add_f32 v152, v152, v156
v_add_f32 v153, v153, v157
v_add_f32 v154, v154, v158
v_mfma_f32_16x16x32_bf16 v[60:63], v[196:199], a[188:191], v[60:63]
v_add_f32 v155, v155, v159
v_cvt_pk_bf16_f32 v144, v144, v145
v_cvt_pk_bf16_f32 v145, v146, v147
v_mfma_f32_16x16x32_bf16 v[60:63], v[200:203], a[204:207], v[60:63]
v_cvt_pk_bf16_f32 v146, v152, v153
v_cvt_pk_bf16_f32 v147, v154, v155
v_bfi_b32 v144, s61, v18, v144
v_mfma_f32_16x16x32_bf16 v[60:63], v[204:207], a[220:223], v[60:63]
v_bfi_b32 v145, s61, v47, v145
buffer_store_dwordx4 v[144:147], v42, s[28:31], s71 offen sc1
v_add_f32 v160, v160, v162
v_add_f32 v161, v161, v163
s_waitcnt lgkmcnt(0)
v_mfma_f32_16x16x32_bf16 v[48:51], v[208:211], a[224:227], v[48:51]
v_add_f32 v164, v164, v166
v_add_f32 v165, v165, v167
v_mfma_f32_16x16x32_bf16 v[48:51], v[212:215], a[240:243], v[48:51]
v_lshrrev_b32 v168, 2, v15
v_add_f32 v160, v160, v164
v_add_f32 v161, v161, v165
v_mfma_f32_16x16x32_bf16 v[48:51], v[216:219], v[224:227], v[48:51]
v_xor_b32 v168, s7, v168
v_cvt_pk_bf16_f32 v160, v160, v161
v_mfma_f32_16x16x32_bf16 v[48:51], v[220:223], v[240:243], v[48:51]
ds_read_b64_tr_b16 v[192:193], v13 offset:57344
v_bfi_b32 v168, 1, v168, v18
v_lshlrev_b32 v161, 2, v15
v_mfma_f32_16x16x32_bf16 v[52:55], v[208:211], a[228:231], v[52:55]
ds_read_b64_tr_b16 v[194:195], v13 offset:59392
v_bfi_b32 v160, s61, v168, v160
s_lshl_b32 s71, s5, 16
s_add_u32 s71, s71, s77
s_xor_b32 s71, s71, 0x6000
buffer_store_dword v160, v161, s[28:31], s71 offen sc1
v_mfma_f32_16x16x32_bf16 v[52:55], v[212:215], a[244:247], v[52:55]
ds_read_b64_tr_b16 v[196:197], v13 offset:61440
v_mfma_f32_16x16x32_bf16 v[52:55], v[216:219], v[228:231], v[52:55]
ds_read_b64_tr_b16 v[198:199], v13 offset:63488
v_mfma_f32_16x16x32_bf16 v[52:55], v[220:223], v[244:247], v[52:55]
s_branch SK9
.p2align 12
PAD9:
s_branch L_back
SK9:
ds_read_b64_tr_b16 v[200:201], v14 offset:0
v_lshlrev_b32 v104, 16, v188
v_fma_f32 v120, v104, v37, v36
v_mfma_f32_16x16x32_bf16 v[56:59], v[208:211], a[232:235], v[56:59]
ds_read_b64_tr_b16 v[202:203], v14 offset:2048
v_and_b32 v105, s64, v188
v_fma_f32 v121, v105, v37, v36
v_mfma_f32_16x16x32_bf16 v[56:59], v[212:215], a[248:251], v[56:59]
ds_read_b64_tr_b16 v[204:205], v14 offset:4096
v_lshlrev_b32 v106, 16, v189
v_fma_f32 v122, v106, v37, v36
v_mfma_f32_16x16x32_bf16 v[56:59], v[216:219], v[232:235], v[56:59]
ds_read_b64_tr_b16 v[206:207], v14 offset:6144
v_and_b32 v107, s64, v189
v_fma_f32 v123, v107, v37, v36
v_mfma_f32_16x16x32_bf16 v[56:59], v[220:223], v[248:251], v[56:59]
buffer_load_dwordx4 v9, s[24:27], s57 offen offset:1024 lds
v_lshlrev_b32 v108, 16, v190
v_fma_f32 v124, v108, v39, v38
v_mfma_f32_16x16x32_bf16 v[60:63], v[208:211], a[236:239], v[60:63]
v_and_b32 v109, s64, v190
v_fma_f32 v125, v109, v39, v38
v_lshlrev_b32 v110, 16, v191
v_fma_f32 v126, v110, v39, v38
v_mfma_f32_16x16x32_bf16 v[60:63], v[212:215], a[252:255], v[60:63]
buffer_load_dwordx4 v10, s[24:27], s57 offen offset:2048 lds
v_and_b32 v111, s64, v191
v_fma_f32 v127, v111, v39, v38
v_and_b32 v20, 31, v15
v_mfma_f32_16x16x32_bf16 v[60:63], v[216:219], v[236:239], v[60:63]
v_mul_u32_u24 v20, 1152, v20
v_and_b32 v182, 16, v17
v_lshrrev_b32 v171, 2, v182
v_add_u32 v182, v20, v182
v_add_u32 v171, v20, v171
v_and_b32 v20, 0xf0, v16
v_mfma_f32_16x16x32_bf16 v[60:63], v[220:223], v[252:255], v[60:63]
s_mov_b32 s70, 133120
v_mad_u32_u24 v169, v17, s70, v20
v_lshrrev_b32 v20, 2, v20
v_lshl_add_u32 v170, v17, 18, v20
v_and_b32 v20, 8, v17
v_lshl_add_u32 v170, v20, 12, v170
s_waitcnt vmcnt(10) lgkmcnt(0)
s_barrier
v_mfma_f32_16x16x32_bf16 v[64:67], v[192:195], a[0:3], 0
buffer_load_dwordx4 v11, s[24:27], s57 offen offset:3072 lds
v_mfma_f32_16x16x32_bf16 v[64:67], v[196:199], a[16:19], v[64:67]
s_add_u32 m0, s6, 49152
ds_read_b64_tr_b16 v[208:209], v12 offset:16384
v_mfma_f32_16x16x32_bf16 v[64:67], v[200:203], a[32:35], v[64:67]
s_add_u32 s57, s60, 73728
ds_read_b64_tr_b16 v[210:211], v12 offset:18432
v_xor_b32 v20, v24, v18
v_bitop3_b32 v20, v25, v20, v19 bitop3:0xde
v_bitop3_b32 v20, v28, v20, v18 bitop3:0xde
v_bitop3_b32 v20, v29, v20, v19 bitop3:0xde
v_and_b32 v20, s61, v20
v_cmp_ne_u32 vcc, 0, v20
s_cmp_lg_u64 vcc, 0
s_cbranch_scc1 Ps19
Pk18:
v_xor_b32 v19, 0x10000, v19
v_mfma_f32_16x16x32_bf16 v[64:67], v[204:207], a[48:51], v[64:67]
buffer_load_dwordx4 v8, s[24:27], s57 offen offset:0 lds
v_mfma_f32_16x16x32_bf16 v[68:71], v[192:195], a[4:7], 0
ds_read_b64_tr_b16 v[212:213], v12 offset:20480
v_mfma_f32_16x16x32_bf16 v[68:71], v[196:199], a[20:23], v[68:71]
buffer_load_dwordx4 v9, s[24:27], s57 offen offset:1024 lds
v_mfma_f32_16x16x32_bf16 v[80:83], v[174:177], v[24:27], v[80:83]
v_mfma_f32_16x16x32_bf16 v[84:87], v[172:175], v[24:27], v[84:87]
v_mfma_f32_16x16x32_bf16 v[88:91], v[174:177], v[28:31], v[88:91]
v_mfma_f32_16x16x32_bf16 v[92:95], v[172:175], v[28:31], v[92:95]
v_mfma_f32_16x16x32_bf16 v[68:71], v[200:203], a[36:39], v[68:71]
ds_read_b64_tr_b16 v[214:215], v12 offset:22528
v_mfma_f32_16x16x32_bf16 v[68:71], v[204:207], a[52:55], v[68:71]
ds_read_b64_tr_b16 v[216:217], v12 offset:24576
v_mfma_f32_16x16x32_bf16 v[72:75], v[192:195], a[8:11], 0
buffer_load_dwordx4 v10, s[24:27], s57 offen offset:2048 lds
s_xor_b32 s43, s75, 0x80000
v_cvt_pk_bf16_f32 v48, v48, v49
v_mfma_f32_16x16x32_bf16 v[72:75], v[196:199], a[24:27], v[72:75]
ds_read_b64_tr_b16 v[218:219], v12 offset:26624
v_cvt_pk_bf16_f32 v49, v50, v51
v_mfma_f32_16x16x32_bf16 v[72:75], v[200:203], a[40:43], v[72:75]
ds_read_b64_tr_b16 v[220:221], v12 offset:28672
ds_read_b64_tr_b16 v[222:223], v12 offset:30720
v_cvt_pk_bf16_f32 v50, v52, v53
v_mfma_f32_16x16x32_bf16 v[72:75], v[204:207], a[56:59], v[72:75]
buffer_load_dwordx4 v11, s[24:27], s57 offen offset:3072 lds
s_add_u32 m0, s6, 0
v_cvt_pk_bf16_f32 v51, v54, v55
v_mfma_f32_16x16x32_bf16 v[76:79], v[192:195], a[12:15], 0
s_add_u32 s57, s60, 221184
v_bfi_b32 v48, s61, v18, v48
v_mfma_f32_16x16x32_bf16 v[76:79], v[196:199], a[28:31], v[76:79]
buffer_load_dwordx4 v8, s[24:27], s57 offen offset:0 lds
v_bfi_b32 v49, s61, v47, v49
v_mfma_f32_16x16x32_bf16 v[76:79], v[200:203], a[44:47], v[76:79]
buffer_store_dwordx4 v[48:51], v16, s[28:31], s43 offen offset:0 sc1
v_cvt_pk_bf16_f32 v56, v56, v57
v_cvt_pk_bf16_f32 v57, v58, v59
v_cvt_pk_bf16_f32 v58, v60, v61
v_mfma_f32_16x16x32_bf16 v[76:79], v[204:207], a[60:63], v[76:79]
v_cvt_pk_bf16_f32 v59, v62, v63
v_bfi_b32 v56, s61, v18, v56
s_waitcnt lgkmcnt(0)
v_mfma_f32_16x16x32_bf16 v[64:67], v[208:211], a[64:67], v[64:67]
buffer_load_dwordx4 v9, s[24:27], s57 offen offset:1024 lds
v_bfi_b32 v57, s61, v47, v57
buffer_store_dwordx4 v[56:59], v16, s[28:31], s43 offen offset:1024 sc1
v_mfma_f32_16x16x32_bf16 v[64:67], v[212:215], a[80:83], v[64:67]
ds_read_b64_tr_b16 v[192:193], v14 offset:8192
v_mfma_f32_16x16x32_bf16 v[64:67], v[216:219], a[96:99], v[64:67]
ds_read_b64_tr_b16 v[194:195], v14 offset:10240
v_mfma_f32_16x16x32_bf16 v[64:67], v[220:223], a[112:115], v[64:67]
buffer_load_dwordx4 v10, s[24:27], s57 offen offset:2048 lds
v_mfma_f32_16x16x32_bf16 v[68:71], v[208:211], a[68:71], v[68:71]
ds_read_b64_tr_b16 v[196:197], v14 offset:12288
v_mfma_f32_16x16x32_bf16 v[68:71], v[212:215], a[84:87], v[68:71]
buffer_load_dwordx4 v11, s[24:27], s57 offen offset:3072 lds
v_mfma_f32_16x16x32_bf16 v[68:71], v[216:219], a[100:103], v[68:71]
s_add_u32 m0, s6, 90112
ds_read_b64_tr_b16 v[198:199], v14 offset:14336
v_mfma_f32_16x16x32_bf16 v[68:71], v[220:223], a[116:119], v[68:71]
s_add_u32 s57, s60, 368640
ds_read_b64_tr_b16 v[200:201], v14 offset:16384
v_mfma_f32_16x16x32_bf16 v[72:75], v[208:211], a[72:75], v[72:75]
buffer_load_dwordx4 v8, s[24:27], s57 offen offset:0 lds
s_xor_b32 s71, s68, 0x62000
v_mfma_f32_16x16x32_bf16 v[72:75], v[212:215], a[88:91], v[72:75]
ds_read_b64_tr_b16 v[202:203], v14 offset:18432
v_mfma_f32_16x16x32_bf16 v[72:75], v[216:219], a[104:107], v[72:75]
ds_read_b64_tr_b16 v[204:205], v14 offset:20480
ds_read_b64_tr_b16 v[206:207], v14 offset:22528
buffer_load_dwordx4 v[24:27], v16, s[28:31], s71 offen sc1
v_mfma_f32_16x16x32_bf16 v[72:75], v[220:223], a[120:123], v[72:75]
buffer_load_dwordx4 v9, s[24:27], s57 offen offset:1024 lds
v_mfma_f32_16x16x32_bf16 v[76:79], v[208:211], a[76:79], v[76:79]
buffer_load_dwordx4 v[28:31], v16, s[28:31], s71 offen offset:1024 sc1
v_mfma_f32_16x16x32_bf16 v[76:79], v[212:215], a[92:95], v[76:79]
buffer_load_dwordx4 v10, s[24:27], s57 offen offset:2048 lds
v_mfma_f32_16x16x32_bf16 v[76:79], v[216:219], a[108:111], v[76:79]
v_mfma_f32_16x16x32_bf16 v[76:79], v[220:223], a[124:127], v[76:79]
s_waitcnt vmcnt(15) lgkmcnt(0)
s_barrier
v_mfma_f32_16x16x32_bf16 v[64:67], v[192:195], a[128:131], v[64:67]
buffer_load_dwordx4 v11, s[24:27], s57 offen offset:3072 lds
v_mfma_f32_16x16x32_bf16 v[64:67], v[196:199], a[144:147], v[64:67]
s_add_u32 m0, s6, 16384
ds_read_b64_tr_b16 v[208:209], v13 offset:8192
v_mfma_f32_16x16x32_bf16 v[64:67], v[200:203], a[160:163], v[64:67]
s_add_u32 s57, s60, 516096
ds_read_b64_tr_b16 v[210:211], v13 offset:10240
v_mfma_f32_16x16x32_bf16 v[64:67], v[204:207], a[176:179], v[64:67]
buffer_load_dwordx4 v8, s[24:27], s57 offen offset:0 lds
v_mfma_f32_16x16x32_bf16 v[68:71], v[192:195], a[132:135], v[68:71]
ds_read_b64_tr_b16 v[212:213], v13 offset:12288
v_mfma_f32_16x16x32_bf16 v[68:71], v[196:199], a[148:151], v[68:71]
buffer_load_dwordx4 v9, s[24:27], s57 offen offset:1024 lds
v_mfma_f32_16x16x32_bf16 v[68:71], v[200:203], a[164:167], v[68:71]
ds_read_b64_tr_b16 v[214:215], v13 offset:14336
v_mfma_f32_16x16x32_bf16 v[68:71], v[204:207], a[180:183], v[68:71]
ds_read_b64_tr_b16 v[216:217], v13 offset:16384
v_mfma_f32_16x16x32_bf16 v[72:75], v[192:195], a[136:139], v[72:75]
buffer_load_dwordx4 v10, s[24:27], s57 offen offset:2048 lds
v_mfma_f32_16x16x32_bf16 v[72:75], v[196:199], a[152:155], v[72:75]
ds_read_b64_tr_b16 v[218:219], v13 offset:18432
v_mfma_f32_16x16x32_bf16 v[72:75], v[200:203], a[168:171], v[72:75]
ds_read_b64_tr_b16 v[220:221], v13 offset:20480
ds_read_b64_tr_b16 v[222:223], v13 offset:22528
v_mfma_f32_16x16x32_bf16 v[72:75], v[204:207], a[184:187], v[72:75]
buffer_load_dwordx4 v11, s[24:27], s57 offen offset:3072 lds
v_mfma_f32_16x16x32_bf16 v[76:79], v[192:195], a[140:143], v[76:79]
v_mfma_f32_16x16x32_bf16 v[76:79], v[196:199], a[156:159], v[76:79]
v_mfma_f32_16x16x32_bf16 v[76:79], v[200:203], a[172:175], v[76:79]
v_mfma_f32_16x16x32_bf16 v[76:79], v[204:207], a[188:191], v[76:79]
s_waitcnt lgkmcnt(0)
v_mfma_f32_16x16x32_bf16 v[64:67], v[208:211], a[192:195], v[64:67]
v_mfma_f32_16x16x32_bf16 v[64:67], v[212:215], a[208:211], v[64:67]
v_mfma_f32_16x16x32_bf16 v[64:67], v[216:219], a[224:227], v[64:67]
v_mfma_f32_16x16x32_bf16 v[64:67], v[220:223], a[240:243], v[64:67]
ds_read_b64_tr_b16 v[192:193], v12 offset:32768
v_mfma_f32_16x16x32_bf16 v[68:71], v[208:211], a[196:199], v[68:71]
ds_read_b64_tr_b16 v[194:195], v12 offset:34816
v_mfma_f32_16x16x32_bf16 v[68:71], v[212:215], a[212:215], v[68:71]
ds_read_b64_tr_b16 v[196:197], v12 offset:36864
v_mfma_f32_16x16x32_bf16 v[68:71], v[216:219], a[228:231], v[68:71]
ds_read_b64_tr_b16 v[198:199], v12 offset:38912
v_mfma_f32_16x16x32_bf16 v[68:71], v[220:223], a[244:247], v[68:71]
ds_read_b64_tr_b16 v[200:201], v12 offset:40960
v_mfma_f32_16x16x32_bf16 v[72:75], v[208:211], a[200:203], v[72:75]
ds_read_b64_tr_b16 v[202:203], v12 offset:43008
v_mfma_f32_16x16x32_bf16 v[72:75], v[212:215], a[216:219], v[72:75]
ds_read_b64_tr_b16 v[204:205], v12 offset:45056
v_mfma_f32_16x16x32_bf16 v[72:75], v[216:219], a[232:235], v[72:75]
ds_read_b64_tr_b16 v[206:207], v12 offset:47104
buffer_load_dwordx4 v[128:131], v169, s[28:31], s78 offen sc1
s_add_u32 s71, s78, 0x82000
v_mfma_f32_16x16x32_bf16 v[72:75], v[220:223], a[248:251], v[72:75]
buffer_load_dwordx4 v[132:135], v169, s[28:31], s71 offen sc1
v_mfma_f32_16x16x32_bf16 v[76:79], v[208:211], a[204:207], v[76:79]
buffer_load_dword v136, v170, s[28:31], s69 offen sc1
v_mfma_f32_16x16x32_bf16 v[76:79], v[212:215], a[220:223], v[76:79]
v_mfma_f32_16x16x32_bf16 v[76:79], v[216:219], a[236:239], v[76:79]
v_mfma_f32_16x16x32_bf16 v[76:79], v[220:223], a[252:255], v[76:79]
s_waitcnt vmcnt(13) lgkmcnt(0)
s_barrier
v_mfma_f32_16x16x32_bf16 v[64:67], v[192:195], v[224:227], v[64:67]
v_mfma_f32_16x16x32_bf16 v[64:67], v[196:199], v[240:243], v[64:67]
v_mfma_f32_16x16x32_bf16 v[68:71], v[192:195], v[228:231], v[68:71]
v_mfma_f32_16x16x32_bf16 v[68:71], v[196:199], v[244:247], v[68:71]
ds_read_b64_tr_b16 v[208:209], v12 offset:49152
v_mfma_f32_16x16x32_bf16 v[72:75], v[192:195], v[232:235], v[72:75]
ds_read_b64_tr_b16 v[210:211], v12 offset:51200
v_mfma_f32_16x16x32_bf16 v[72:75], v[196:199], v[248:251], v[72:75]
ds_read_b64_tr_b16 v[212:213], v12 offset:53248
v_mfma_f32_16x16x32_bf16 v[76:79], v[192:195], v[236:239], v[76:79]
ds_read_b64_tr_b16 v[214:215], v12 offset:55296
v_mfma_f32_16x16x32_bf16 v[76:79], v[196:199], v[252:255], v[76:79]
ds_read_b64_tr_b16 v[216:217], v12 offset:57344
s_waitcnt vmcnt(9)
v_xor_b32 v20, v24, v18
v_bitop3_b32 v20, v25, v20, v47 bitop3:0xde
v_bitop3_b32 v20, v28, v20, v18 bitop3:0xde
v_bitop3_b32 v20, v29, v20, v47 bitop3:0xde
v_and_b32 v20, s61, v20
v_cmp_ne_u32 vcc, 0, v20
s_cmp_lg_u64 vcc, 0
s_cbranch_scc1 Ps22
Pk21:
v_mfma_f32_16x16x32_bf16 v[80:83], v[200:203], a[0:3], v[80:83]
ds_read_b64_tr_b16 v[218:219], v12 offset:59392
v_mfma_f32_16x16x32_bf16 v[80:83], v[174:177], v[24:27], v[80:83]
v_mfma_f32_16x16x32_bf16 v[80:83], v[204:207], a[16:19], v[80:83]
ds_read_b64_tr_b16 v[220:221], v12 offset:61440
v_mfma_f32_16x16x32_bf16 v[84:87], v[172:175], v[24:27], v[84:87]
v_mfma_f32_16x16x32_bf16 v[84:87], v[200:203], a[4:7], v[84:87]
ds_read_b64_tr_b16 v[222:223], v12 offset:63488
v_mfma_f32_16x16x32_bf16 v[88:91], v[174:177], v[28:31], v[88:91]
v_mfma_f32_16x16x32_bf16 v[84:87], v[204:207], a[20:23], v[84:87]
v_mfma_f32_16x16x32_bf16 v[92:95], v[172:175], v[28:31], v[92:95]
v_mfma_f32_16x16x32_bf16 v[88:91], v[200:203], a[8:11], v[88:91]
s_xor_b32 s43, s68, 0x62000
v_cvt_pk_bf16_f32 v64, v64, v65
v_mfma_f32_16x16x32_bf16 v[88:91], v[204:207], a[24:27], v[88:91]
v_cvt_pk_bf16_f32 v65, v66, v67
v_cvt_pk_bf16_f32 v66, v68, v69
v_cvt_pk_bf16_f32 v67, v70, v71
v_mfma_f32_16x16x32_bf16 v[92:95], v[200:203], a[12:15], v[92:95]
v_bfi_b32 v64, s61, v18, v64
v_bfi_b32 v65, s61, v19, v65
buffer_store_dwordx4 v[64:67], v16, s[28:31], s43 offen offset:0 sc1
v_mfma_f32_16x16x32_bf16 v[92:95], v[204:207], a[28:31], v[92:95]
v_cvt_pk_bf16_f32 v72, v72, v73
v_cvt_pk_bf16_f32 v73, v74, v75
s_waitcnt lgkmcnt(0)
v_mfma_f32_16x16x32_bf16 v[80:83], v[208:211], a[32:35], v[80:83]
v_cvt_pk_bf16_f32 v74, v76, v77
v_cvt_pk_bf16_f32 v75, v78, v79
v_mfma_f32_16x16x32_bf16 v[80:83], v[212:215], a[48:51], v[80:83]
v_bfi_b32 v72, s61, v18, v72
v_bfi_b32 v73, s61, v19, v73
buffer_store_dwordx4 v[72:75], v16, s[28:31], s43 offen offset:1024 sc1
v_mfma_f32_16x16x32_bf16 v[80:83], v[216:219], a[64:67], v[80:83]
s_xor_b32 s71, s75, 0x0
buffer_load_dwordx4 v[144:147], v16, s[28:31], s71 offen sc1
v_mfma_f32_16x16x32_bf16 v[80:83], v[220:223], a[80:83], v[80:83]
ds_read_b64_tr_b16 v[192:193], v12 offset:0
v_mfma_f32_16x16x32_bf16 v[84:87], v[208:211], a[36:39], v[84:87]
ds_read_b64_tr_b16 v[194:195], v12 offset:2048
buffer_load_dwordx4 v[148:151], v16, s[28:31], s71 offen offset:1024 sc1
v_mfma_f32_16x16x32_bf16 v[84:87], v[212:215], a[52:55], v[84:87]
ds_read_b64_tr_b16 v[196:197], v12 offset:4096
v_mfma_f32_16x16x32_bf16 v[84:87], v[216:219], a[68:71], v[84:87]
ds_read_b64_tr_b16 v[198:199], v12 offset:6144
v_mfma_f32_16x16x32_bf16 v[84:87], v[220:223], a[84:87], v[84:87]
ds_read_b64_tr_b16 v[200:201], v12 offset:8192
v_mfma_f32_16x16x32_bf16 v[88:91], v[208:211], a[40:43], v[88:91]
ds_read_b64_tr_b16 v[202:203], v12 offset:10240
v_mfma_f32_16x16x32_bf16 v[88:91], v[212:215], a[56:59], v[88:91]
ds_read_b64_tr_b16 v[204:205], v12 offset:12288
v_mfma_f32_16x16x32_bf16 v[88:91], v[216:219], a[72:75], v[88:91]
ds_read_b64_tr_b16 v[206:207], v12 offset:14336
v_mfma_f32_16x16x32_bf16 v[88:91], v[220:223], a[88:91], v[88:91]
v_mfma_f32_16x16x32_bf16 v[92:95], v[208:211], a[44:47], v[92:95]
v_mfma_f32_16x16x32_bf16 v[92:95], v[212:215], a[60:63], v[92:95]
v_mfma_f32_16x16x32_bf16 v[92:95], v[216:219], a[76:79], v[92:95]
v_mfma_f32_16x16x32_bf16 v[92:95], v[220:223], a[92:95], v[92:95]
s_waitcnt vmcnt(7) lgkmcnt(0)
s_barrier
v_mfma_f32_16x16x32_bf16 v[80:83], v[192:195], a[96:99], v[80:83]
v_mfma_f32_16x16x32_bf16 v[80:83], v[196:199], a[112:115], v[80:83]
v_mfma_f32_16x16x32_bf16 v[80:83], v[200:203], a[128:131], v[80:83]
v_mfma_f32_16x16x32_bf16 v[80:83], v[204:207], a[144:147], v[80:83]
ds_read_b64_tr_b16 v[208:209], v13 offset:24576
v_mfma_f32_16x16x32_bf16 v[84:87], v[192:195], a[100:103], v[84:87]
ds_read_b64_tr_b16 v[210:211], v13 offset:26624
v_mfma_f32_16x16x32_bf16 v[84:87], v[196:199], a[116:119], v[84:87]
ds_read_b64_tr_b16 v[212:213], v13 offset:28672
v_mfma_f32_16x16x32_bf16 v[84:87], v[200:203], a[132:135], v[84:87]
ds_read_b64_tr_b16 v[214:215], v13 offset:30720
v_mfma_f32_16x16x32_bf16 v[84:87], v[204:207], a[148:151], v[84:87]
ds_read_b64_tr_b16 v[216:217], v13 offset:32768
v_mfma_f32_16x16x32_bf16 v[88:91], v[192:195], a[104:107], v[88:91]
ds_read_b64_tr_b16 v[218:219], v13 offset:34816
v_mfma_f32_16x16x32_bf16 v[88:91], v[196:199], a[120:123], v[88:91]
ds_read_b64_tr_b16 v[220:221], v13 offset:36864
s_waitcnt vmcnt(4)
v_mfma_f32_16x16x32_bf16 v[88:91], v[200:203], a[136:139], v[88:91]
ds_read_b64_tr_b16 v[222:223], v13 offset:38912
v_mfma_f32_16x16x32_bf16 v[88:91], v[204:207], a[152:155], v[88:91]
v_xor_b32 v20, v128, v18
v_bitop3_b32 v20, v129, v20, v47 bitop3:0xde
v_mfma_f32_16x16x32_bf16 v[92:95], v[192:195], a[108:111], v[92:95]
v_bitop3_b32 v20, v132, v20, v18 bitop3:0xde
v_bitop3_b32 v20, v133, v20, v47 bitop3:0xde
v_bitop3_b32 v20, v136, v20, v168 bitop3:0xde
v_mfma_f32_16x16x32_bf16 v[92:95], v[196:199], a[124:127], v[92:95]
v_and_b32 v20, s61, v20
v_cmp_ne_u32 vcc, 0, v20
s_cmp_lg_u64 vcc, 0
s_cbranch_scc1 Ps25
Pk24:
v_mfma_f32_16x16x32_bf16 v[92:95], v[200:203], a[140:143], v[92:95]
s_xor_b32 s71, s68, 0x72000
v_mfma_f32_16x16x32_bf16 v[92:95], v[204:207], a[156:159], v[92:95]
buffer_load_dwordx4 v[152:155], v16, s[28:31], s71 offen sc1
s_waitcnt lgkmcnt(0)
v_mfma_f32_16x16x32_bf16 v[80:83], v[208:211], a[160:163], v[80:83]
buffer_load_dwordx4 v[156:159], v16, s[28:31], s71 offen offset:1024 sc1
v_and_b32 v137, s64, v136
v_lshlrev_b32 v136, 16, v136
v_mfma_f32_16x16x32_bf16 v[80:83], v[212:215], a[176:179], v[80:83]
v_lshlrev_b32 v20, 16, v181
v_and_b32 v21, s64, v181
v_permlane16_swap_b32 v136, v137
v_mfma_f32_16x16x32_bf16 v[80:83], v[216:219], a[192:195], v[80:83]
s_nop 0
v_fmac_f32 v40, v20, v136
v_mfma_f32_16x16x32_bf16 v[80:83], v[220:223], a[208:211], v[80:83]
ds_read_b64_tr_b16 v[192:193], v12 offset:16384
v_fmac_f32 v41, v21, v137
v_cvt_pk_bf16_f32 v40, v40, v41
v_mfma_f32_16x16x32_bf16 v[84:87], v[208:211], a[164:167], v[84:87]
ds_read_b64_tr_b16 v[194:195], v12 offset:18432
v_mfma_f32_16x16x32_bf16 v[84:87], v[212:215], a[180:183], v[84:87]
ds_read_b64_tr_b16 v[196:197], v12 offset:20480
buffer_store_dword v40, v171, s[32:35], s79 offen
v_lshlrev_b32 v20, 16, v128
v_mfma_f32_16x16x32_bf16 v[84:87], v[216:219], a[196:199], v[84:87]
ds_read_b64_tr_b16 v[198:199], v12 offset:22528
v_and_b32 v21, s64, v128
v_lshlrev_b32 v22, 16, v129
v_mfma_f32_16x16x32_bf16 v[84:87], v[220:223], a[212:215], v[84:87]
ds_read_b64_tr_b16 v[200:201], v12 offset:24576
v_and_b32 v23, s64, v129
v_mfma_f32_16x16x32_bf16 v[88:91], v[208:211], a[168:171], v[88:91]
ds_read_b64_tr_b16 v[202:203], v12 offset:26624
v_fmac_f32 v112, v96, v20
v_fmac_f32 v116, v100, v21
v_mfma_f32_16x16x32_bf16 v[88:91], v[212:215], a[184:187], v[88:91]
ds_read_b64_tr_b16 v[204:205], v12 offset:28672
v_fmac_f32 v120, v104, v22
v_mfma_f32_16x16x32_bf16 v[88:91], v[216:219], a[200:203], v[88:91]
ds_read_b64_tr_b16 v[206:207], v12 offset:30720
v_fmac_f32 v124, v108, v23
v_lshlrev_b32 v20, 16, v130
v_mfma_f32_16x16x32_bf16 v[88:91], v[220:223], a[216:219], v[88:91]
v_and_b32 v21, s64, v130
v_lshlrev_b32 v22, 16, v131
v_mfma_f32_16x16x32_bf16 v[92:95], v[208:211], a[172:175], v[92:95]
v_and_b32 v23, s64, v131
v_fmac_f32 v113, v97, v20
v_fmac_f32 v117, v101, v21
v_mfma_f32_16x16x32_bf16 v[92:95], v[212:215], a[188:191], v[92:95]
v_fmac_f32 v121, v105, v22
v_fmac_f32 v125, v109, v23
v_mfma_f32_16x16x32_bf16 v[92:95], v[216:219], a[204:207], v[92:95]
v_lshlrev_b32 v20, 16, v132
v_and_b32 v21, s64, v132
v_lshlrev_b32 v22, 16, v133
v_mfma_f32_16x16x32_bf16 v[92:95], v[220:223], a[220:223], v[92:95]
v_and_b32 v23, s64, v133
v_fmac_f32 v114, v98, v20
s_waitcnt lgkmcnt(0)
v_mfma_f32_16x16x32_bf16 v[80:83], v[192:195], a[224:227], v[80:83]
v_fmac_f32 v118, v102, v21
v_fmac_f32 v122, v106, v22
v_fmac_f32 v126, v110, v23
v_mfma_f32_16x16x32_bf16 v[80:83], v[196:199], a[240:243], v[80:83]
v_lshlrev_b32 v20, 16, v134
v_and_b32 v21, s64, v134
v_mfma_f32_16x16x32_bf16 v[80:83], v[200:203], v[224:227], v[80:83]
v_lshlrev_b32 v22, 16, v135
v_and_b32 v23, s64, v135
v_fmac_f32 v115, v99, v20
v_mfma_f32_16x16x32_bf16 v[80:83], v[204:207], v[240:243], v[80:83]
v_fmac_f32 v119, v103, v21
v_fmac_f32 v123, v107, v22
v_mfma_f32_16x16x32_bf16 v[84:87], v[192:195], a[228:231], v[84:87]
v_fmac_f32 v127, v111, v23
v_mfma_f32_16x16x32_bf16 v[84:87], v[196:199], a[244:247], v[84:87]
s_waitcnt vmcnt(3)
v_mfma_f32_16x16x32_bf16 v[84:87], v[200:203], v[228:231], v[84:87]
v_xor_b32 v20, v144, v18
v_bitop3_b32 v20, v145, v20, v47 bitop3:0xde
v_mfma_f32_16x16x32_bf16 v[84:87], v[204:207], v[244:247], v[84:87]
v_bitop3_b32 v20, v148, v20, v18 bitop3:0xde
v_bitop3_b32 v20, v149, v20, v47 bitop3:0xde
v_mfma_f32_16x16x32_bf16 v[88:91], v[192:195], a[232:235], v[88:91]
v_and_b32 v20, s61, v20
v_cmp_ne_u32 vcc, 0, v20
s_cmp_lg_u64 vcc, 0
s_cbranch_scc1 Ps28
Pk27:
v_mfma_f32_16x16x32_bf16 v[88:91], v[196:199], a[248:251], v[88:91]
v_mfma_f32_16x16x32_bf16 v[80:83], v[174:177], v[144:147], v[80:83]
v_mfma_f32_16x16x32_bf16 v[88:91], v[200:203], v[232:235], v[88:91]
v_mfma_f32_16x16x32_bf16 v[84:87], v[172:175], v[144:147], v[84:87]
v_mfma_f32_16x16x32_bf16 v[88:91], v[204:207], v[248:251], v[88:91]
v_mfma_f32_16x16x32_bf16 v[88:91], v[174:177], v[148:151], v[88:91]
v_mfma_f32_16x16x32_bf16 v[92:95], v[192:195], a[236:239], v[92:95]
v_mfma_f32_16x16x32_bf16 v[92:95], v[172:175], v[148:151], v[92:95]
v_mfma_f32_16x16x32_bf16 v[92:95], v[196:199], a[252:255], v[92:95]
v_mfma_f32_16x16x32_bf16 v[92:95], v[200:203], v[236:239], v[92:95]
v_mfma_f32_16x16x32_bf16 v[92:95], v[204:207], v[252:255], v[92:95]
s_waitcnt vmcnt(1)
v_xor_b32 v20, v152, v18
v_bitop3_b32 v20, v153, v20, v19 bitop3:0xde
v_bitop3_b32 v20, v156, v20, v18 bitop3:0xde
v_bitop3_b32 v20, v157, v20, v19 bitop3:0xde
v_and_b32 v20, s61, v20
v_cmp_ne_u32 vcc, 0, v20
s_cmp_lg_u64 vcc, 0
s_cbranch_scc1 Ps31
Pk30:
v_mfma_f32_16x16x32_bf16 v[80:83], v[174:177], v[152:155], v[80:83]
v_mfma_f32_16x16x32_bf16 v[84:87], v[172:175], v[152:155], v[84:87]
v_mfma_f32_16x16x32_bf16 v[88:91], v[174:177], v[156:159], v[88:91]
v_mfma_f32_16x16x32_bf16 v[92:95], v[172:175], v[156:159], v[92:95]
s_add_u32 s71, s76, 36864
s_nop 3
v_fma_f32 v80, v80, s65, v112
v_fma_f32 v81, v81, s65, v113
v_fma_f32 v82, v82, s65, v114
v_fma_f32 v83, v83, s65, v115
v_fma_f32 v84, v84, s65, v116
v_fma_f32 v85, v85, s65, v117
v_fma_f32 v86, v86, s65, v118
v_fma_f32 v87, v87, s65, v119
v_cvt_pk_bf16_f32 v80, v80, v81
v_cvt_pk_bf16_f32 v81, v82, v83
v_cvt_pk_bf16_f32 v82, v84, v85
v_cvt_pk_bf16_f32 v83, v86, v87
s_nop 0
v_permlane16_swap_b32 v80, v82
v_permlane16_swap_b32 v81, v83
buffer_store_dwordx4 v[80:83], v182, s[32:35], s76 offen
v_fma_f32 v88, v88, s65, v120
v_fma_f32 v89, v89, s65, v121
v_fma_f32 v90, v90, s65, v122
v_fma_f32 v91, v91, s65, v123
v_fma_f32 v92, v92, s65, v124
v_fma_f32 v93, v93, s65, v125
v_fma_f32 v94, v94, s65, v126
v_fma_f32 v95, v95, s65, v127
v_cvt_pk_bf16_f32 v88, v88, v89
v_cvt_pk_bf16_f32 v89, v90, v91
v_cvt_pk_bf16_f32 v90, v92, v93
v_cvt_pk_bf16_f32 v91, v94, v95
s_nop 0
v_permlane16_swap_b32 v88, v90
v_permlane16_swap_b32 v89, v91
buffer_store_dwordx4 v[88:91], v182, s[32:35], s71 offen
s_or_b32 s71, s4, s5
s_or_b32 s71, s71, s3
s_cmp_lg_u32 s71, 0
s_cbranch_scc1 L_end
v_mov_b32 v20, s7
v_mov_b32 v21, 0
buffer_store_dword v20, v21, s[28:31], 0 offen sc1
L_end:
s_endpgm
Ps4:
s_movk_i32 s82, 4000
Pl5:
buffer_load_dwordx4 v[168:171], v16, s[28:31], 0 offen offset:1024 sc1
s_waitcnt vmcnt(0)
v_xor_b32 v168, s7, v168
v_bitop3_b32 v168, v169, v168, s7 bitop3:0xde
v_bitop3_b32 v168, v170, v168, s7 bitop3:0xde
v_bitop3_b32 v168, v171, v168, s7 bitop3:0xde
v_cmp_ne_u32 vcc, 0, v168
s_cmp_lg_u64 vcc, 0
s_cbranch_scc0 Pk3
s_sub_u32 s82, s82, 1
s_cmp_lg_u32 s82, 0
s_cbranch_scc1 Pl5
s_branch Pk3
Ps7:
s_movk_i32 s82, 4000
Pl8:
v_and_b32 v22, 0xf0, v16
v_lshl_add_u32 v23, v17, 13, v22
buffer_load_dwordx4 v[80:83], v23, s[28:31], s77 offen sc1
s_add_u32 s71, s77, 0x40000
buffer_load_dwordx4 v[84:87], v23, s[28:31], s71 offen sc1
s_waitcnt vmcnt(0)
v_xor_b32 v20, v80, v18
v_bitop3_b32 v20, v81, v20, v47 bitop3:0xde
v_bitop3_b32 v20, v82, v20, v18 bitop3:0xde
v_bitop3_b32 v20, v83, v20, v47 bitop3:0xde
v_bitop3_b32 v20, v84, v20, v18 bitop3:0xde
v_bitop3_b32 v20, v85, v20, v47 bitop3:0xde
v_bitop3_b32 v20, v86, v20, v18 bitop3:0xde
v_bitop3_b32 v20, v87, v20, v47 bitop3:0xde
v_and_b32 v20, s61, v20
v_cmp_ne_u32 vcc, 0, v20
s_cmp_lg_u64 vcc, 0
s_cbranch_scc0 Pk6
s_sub_u32 s82, s82, 1
s_cmp_lg_u32 s82, 0
s_cbranch_scc1 Pl8
s_branch Pk6
Ps10:
s_movk_i32 s82, 4000
Pl11:
s_xor_b32 s71, s68, 0x2000
buffer_load_dwordx4 v[24:27], v16, s[28:31], s71 offen sc1
buffer_load_dwordx4 v[28:31], v16, s[28:31], s71 offen offset:1024 sc1
s_waitcnt vmcnt(0)
v_xor_b32 v20, v24, v18
v_bitop3_b32 v20, v25, v20, v47 bitop3:0xde
v_bitop3_b32 v20, v26, v20, v18 bitop3:0xde
v_bitop3_b32 v20, v27, v20, v47 bitop3:0xde
v_bitop3_b32 v20, v28, v20, v18 bitop3:0xde
v_bitop3_b32 v20, v29, v20, v47 bitop3:0xde
v_bitop3_b32 v20, v30, v20, v18 bitop3:0xde
v_bitop3_b32 v20, v31, v20, v47 bitop3:0xde
v_and_b32 v20, s61, v20
v_cmp_ne_u32 vcc, 0, v20
s_cmp_lg_u64 vcc, 0
s_cbranch_scc0 Pk9
s_sub_u32 s82, s82, 1
s_cmp_lg_u32 s82, 0
s_cbranch_scc1 Pl11
s_branch Pk9
Ps13:
s_movk_i32 s82, 4000
Pl14:
s_xor_b32 s71, s75, 0x180000
buffer_load_dwordx4 v[24:27], v16, s[28:31], s71 offen sc1
buffer_load_dwordx4 v[28:31], v16, s[28:31], s71 offen offset:1024 sc1
s_waitcnt vmcnt(0)
v_xor_b32 v20, v24, v18
v_bitop3_b32 v20, v25, v20, v47 bitop3:0xde
v_bitop3_b32 v20, v26, v20, v18 bitop3:0xde
v_bitop3_b32 v20, v27, v20, v47 bitop3:0xde
v_bitop3_b32 v20, v28, v20, v18 bitop3:0xde
v_bitop3_b32 v20, v29, v20, v47 bitop3:0xde
v_bitop3_b32 v20, v30, v20, v18 bitop3:0xde
v_bitop3_b32 v20, v31, v20, v47 bitop3:0xde
v_and_b32 v20, s61, v20
v_cmp_ne_u32 vcc, 0, v20
s_cmp_lg_u64 vcc, 0
s_cbranch_scc0 Pk12
s_sub_u32 s82, s82, 1
s_cmp_lg_u32 s82, 0
s_cbranch_scc1 Pl14
s_branch Pk12
Ps16:
s_movk_i32 s82, 4000
Pl17:
s_xor_b32 s71, s68, 0x52000
buffer_load_dwordx4 v[24:27], v16, s[28:31], s71 offen sc1
buffer_load_dwordx4 v[28:31], v16, s[28:31], s71 offen offset:1024 sc1
s_waitcnt vmcnt(0)
v_xor_b32 v20, v24, v18
v_bitop3_b32 v20, v25, v20, v19 bitop3:0xde
v_bitop3_b32 v20, v28, v20, v18 bitop3:0xde
v_bitop3_b32 v20, v29, v20, v19 bitop3:0xde
v_and_b32 v20, s61, v20
v_cmp_ne_u32 vcc, 0, v20
s_cmp_lg_u64 vcc, 0
s_cbranch_scc0 Pk15
s_sub_u32 s82, s82, 1
s_cmp_lg_u32 s82, 0
s_cbranch_scc1 Pl17
s_branch Pk15
Ps19:
s_movk_i32 s82, 4000
Pl20:
s_xor_b32 s71, s75, 0x80000
buffer_load_dwordx4 v[24:27], v16, s[28:31], s71 offen sc1
buffer_load_dwordx4 v[28:31], v16, s[28:31], s71 offen offset:1024 sc1
s_waitcnt vmcnt(0)
v_xor_b32 v20, v24, v18
v_bitop3_b32 v20, v25, v20, v19 bitop3:0xde
v_bitop3_b32 v20, v28, v20, v18 bitop3:0xde
v_bitop3_b32 v20, v29, v20, v19 bitop3:0xde
v_and_b32 v20, s61, v20
v_cmp_ne_u32 vcc, 0, v20
s_cmp_lg_u64 vcc, 0
s_cbranch_scc0 Pk18
s_sub_u32 s82, s82, 1
s_cmp_lg_u32 s82, 0
s_cbranch_scc1 Pl20
s_branch Pk18
Ps22:
s_movk_i32 s82, 4000
Pl23:
s_xor_b32 s71, s68, 0x62000
buffer_load_dwordx4 v[24:27], v16, s[28:31], s71 offen sc1
buffer_load_dwordx4 v[28:31], v16, s[28:31], s71 offen offset:1024 sc1
s_waitcnt vmcnt(0)
v_xor_b32 v20, v24, v18
v_bitop3_b32 v20, v25, v20, v47 bitop3:0xde
v_bitop3_b32 v20, v28, v20, v18 bitop3:0xde
v_bitop3_b32 v20, v29, v20, v47 bitop3:0xde
v_and_b32 v20, s61, v20
v_cmp_ne_u32 vcc, 0, v20
s_cmp_lg_u64 vcc, 0
s_cbranch_scc0 Pk21
s_sub_u32 s82, s82, 1
s_cmp_lg_u32 s82, 0
s_cbranch_scc1 Pl23
s_branch Pk21
Ps25:
s_movk_i32 s82, 4000
Pl26:
buffer_load_dwordx4 v[128:131], v169, s[28:31], s78 offen sc1
s_add_u32 s71, s78, 0x82000
buffer_load_dwordx4 v[132:135], v169, s[28:31], s71 offen sc1
buffer_load_dword v136, v170, s[28:31], s69 offen sc1
s_waitcnt vmcnt(0)
v_xor_b32 v20, v128, v18
v_bitop3_b32 v20, v129, v20, v47 bitop3:0xde
v_bitop3_b32 v20, v132, v20, v18 bitop3:0xde
v_bitop3_b32 v20, v133, v20, v47 bitop3:0xde
v_bitop3_b32 v20, v136, v20, v168 bitop3:0xde
v_and_b32 v20, s61, v20
v_cmp_ne_u32 vcc, 0, v20
s_cmp_lg_u64 vcc, 0
s_cbranch_scc0 Pk24
s_sub_u32 s82, s82, 1
s_cmp_lg_u32 s82, 0
s_cbranch_scc1 Pl26
s_branch Pk24
Ps28:
s_movk_i32 s82, 4000
Pl29:
s_xor_b32 s71, s75, 0x0
buffer_load_dwordx4 v[144:147], v16, s[28:31], s71 offen sc1
buffer_load_dwordx4 v[148:151], v16, s[28:31], s71 offen offset:1024 sc1
s_waitcnt vmcnt(0)
v_xor_b32 v20, v144, v18
v_bitop3_b32 v20, v145, v20, v47 bitop3:0xde
v_bitop3_b32 v20, v148, v20, v18 bitop3:0xde
v_bitop3_b32 v20, v149, v20, v47 bitop3:0xde
v_and_b32 v20, s61, v20
v_cmp_ne_u32 vcc, 0, v20
s_cmp_lg_u64 vcc, 0
s_cbranch_scc0 Pk27
s_sub_u32 s82, s82, 1
s_cmp_lg_u32 s82, 0
s_cbranch_scc1 Pl29
s_branch Pk27
Ps31:
s_movk_i32 s82, 4000
Pl32:
s_xor_b32 s71, s68, 0x72000
buffer_load_dwordx4 v[152:155], v16, s[28:31], s71 offen sc1
buffer_load_dwordx4 v[156:159], v16, s[28:31], s71 offen offset:1024 sc1
s_waitcnt vmcnt(0)
v_xor_b32 v20, v152, v18
v_bitop3_b32 v20, v153, v20, v19 bitop3:0xde
v_bitop3_b32 v20, v156, v20, v18 bitop3:0xde
v_bitop3_b32 v20, v157, v20, v19 bitop3:0xde
v_and_b32 v20, s61, v20
v_cmp_ne_u32 vcc, 0, v20
s_cmp_lg_u64 vcc, 0
s_cbranch_scc0 Pk30
s_sub_u32 s82, s82, 1
s_cmp_lg_u32 s82, 0
s_cbranch_scc1 Pl32
s_branch Pk30
ZEND:
.section .rodata,"a"
.p2align 6
.amdhsa_kernel parallel_sum__ssm_conv_h3__dense_activation_gelu__prompt_kernel
  .amdhsa_next_free_vgpr 512
  .amdhsa_next_free_sgpr 102
  .amdhsa_accum_offset 256
  .amdhsa_group_segment_fixed_size 0
  .amdhsa_kernarg_size 112
  .amdhsa_user_sgpr_count 2
  .amdhsa_user_sgpr_kernarg_segment_ptr 1
  .amdhsa_system_sgpr_workgroup_id_x 1
.end_amdhsa_kernel
```
